```python
import torch

def _softmax(x, axis=-1):
    return torch.softmax(x, dim=axis)
def _gelu(x):
    return torch.nn.functional.gelu(x, approximate="tanh")
def _silu(x):
    return torch.nn.functional.silu(x)
def _sigmoid(x):
    return torch.sigmoid(x)
def _layernorm(x, axis=-1, eps=1e-5):
    m = x.mean(dim=axis, keepdim=True)
    v = x.var(dim=axis, keepdim=True, unbiased=False)
    return (x - m) / torch.sqrt(v + eps)
def _scatter_add(tgt, idx, src, axis=0):
    return tgt.clone().index_add_(axis, idx, src)
def _segment_sum(src, seg, n):
    out = torch.zeros((n,) + src.shape[1:], dtype=src.dtype)
    return out.index_add_(0, seg, src)
def _pad(x, pw):
    flat = tuple(v for pair in reversed(pw) for v in pair)
    return torch.nn.functional.pad(x, flat)

kernel_name = 'recurrent_scan__spectral_fnet__glu_gated_reglu__prompt'

def setup_inputs():

    _w = (lambda a: (lambda t: t.to(torch.bfloat16) if t.is_floating_point() else t)(torch.as_tensor(a)))
    def _A_setup():
        B, S, D = 1, 2048, 576
        ns = torch.arange(S)[:, None] * torch.arange(S)[None, :]
        nd = torch.arange(D)[:, None] * torch.arange(D)[None, :]
        Ws_re = torch.cos(-2.0 * torch.pi * ns / S).to(float)
        Ws_im = torch.sin(-2.0 * torch.pi * ns / S).to(float)
        Wd_re = torch.cos(-2.0 * torch.pi * nd / D).to(float)
        Wd_im = torch.sin(-2.0 * torch.pi * nd / D).to(float)
        return {
            "x": _w((lambda *s: torch.randn(*s, dtype=torch.bfloat16) * 0.05)(B, S, D)),
            "dft_seq_re": _w(Ws_re),
            "dft_seq_im": _w(Ws_im),
            "dft_hid_re": _w(Wd_re),
            "dft_hid_im": _w(Wd_im),
        }
    _A_in = _A_setup()

    def _B_setup():
        B, S, D, F = 1, 2048, 576, 4608
        return {
            "x": _w((lambda *s: torch.randn(*s, dtype=torch.bfloat16) * 0.05)(B, S, D)),
            "W_gate": _w((lambda *s: torch.randn(*s, dtype=torch.bfloat16) * 0.05)(D, F) * (2.0 / D) ** 0.5),
            "W_up": _w((lambda *s: torch.randn(*s, dtype=torch.bfloat16) * 0.05)(D, F) * (2.0 / D) ** 0.5),
            "W_down": _w((lambda *s: torch.randn(*s, dtype=torch.bfloat16) * 0.05)(F, D) * (1.0 / F) ** 0.5),
        }
    _B_in = _B_setup()

    return {
        "A_x": _A_in["x"],
        "A_dft_seq_re": _A_in["dft_seq_re"],
        "A_dft_seq_im": _A_in["dft_seq_im"],
        "A_dft_hid_re": _A_in["dft_hid_re"],
        "A_dft_hid_im": _A_in["dft_hid_im"],
        "B_x": _B_in["x"],
        "B_W_gate": _B_in["W_gate"],
        "B_W_up": _B_in["W_up"],
        "B_W_down": _B_in["W_down"],
    }

def reference(A_x, A_dft_seq_re, A_dft_seq_im, A_dft_hid_re, A_dft_hid_im, B_x, B_W_gate, B_W_up, B_W_down):
    def _A_ref(x, dft_seq_re, dft_seq_im, dft_hid_re, dft_hid_im):
        a = torch.einsum("bsd,ed->bse", x, dft_hid_re)
        b = torch.einsum("bsd,ed->bse", x, dft_hid_im)
        y = torch.einsum("ts,bse->bte", dft_seq_re, a) - torch.einsum("ts,bse->bte", dft_seq_im, b)
        return y

    def _B_ref(x, W_gate, W_up, W_down):
        gate = torch.einsum("bsd,df->bsf", x, W_gate)
        up = torch.einsum("bsd,df->bsf", x, W_up)
        gate = gate * (lambda x, dt: x.to(dt))(gate > 0, gate.dtype)
        h = gate * up
        return torch.einsum("bsf,fd->bsd", h, W_down)

    x = A_x
    xn = _layernorm(x, axis=-1)
    s = _A_ref(xn, A_dft_seq_re, A_dft_seq_im, A_dft_hid_re, A_dft_hid_im)
    g = _silu(_B_ref(xn, B_W_gate, B_W_up, B_W_down))
    return x + s * g
```

```asm
; @launch grid=(256,1,1) block=(256,1,1) lds=163840
.amdgcn_target "amdgcn-amd-amdhsa--gfx950"
.text
.globl recurrent_scan__spectral_fnet__glu_gated_reglu__prompt_kernel
.p2align 8
.type recurrent_scan__spectral_fnet__glu_gated_reglu__prompt_kernel,@function
recurrent_scan__spectral_fnet__glu_gated_reglu__prompt_kernel:
s_cmp_ge_u32 s2, 256
s_cbranch_scc1 L_end
s_load_dwordx16 s[76:91], s[0:1], 0
s_load_dwordx8 s[92:99], s[0:1], 64
s_memrealtime s[62:63]
v_lshrrev_b32 v1, 6, v0
v_and_b32 v19, 63, v0
v_readfirstlane_b32 s32, v1
s_and_b32 s35, s2, 3
s_bfe_u32 s44, s2, 0x10002
s_bfe_u32 s36, s2, 0x20003
s_lshr_b32 s45, s2, 5
s_lshl_b32 s45, s45, 1
s_add_u32 s33, s44, s45
s_lshl_b32 s34, s35, 2
s_add_u32 s34, s34, s36
s_lshl_b32 s49, s32, 13
s_lshl_b32 s44, s33, 2
s_add_u32 s44, s44, s32
s_mul_i32 s44, s44, 1152
v_lshrrev_b32 v48, 3, v19
v_mul_u32_u24 v51, 73728, v48
v_add_u32 v51, s44, v51
v_and_b32 v49, 7, v19
v_lshrrev_b32 v50, 4, v19
v_xor_b32 v50, v49, v50
v_lshl_add_u32 v0, v50, 4, v51
v_xor_b32 v50, 4, v50
v_lshl_add_u32 v1, v50, 4, v51
v_add_u32 v2, 1177600, v0
v_add_u32 v3, 1766400, v1
v_add_u32 v1, 588800, v1
s_mul_i32 s44, s34, 576
s_and_b32 s45, s34, 1
s_lshl_b32 s46, s45, 6
s_add_u32 s46, s46, s44
s_lshl_b32 s47, s32, 7
s_add_u32 s46, s46, s47
v_mul_u32_u24 v51, 9216, v48
v_add_u32 v51, s46, v51
v_bfe_u32 v50, v19, 4, 1
v_lshlrev_b32 v50, 1, v50
v_xor_b32 v50, v49, v50
v_lshl_add_u32 v4, v50, 4, v51
v_xor_b32 v50, 4, v50
v_lshl_add_u32 v5, v50, 4, v51
v_add_u32 v6, 145408, v4
v_add_u32 v7, 218112, v5
v_add_u32 v5, 72704, v5
s_lshl_b32 s43, s32, 12
s_add_u32 s43, s43, 98304
s_mov_b32 s10, 2359296
s_mov_b32 s11, 0x20000
s_mov_b32 s14, 5308416
s_mov_b32 s15, 0x20000
s_mov_b32 s39, 0
s_mov_b32 s37, 0
s_mov_b32 m0, s43
s_waitcnt lgkmcnt(0)
s_mov_b64 s[8:9], s[76:77]
s_mov_b64 s[12:13], s[88:89]
buffer_load_dwordx4 v0, s[8:11], s39 offen lds
buffer_load_dwordx4 v1, s[8:11], s39 offen offset:1024 lds
buffer_load_dwordx4 v2, s[8:11], s39 offen offset:2048 lds
buffer_load_dwordx4 v3, s[8:11], s39 offen offset:3072 lds
s_mov_b32 m0, s49
s_mov_b32 s38, 0
buffer_load_dwordx4 v4, s[12:15], s37 offen lds
buffer_load_dwordx4 v5, s[12:15], s37 offen offset:1024 lds
buffer_load_dwordx4 v6, s[12:15], s37 offen offset:2048 lds
buffer_load_dwordx4 v7, s[12:15], s37 offen offset:3072 lds
s_getpc_b64 s[46:47]
L_pca:
s_lshr_b32 s44, s2, 3
s_mul_i32 s44, s44, 1664
v_min_u32 v40, 12, v19
v_lshl_add_u32 v40, v40, 7, s44
v_min_u32 v40, L_end-recurrent_scan__spectral_fnet__glu_gated_reglu__prompt_kernel, v40
s_sub_u32 s46, s46, L_pca-recurrent_scan__spectral_fnet__glu_gated_reglu__prompt_kernel
s_subb_u32 s47, s47, 0
v_mov_b32 v41, s47
v_add_co_u32 v40, vcc, s46, v40
s_nop 1
v_addc_co_u32 v41, vcc, 0, v41, vcc
global_load_dword v40, v[40:41], off
s_mov_b32 s16, s90
s_mov_b32 s17, s91
s_mov_b32 s18, 5308416
s_mov_b32 s19, 0x20000
s_xor_b32 s45, s34, 1
s_and_b32 s45, s45, 1
s_lshl_b32 s45, s45, 9
s_mul_i32 s44, s34, 576
s_add_u32 s45, s45, s44
s_mul_i32 s44, s32, 147456
s_add_u32 s45, s45, s44
v_lshrrev_b32 v48, 2, v19
v_mul_u32_u24 v51, 9216, v48
v_add_u32 v51, s45, v51
v_and_b32 v49, 3, v19
v_lshrrev_b32 v50, 5, v19
v_xor_b32 v49, v49, v50
v_lshl_add_u32 v8, v49, 4, v51
v_mul_u32_u24 v48, 57, v19
v_lshrrev_b32 v48, 9, v48
v_mul_u32_u24 v49, 9, v48
v_sub_u32 v49, v19, v49
v_mul_u32_u24 v50, 589824, v48
v_lshl_add_u32 v50, v49, 7, v50
s_bfe_u32 s44, s2, 0x10002
s_lshl_b32 s44, s44, 5
s_lshr_b32 s45, s2, 3
s_add_u32 s44, s44, s45
s_mul_i32 s44, s44, 9216
s_mul_i32 s45, s35, 2304
s_add_u32 s44, s44, s45
s_and_b32 s45, s32, 1
s_mul_i32 s45, s45, 1152
s_add_u32 s44, s44, s45
v_add_u32 v50, s44, v50
v_cmp_gt_u32 vcc, 1, v48
v_mov_b32 v51, 1073741824
s_nop 0
v_cndmask_b32 v42, v51, v50, vcc
v_cmp_gt_u32 vcc, 2, v48
v_add_u32 v50, 589824, v50
s_nop 0
v_cndmask_b32 v43, v51, v50, vcc
s_lshl_b32 s3, s32, 10
s_add_u32 s3, s3, 114688
s_or_b32 s44, s2, s32
s_cbranch_scc1 L_nononce
s_or_b32 s62, s62, 1
v_mov_b32 v48, 0
v_mov_b32 v49, s62
 global_store_dword v48, v49, s[96:97] offset:8 sc1
L_nononce:
s_cmp_lt_u32 s32, 2
s_cselect_b32 s52, s88, s90
s_cselect_b32 s53, s89, s91
s_mov_b32 s54, 5308416
s_mov_b32 s55, 0x20000
buffer_load_dword v42, v42, s[52:55], 0 offen
s_mov_b32 s20, s98
s_mov_b32 s21, s99
s_mov_b32 s22, 268435456
s_mov_b32 s23, 0x20000
s_mov_b32 s4, s92
s_mov_b32 s5, s93
s_mov_b32 s6, 5308416
s_mov_b32 s7, 0x20000
s_mov_b32 s24, s78
s_mov_b32 s25, s79
s_mov_b32 s26, 8388608
s_mov_b32 s27, 0x20000
s_mov_b32 s28, s80
s_mov_b32 s29, s81
s_mov_b32 s30, 8388608
s_mov_b32 s31, 0x20000
v_lshrrev_b32 v48, 4, v19
v_bfe_u32 v49, v19, 2, 2
v_and_b32 v50, 3, v19
v_lshl_add_u32 v51, v48, 3, v49
v_lshlrev_b32 v52, 7, v51
v_lshl_add_u32 v52, v50, 3, v52
v_add_u32 v52, s49, v52
v_lshrrev_b32 v53, 1, v49
v_and_b32 v54, 1, v48
v_lshl_or_b32 v53, v54, 1, v53
v_lshl_add_u32 v10, v53, 5, v52
v_xor_b32 v11, 32, v10
v_xor_b32 v12, 64, v10
v_xor_b32 v13, 96, v10
v_lshlrev_b32 v52, 6, v51
v_lshrrev_b32 v53, 1, v50
v_lshl_add_u32 v52, v53, 12, v52
s_lshr_b32 s44, s32, 1
v_xor_b32 v54, s44, v54
v_lshl_add_u32 v52, v54, 4, v52
v_and_b32 v53, 1, v50
v_lshl_add_u32 v52, v53, 5, v52
s_and_b32 s44, s32, 1
s_lshl_b32 s44, s44, 3
s_add_u32 s44, s44, 98304
v_add_u32 v14, s44, v52
v_and_b32 v49, 15, v19
v_lshrrev_b32 v50, 1, v49
v_xor_b32 v50, v50, v48
v_lshlrev_b32 v50, 4, v50
v_lshl_add_u32 v50, v49, 7, v50
v_add_u32 v15, s43, v50
v_xor_b32 v16, 0x1000, v15
v_xor_b32 v17, 0x2000, v15
v_xor_b32 v18, 0x3000, v15
s_add_u32 m0, s49, 4096
s_nop 0
buffer_load_dwordx4 v4, s[16:19], s37 offen lds
buffer_load_dwordx4 v5, s[16:19], s37 offen offset:1024 lds
buffer_load_dwordx4 v6, s[16:19], s37 offen offset:2048 lds
buffer_load_dwordx4 v7, s[16:19], s37 offen offset:3072 lds
s_mov_b32 m0, s3
s_nop 0
buffer_load_dwordx4 v8, s[12:15], s38 offen lds
s_add_u32 m0, m0, 4096
s_nop 0
buffer_load_dwordx4 v8, s[16:19], s38 offen lds
s_lshl_b32 s48, s35, 1
s_add_u32 s48, s48, s36
s_cmp_lt_u32 s36, 2
s_cbranch_scc1 L_heavy
s_mov_b32 s48, 8
s_cmp_eq_u32 s34, 2
s_cbranch_scc1 L_heavy
s_lshl_b32 s44, s33, 2
s_add_u32 s44, s44, s35
s_mul_i32 s45, s33, 3
s_add_u32 s45, s45, s35
s_add_u32 s45, s45, 63
s_cmp_eq_u32 s36, 3
s_cselect_b32 s44, s44, s45
s_cselect_b32 s64, 0, 12
s_mul_i32 s45, s44, 171
s_lshr_b32 s45, s45, 9
s_mul_i32 s46, s45, 3
s_sub_u32 s46, s44, s46
s_mul_i32 s60, s46, 147456
s_mul_i32 s48, s46, 73728
s_cmp_ge_u32 s45, 18
s_cselect_b32 s56, s90, s88
s_cselect_b32 s57, s91, s89
s_cselect_b32 s46, 18, 0
s_mov_b32 s58, 5308416
s_mov_b32 s59, 0x20000
s_lshl_b32 s47, s45, 11
s_add_u32 s48, s48, s47
s_lshl_b32 s47, s32, 9
s_add_u32 s48, s48, s47
s_add_u32 s48, s48, 21233664
s_sub_u32 s45, s45, s46
s_lshl_b32 s45, s45, 9
s_lshl_b32 s47, s32, 7
s_add_u32 s45, s45, s47
s_cmp_ge_u32 s44, 108
s_cselect_b32 s60, 1073741824, s60
s_cselect_b32 s48, 1073741824, s48
s_cmp_eq_u32 s44, 108
s_cselect_b32 s63, 0, 1073741824
v_lshrrev_b32 v48, 4, v19
v_bfe_u32 v49, v19, 3, 1
v_lshl_add_u32 v49, v49, 2, v48
v_mul_u32_u24 v49, 9216, v49
v_and_b32 v50, 7, v19
v_lshl_add_u32 v49, v50, 4, v49
v_add_u32 v20, s45, v49
v_add_u32 v21, 73728, v20
s_lshl_b32 s44, s35, 2
s_add_u32 s44, s44, s32
s_add_u32 s64, s64, s44
s_mul_i32 s44, s64, 171
s_lshr_b32 s44, s44, 9
s_mul_i32 s45, s44, 3
s_sub_u32 s45, s64, s45
s_cmp_lt_u32 s64, 24
s_cselect_b32 s61, 0, 1073741824
s_lshl_b32 s46, s33, 3
s_add_u32 s46, s46, s44
s_lshl_b32 s46, s46, 8
s_lshl_b32 s47, s45, 15
s_add_u32 s46, s46, s47
s_add_u32 s46, s46, 21463040
s_add_u32 s64, s46, s61
s_and_b32 s46, s44, 1
s_lshl_b32 s46, s46, 10
s_lshr_b32 s44, s44, 1
s_add_u32 s44, s44, s46
s_lshl_b32 s46, s33, 2
s_add_u32 s44, s44, s46
s_mul_i32 s44, s44, 1152
s_lshl_b32 s45, s45, 7
s_add_u32 s44, s44, s45
v_and_b32 v49, 15, v19
v_mul_u32_u24 v50, 73728, v49
v_lshl_add_u32 v50, v48, 4, v50
v_add_u32 v22, s44, v50
s_add_u32 m0, s49, 32768
s_mov_b32 s37, 294912
buffer_load_dwordx4 v4, s[12:15], s37 offen lds
buffer_load_dwordx4 v5, s[12:15], s37 offen offset:1024 lds
buffer_load_dwordx4 v6, s[12:15], s37 offen offset:2048 lds
buffer_load_dwordx4 v7, s[12:15], s37 offen offset:3072 lds
buffer_load_dword v43, v43, s[52:55], 0 offen
s_lshl_b32 s44, s34, 3
s_lshl_b32 s45, s32, 1
s_add_u32 s44, s44, s45
s_lshr_b32 s45, s44, 5
s_and_b32 s44, s44, 31
s_lshl_b32 s44, s44, 6
s_add_u32 s44, s44, s45
s_lshl_b32 s45, s33, 2
s_add_u32 s44, s44, s45
s_mul_i32 s44, s44, 1152
s_add_u32 s44, s44, 128
v_and_b32 v48, 1, v19
v_mul_u32_u24 v48, 73728, v48
v_lshrrev_b32 v49, 1, v19
v_lshl_add_u32 v48, v49, 7, v48
v_cmp_gt_u32 vcc, 6, v19
v_add_u32 v48, s44, v48
v_mov_b32 v49, 1073741824
v_cndmask_b32 v44, v49, v48, vcc
buffer_load_dword v44, v44, s[8:11], 0 offen
s_mov_b32 s52, s94
s_mov_b32 s53, s95
s_mov_b32 s54, 2359296
s_mov_b32 s55, 0x20000
s_lshl_b32 s45, s32, 4
v_and_b32 v48, 15, v19
v_add_u32 v48, s45, v48
v_lshrrev_b32 v49, 4, v19
v_lshlrev_b32 v50, 4, v49
v_lshrrev_b32 v51, 1, v48
v_lshl_add_u32 v50, v51, 6, v50
v_and_b32 v51, 1, v48
v_lshl_add_u32 v45, v51, 13, v50
v_lshlrev_b32 v49, 3, v49
v_lshl_add_u32 v38, v48, 17, v49
v_sub_u32 v48, 64, v48
v_and_b32 v48, 63, v48
v_lshl_add_u32 v39, v48, 17, v49
s_bfe_u32 s41, s2, 0x10005
v_and_b32 v49, 1, v19
v_lshlrev_b32 v49, 4, v49
v_mov_b32 v50, 0x3f80
v_lshlrev_b32 v49, v49, v50
v_bfe_u32 v50, v19, 1, 2
s_mov_b32 s44, 0x3f803f80
v_cmp_eq_u32 vcc, 0, v50
v_accvgpr_write_b32 a248, s44
s_nop 0
v_cndmask_b32 v51, 0, v49, vcc
v_accvgpr_write_b32 a244, v51
v_cmp_eq_u32 vcc, 1, v50
v_accvgpr_write_b32 a249, s44
s_nop 0
v_cndmask_b32 v51, 0, v49, vcc
v_accvgpr_write_b32 a245, v51
v_cmp_eq_u32 vcc, 2, v50
v_accvgpr_write_b32 a250, s44
s_nop 0
v_cndmask_b32 v51, 0, v49, vcc
v_accvgpr_write_b32 a246, v51
v_cmp_eq_u32 vcc, 3, v50
v_accvgpr_write_b32 a251, s44
s_nop 0
v_cndmask_b32 v51, 0, v49, vcc
v_accvgpr_write_b32 a247, v51
s_add_u32 s50, s49, 32768
s_mov_b32 s42, 6
s_waitcnt vmcnt(14)
s_barrier
ds_read_b128 a[0:3], v15 offset:0
ds_read_b128 a[4:7], v15 offset:2048
ds_read_b128 a[8:11], v16 offset:0
ds_read_b128 a[12:15], v16 offset:2048
ds_read_b128 a[16:19], v17 offset:0
ds_read_b128 a[20:23], v17 offset:2048
ds_read_b128 a[24:27], v18 offset:0
ds_read_b128 a[28:31], v18 offset:2048
ds_read_b64_tr_b16 a[64:65], v10 offset:0
ds_read_b64_tr_b16 a[66:67], v10 offset:512
ds_read_b64_tr_b16 a[72:73], v11 offset:0
ds_read_b64_tr_b16 a[74:75], v11 offset:512
ds_read_b64_tr_b16 a[80:81], v12 offset:0
ds_read_b64_tr_b16 a[82:83], v12 offset:512
ds_read_b64_tr_b16 a[88:89], v13 offset:0
ds_read_b64_tr_b16 a[90:91], v13 offset:512
v_xor_b32 v15, 64, v15
v_xor_b32 v16, 64, v16
v_xor_b32 v17, 64, v17
v_xor_b32 v18, 64, v18
v_mov_b32 v33, 0
global_load_dword v33, v33, s[96:97] offset:8 sc1
s_waitcnt lgkmcnt(0)
v_mfma_f32_16x16x32_bf16 v[56:59], a[64:67], a[0:3], 0
v_mfma_f32_16x16x32_bf16 v[60:63], a[64:67], a[4:7], 0
v_mfma_f32_16x16x32_bf16 v[64:67], a[64:67], a[8:11], 0
s_add_u32 m0, s50, 4096
v_mfma_f32_16x16x32_bf16 v[68:71], a[64:67], a[12:15], 0
v_mfma_f32_16x16x32_bf16 v[72:75], a[64:67], a[16:19], 0
buffer_load_dwordx4 v4, s[16:19], s37 offen lds
v_mfma_f32_16x16x32_bf16 v[76:79], a[64:67], a[20:23], 0
v_mfma_f32_16x16x32_bf16 v[80:83], a[64:67], a[24:27], 0
s_waitcnt vmcnt(4)
buffer_load_dwordx4 v5, s[16:19], s37 offen offset:1024 lds
v_mfma_f32_16x16x32_bf16 v[84:87], a[64:67], a[28:31], 0
ds_read_b64_tr_b16 a[64:65], v10 offset:32768
v_mfma_f32_16x16x32_bf16 v[120:123], a[72:75], a[0:3], 0
ds_read_b64_tr_b16 a[66:67], v10 offset:33280
buffer_load_dwordx4 v6, s[16:19], s37 offen offset:2048 lds
s_lshl_b32 s44, s36, 8
v_mfma_f32_16x16x32_bf16 v[124:127], a[72:75], a[4:7], 0
s_lshl_b32 s45, s35, 1
v_lshrrev_b32 v48, 4, v19
v_mfma_f32_16x16x32_bf16 v[128:131], a[72:75], a[8:11], 0
ds_read_b128 a[32:35], v15 offset:0
v_bfe_u32 v49, v19, 1, 3
v_mfma_f32_16x16x32_bf16 v[132:135], a[72:75], a[12:15], 0
buffer_load_dwordx4 v7, s[16:19], s37 offen offset:3072 lds
v_xor_b32 v49, v49, v48
v_mfma_f32_16x16x32_bf16 v[136:139], a[72:75], a[16:19], 0
v_xor_b32 v49, s45, v49
v_mfma_f32_16x16x32_bf16 v[140:143], a[72:75], a[20:23], 0
s_mov_b32 s39, 128
v_mul_u32_u24 v48, 1152, v48
v_mfma_f32_16x16x32_bf16 v[144:147], a[72:75], a[24:27], 0
ds_read_b128 a[36:39], v15 offset:2048
v_and_b32 v50, 1, v19
v_mfma_f32_16x16x32_bf16 v[148:151], a[72:75], a[28:31], 0
ds_read_b64_tr_b16 a[72:73], v11 offset:32768
s_xor_b32 m0, s43, 229376
v_lshl_add_u32 v48, v50, 4, v48
v_mfma_f32_16x16x32_bf16 v[160:163], a[80:83], a[0:3], 0
ds_read_b64_tr_b16 a[74:75], v11 offset:33280
v_add_u32 v48, s44, v48
v_mfma_f32_16x16x32_bf16 v[164:167], a[80:83], a[4:7], 0
s_mov_b32 s38, 589824
v_lshl_add_u32 v24, v49, 5, v48
v_mfma_f32_16x16x32_bf16 v[168:171], a[80:83], a[8:11], 0
s_waitcnt vmcnt(11)
s_barrier
v_xor_b32 v49, 4, v49
v_mfma_f32_16x16x32_bf16 v[172:175], a[80:83], a[12:15], 0
ds_read_b64_tr_b16 a[96:97], v14 offset:16384
v_lshl_add_u32 v25, v49, 5, v48
v_mfma_f32_16x16x32_bf16 v[176:179], a[80:83], a[16:19], 0
ds_read_b64_tr_b16 a[98:99], v14 offset:16640
buffer_load_dwordx4 v0, s[8:11], s39 offen lds
v_add_u32 v26, 7168, v24
v_mfma_f32_16x16x32_bf16 v[180:183], a[80:83], a[20:23], 0
ds_read_b64_tr_b16 a[68:69], v10 offset:4096
v_add_u32 v27, 10752, v25
v_mfma_f32_16x16x32_bf16 v[184:187], a[80:83], a[24:27], 0
ds_read_b64_tr_b16 a[70:71], v10 offset:4608
buffer_load_dwordx4 v1, s[8:11], s39 offen offset:1024 lds
v_add_u32 v25, 3584, v25
v_mfma_f32_16x16x32_bf16 v[188:191], a[80:83], a[28:31], 0
ds_read_b64_tr_b16 a[76:77], v11 offset:4096
v_lshrrev_b32 v48, 3, v19
v_mfma_f32_16x16x32_bf16 v[192:195], a[88:91], a[0:3], 0
ds_read_b64_tr_b16 a[78:79], v11 offset:4608
buffer_load_dwordx4 v2, s[8:11], s39 offen offset:2048 lds
v_bfe_u32 v49, v19, 1, 2
v_mfma_f32_16x16x32_bf16 v[196:199], a[88:91], a[4:7], 0
ds_read_b64_tr_b16 a[84:85], v12 offset:4096
v_bfe_u32 v51, v19, 4, 2
v_mfma_f32_16x16x32_bf16 v[200:203], a[88:91], a[8:11], 0
ds_read_b64_tr_b16 a[86:87], v12 offset:4608
buffer_load_dwordx4 v3, s[8:11], s39 offen offset:3072 lds
v_xor_b32 v49, v49, v51
v_mfma_f32_16x16x32_bf16 v[204:207], a[88:91], a[12:15], 0
ds_read_b64_tr_b16 a[92:93], v13 offset:4096
v_mul_u32_u24 v48, 1152, v48
v_mfma_f32_16x16x32_bf16 v[208:211], a[88:91], a[16:19], 0
ds_read_b64_tr_b16 a[94:95], v13 offset:4608
v_lshl_add_u32 v48, v50, 4, v48
v_mfma_f32_16x16x32_bf16 v[212:215], a[88:91], a[20:23], 0
ds_read_b64_tr_b16 a[80:81], v12 offset:32768
s_xor_b32 m0, s3, 229376
v_lshl_add_u32 v48, v49, 5, v48
v_mfma_f32_16x16x32_bf16 v[216:219], a[88:91], a[24:27], 0
ds_read_b64_tr_b16 a[82:83], v12 offset:33280
buffer_load_dwordx4 a[100:103], v20, s[56:59], s60 offen
v_add_u32 v28, 1024, v48
v_mfma_f32_16x16x32_bf16 v[220:223], a[88:91], a[28:31], 0
s_waitcnt lgkmcnt(10)
buffer_load_dwordx4 v8, s[12:15], s38 offen lds
s_mov_b32 s75, 0x02030100
v_mfma_f32_16x16x32_bf16 v[224:227], a[96:99], a[0:3], 0
ds_read_b64_tr_b16 a[88:89], v13 offset:32768
s_cmp_ge_u32 s36, 1
s_cselect_b32 s75, 0x03020001, s75
v_mfma_f32_16x16x32_bf16 v[228:231], a[96:99], a[4:7], 0
ds_read_b64_tr_b16 a[90:91], v13 offset:33280
s_add_u32 m0, m0, 4096
v_mfma_f32_16x16x32_bf16 v[232:235], a[96:99], a[8:11], 0
v_xor_b32 v15, 229440, v15
buffer_load_dwordx4 a[104:107], v21, s[56:59], s60 offen
v_mfma_f32_16x16x32_bf16 v[236:239], a[96:99], a[12:15], 0
ds_read_b128 a[40:43], v16 offset:0
s_cmp_ge_u32 s36, 2
s_cselect_b32 s75, 0x03010002, s75
s_cselect_b32 s65, 4, 0
v_mfma_f32_16x16x32_bf16 v[240:243], a[96:99], a[16:19], 0
ds_read_b128 a[44:47], v16 offset:2048
buffer_load_dwordx4 v8, s[16:19], s38 offen lds
v_mfma_f32_16x16x32_bf16 v[244:247], a[96:99], a[20:23], 0
v_xor_b32 v16, 229440, v16
buffer_load_dwordx4 a[108:111], v22, s[8:11], s61 offen
v_mfma_f32_16x16x32_bf16 v[248:251], a[96:99], a[24:27], 0
ds_read_b128 a[48:51], v17 offset:0
s_mov_b32 s37, 589824
s_cmp_ge_u32 s36, 3
s_cselect_b32 s75, 0x02000103, s75
v_mfma_f32_16x16x32_bf16 v[252:255], a[96:99], a[28:31], 0
s_waitcnt lgkmcnt(7)
s_add_u32 s60, s60, 442368
s_lshr_b32 s44, s33, 1
v_mfma_f32_16x16x32_bf16 v[88:91], a[68:71], a[0:3], 0
ds_read_b64_tr_b16 a[96:97], v14 offset:18432
s_mov_b32 m0, s49
s_and_b32 s44, s44, 7
v_mfma_f32_16x16x32_bf16 v[92:95], a[68:71], a[4:7], 0
ds_read_b64_tr_b16 a[98:99], v14 offset:18688
s_add_u32 s65, s65, s44
v_mfma_f32_16x16x32_bf16 v[96:99], a[68:71], a[8:11], 0
ds_read_b128 a[52:55], v17 offset:2048
buffer_load_dwordx4 v4, s[12:15], s37 offen lds
v_mfma_f32_16x16x32_bf16 v[100:103], a[68:71], a[12:15], 0
s_add_u32 s61, s61, 64
s_cmp_ge_u32 s65, 9
s_cselect_b32 s44, 9, 0
v_mfma_f32_16x16x32_bf16 v[104:107], a[68:71], a[16:19], 0
s_sub_u32 s65, s65, s44
v_lshl_add_u32 v48, v19, 2, s32
v_mul_u32_u24 v49, 57, v48
v_mfma_f32_16x16x32_bf16 v[108:111], a[68:71], a[20:23], 0
v_xor_b32 v17, 229440, v17
buffer_load_dwordx4 v5, s[12:15], s37 offen offset:1024 lds
v_lshrrev_b32 v49, 9, v49
v_mfma_f32_16x16x32_bf16 v[112:115], a[68:71], a[24:27], 0
s_waitcnt vmcnt(11)
v_mul_u32_u24 v50, 9, v49
v_sub_u32 v48, v48, v50
v_mfma_f32_16x16x32_bf16 v[116:119], a[68:71], a[28:31], 0
ds_read_b64_tr_b16 a[68:69], v10 offset:36864
buffer_load_dwordx4 v6, s[12:15], s37 offen offset:2048 lds
v_cmp_eq_u32 vcc, 0, v49
v_mfma_f32_16x16x32_bf16 v[152:155], a[76:79], a[0:3], 0
ds_read_b64_tr_b16 a[70:71], v10 offset:37376
s_cmp_ge_u32 s61, 1152
s_cselect_b32 s61, 1073741824, s61
v_mfma_f32_16x16x32_bf16 v[156:159], a[76:79], a[4:7], 0
ds_read_b128 a[56:59], v18 offset:0
buffer_load_dwordx4 v7, s[12:15], s37 offen offset:3072 lds
v_mov_b32 v50, s65
v_mfma_f32_16x16x32_bf16 a[188:191], a[76:79], a[8:11], 0
buffer_load_dwordx4 a[112:115], v20, s[56:59], s60 offen
s_nop 0
v_cndmask_b32_e64 v50, v50, 0, vcc
v_mfma_f32_16x16x32_bf16 a[192:195], a[76:79], a[12:15], 0
s_waitcnt lgkmcnt(13)
s_add_u32 m0, m0, 4096
v_add_u32 v48, v48, v50
v_mfma_f32_16x16x32_bf16 a[196:199], a[76:79], a[16:19], 0
buffer_load_dwordx4 a[116:119], v21, s[56:59], s60 offen
v_cmp_lt_u32 vcc, 8, v48
v_subrev_u32 v50, 9, v48
v_mfma_f32_16x16x32_bf16 a[200:203], a[76:79], a[20:23], 0
v_lshlrev_b32 v49, 3, v49
v_cndmask_b32 v48, v48, v50, vcc
v_bfe_u32 v49, s75, v49, 8
v_mfma_f32_16x16x32_bf16 a[204:207], a[76:79], a[24:27], 0
ds_read_b128 a[60:63], v18 offset:2048
buffer_load_dwordx4 v4, s[16:19], s37 offen lds
s_mul_i32 s45, s35, 36
v_mfma_f32_16x16x32_bf16 a[208:211], a[76:79], a[28:31], 0
ds_read_b64_tr_b16 a[76:77], v11 offset:36864
buffer_load_dwordx4 a[120:123], v22, s[8:11], s61 offen
v_mad_u32_u24 v48, v49, 9, v48
v_mfma_f32_16x16x32_bf16 a[124:127], a[84:87], a[0:3], 0
ds_read_b64_tr_b16 a[78:79], v11 offset:37376
buffer_load_dwordx4 v5, s[16:19], s37 offen offset:1024 lds
v_add_u32 v48, s45, v48
v_mfma_f32_16x16x32_bf16 a[128:131], a[84:87], a[4:7], 0
s_add_u32 s60, s60, 442368
v_mul_u32_u24 v48, 36864, v48
v_mfma_f32_16x16x32_bf16 a[132:135], a[84:87], a[8:11], 0
v_xor_b32 v18, 229440, v18
buffer_load_dwordx4 v6, s[16:19], s37 offen offset:2048 lds
s_mul_i32 s51, s34, 331776
v_mfma_f32_16x16x32_bf16 a[136:139], a[84:87], a[12:15], 0
v_readlane_b32 s66, v48, 0
v_mfma_f32_16x16x32_bf16 a[140:143], a[84:87], a[16:19], 0
buffer_load_dwordx4 v7, s[16:19], s37 offen offset:3072 lds
s_add_u32 s61, s61, 320
v_readlane_b32 s67, v48, 1
v_mfma_f32_16x16x32_bf16 a[144:147], a[84:87], a[20:23], 0
v_readlane_b32 s68, v48, 2
v_mfma_f32_16x16x32_bf16 a[148:151], a[84:87], a[24:27], 0
v_readlane_b32 s69, v48, 3
v_mfma_f32_16x16x32_bf16 a[152:155], a[84:87], a[28:31], 0
ds_read_b64_tr_b16 a[84:85], v12 offset:36864
s_add_u32 s37, s37, 294912
v_readlane_b32 s70, v48, 4
v_mfma_f32_16x16x32_bf16 a[156:159], a[92:95], a[0:3], 0
ds_read_b64_tr_b16 a[86:87], v12 offset:37376
v_readlane_b32 s71, v48, 5
v_mfma_f32_16x16x32_bf16 a[160:163], a[92:95], a[4:7], 0
s_mov_b32 s39, 256
v_mfma_f32_16x16x32_bf16 a[164:167], a[92:95], a[8:11], 0
s_cmp_ge_u32 s61, 1152
s_cselect_b32 s61, 1073741824, s61
v_mfma_f32_16x16x32_bf16 a[168:171], a[92:95], a[12:15], 0
s_mov_b32 s38, 1179648
v_mfma_f32_16x16x32_bf16 a[172:175], a[92:95], a[16:19], 0
v_mfma_f32_16x16x32_bf16 a[176:179], a[92:95], a[20:23], 0
v_mfma_f32_16x16x32_bf16 a[180:183], a[92:95], a[24:27], 0
v_mfma_f32_16x16x32_bf16 a[184:187], a[92:95], a[28:31], 0
s_waitcnt lgkmcnt(4)
v_mfma_f32_16x16x32_bf16 v[56:59], a[64:67], a[32:35], v[56:59]
ds_read_b64_tr_b16 a[92:93], v13 offset:36864
v_mfma_f32_16x16x32_bf16 v[60:63], a[64:67], a[36:39], v[60:63]
ds_read_b64_tr_b16 a[94:95], v13 offset:37376
v_mfma_f32_16x16x32_bf16 v[64:67], a[64:67], a[40:43], v[64:67]
s_mov_b32 m0, s50
v_mfma_f32_16x16x32_bf16 v[68:71], a[64:67], a[44:47], v[68:71]
v_mfma_f32_16x16x32_bf16 v[72:75], a[64:67], a[48:51], v[72:75]
buffer_load_dwordx4 v4, s[12:15], s37 offen lds
v_mfma_f32_16x16x32_bf16 v[76:79], a[64:67], a[52:55], v[76:79]
v_mfma_f32_16x16x32_bf16 v[80:83], a[64:67], a[56:59], v[80:83]
s_waitcnt vmcnt(8)
s_barrier
v_mfma_f32_16x16x32_bf16 v[84:87], a[64:67], a[60:63], v[84:87]
ds_read_b64_tr_b16 a[64:65], v10 offset:0
v_mfma_f32_16x16x32_bf16 v[120:123], a[72:75], a[32:35], v[120:123]
ds_read_b64_tr_b16 a[66:67], v10 offset:512
v_readlane_b32 s72, v48, 6
v_mfma_f32_16x16x32_bf16 v[124:127], a[72:75], a[36:39], v[124:127]
buffer_load_dwordx4 v5, s[12:15], s37 offen offset:1024 lds
v_readlane_b32 s73, v48, 7
v_mfma_f32_16x16x32_bf16 v[128:131], a[72:75], a[40:43], v[128:131]
ds_read_b128 a[0:3], v15 offset:0
v_readlane_b32 s100, v48, 8
v_mfma_f32_16x16x32_bf16 v[132:135], a[72:75], a[44:47], v[132:135]
buffer_load_dwordx4 v6, s[12:15], s37 offen offset:2048 lds
s_bfe_u32 s44, s2, 0x10002
v_mfma_f32_16x16x32_bf16 v[136:139], a[72:75], a[48:51], v[136:139]
s_mul_i32 s44, s44, 576
v_mfma_f32_16x16x32_bf16 v[140:143], a[72:75], a[52:55], v[140:143]
buffer_load_dwordx4 v7, s[12:15], s37 offen offset:3072 lds
s_mul_i32 s45, s35, 1152
v_mfma_f32_16x16x32_bf16 v[144:147], a[72:75], a[56:59], v[144:147]
ds_read_b128 a[4:7], v15 offset:2048
s_add_u32 s44, s44, s45
v_mfma_f32_16x16x32_bf16 v[148:151], a[72:75], a[60:63], v[148:151]
ds_read_b64_tr_b16 a[72:73], v11 offset:0
s_lshr_b32 s45, s2, 3
v_mfma_f32_16x16x32_bf16 v[160:163], a[80:83], a[32:35], v[160:163]
ds_read_b64_tr_b16 a[74:75], v11 offset:512
s_mul_i32 s45, s45, 18
v_mfma_f32_16x16x32_bf16 v[164:167], a[80:83], a[36:39], v[164:167]
s_waitcnt lgkmcnt(6)
s_add_u32 m0, m0, 4096
s_add_u32 s44, s44, s45
v_mfma_f32_16x16x32_bf16 v[168:171], a[80:83], a[40:43], v[168:171]
v_xor_b32 v15, 64, v15
s_mul_i32 s44, s44, 1152
v_mfma_f32_16x16x32_bf16 v[172:175], a[80:83], a[44:47], v[172:175]
buffer_load_dwordx4 v4, s[16:19], s37 offen lds
v_mfma_f32_16x16x32_bf16 v[176:179], a[80:83], a[48:51], v[176:179]
s_mul_i32 s45, s32, 5248
v_mfma_f32_16x16x32_bf16 v[180:183], a[80:83], a[52:55], v[180:183]
s_add_u32 s44, s44, s45
v_mfma_f32_16x16x32_bf16 v[184:187], a[80:83], a[56:59], v[184:187]
buffer_load_dwordx4 v5, s[16:19], s37 offen offset:1024 lds
v_lshl_add_u32 v31, v19, 7, s44
v_mfma_f32_16x16x32_bf16 v[188:191], a[80:83], a[60:63], v[188:191]
ds_read_b64_tr_b16 a[80:81], v12 offset:0
v_cmp_gt_u32 vcc, 41, v19
v_mfma_f32_16x16x32_bf16 v[192:195], a[88:91], a[32:35], v[192:195]
ds_read_b64_tr_b16 a[82:83], v12 offset:512
v_mov_b32 v49, 1073741824
v_mfma_f32_16x16x32_bf16 v[196:199], a[88:91], a[36:39], v[196:199]
ds_read_b128 a[8:11], v16 offset:0
s_lshl_b32 s44, s2, 3
v_mfma_f32_16x16x32_bf16 v[200:203], a[88:91], a[40:43], v[200:203]
buffer_load_dwordx4 v6, s[16:19], s37 offen offset:2048 lds
s_lshr_b32 s45, s32, 1
v_mfma_f32_16x16x32_bf16 v[204:207], a[88:91], a[44:47], v[204:207]
ds_read_b128 a[12:15], v16 offset:2048
v_cndmask_b32 v31, v49, v31, vcc
v_mfma_f32_16x16x32_bf16 v[208:211], a[88:91], a[48:51], v[208:211]
buffer_load_dwordx4 v7, s[16:19], s37 offen offset:3072 lds
s_bitcmp1_b32 s2, 2
s_mov_b32 s46, 663552
s_cselect_b32 s46, 4294303744, s46
v_mfma_f32_16x16x32_bf16 v[212:215], a[88:91], a[52:55], v[212:215]
v_add_u32 v29, s46, v31
v_mfma_f32_16x16x32_bf16 v[216:219], a[88:91], a[56:59], v[216:219]
s_lshl_b32 s45, s45, 2
v_mfma_f32_16x16x32_bf16 v[220:223], a[88:91], a[60:63], v[220:223]
ds_read_b64_tr_b16 a[88:89], v13 offset:0
v_mfma_f32_16x16x32_bf16 v[224:227], a[96:99], a[32:35], v[224:227]
ds_read_b64_tr_b16 a[90:91], v13 offset:512
s_add_u32 s44, s44, s45
v_mfma_f32_16x16x32_bf16 v[228:231], a[96:99], a[36:39], v[228:231]
v_xor_b32 v14, 229376, v14
v_add_u32 v48, s44, v19
v_mfma_f32_16x16x32_bf16 v[232:235], a[96:99], a[40:43], v[232:235]
v_xor_b32 v16, 64, v16
v_cmp_gt_u32 vcc, 4, v19
v_mfma_f32_16x16x32_bf16 v[236:239], a[96:99], a[44:47], v[236:239]
s_add_u32 s37, s37, 294912
v_lshlrev_b32 v48, 12, v48
v_mfma_f32_16x16x32_bf16 v[240:243], a[96:99], a[48:51], v[240:243]
ds_read_b128 a[16:19], v17 offset:0
s_nop 0
v_mfma_f32_16x16x32_bf16 v[244:247], a[96:99], a[52:55], v[244:247]
s_mov_b32 m0, s43
v_cndmask_b32 v32, v49, v48, vcc
v_mfma_f32_16x16x32_bf16 v[248:251], a[96:99], a[56:59], v[248:251]
buffer_load_dwordx4 v0, s[8:11], s39 offen lds
s_mul_i32 s44, s34, 2304
v_mfma_f32_16x16x32_bf16 v[252:255], a[96:99], a[60:63], v[252:255]
s_waitcnt vmcnt(12)
s_and_b32 s45, s34, 1
v_mfma_f32_16x16x32_bf16 a[212:215], a[244:247], a[100:103], 0
ds_read_b64_tr_b16 a[96:97], v14 offset:16384
s_lshl_b32 s46, s45, 8
v_mfma_f32_16x16x32_bf16 a[216:219], a[248:251], a[108:111], 0
ds_read_b64_tr_b16 a[98:99], v14 offset:16640
s_add_u32 s46, s46, s44
v_mfma_f32_16x16x32_bf16 a[220:223], a[108:111], a[108:111], 0
ds_read_b128 a[20:23], v17 offset:2048
v_mfma_f32_16x16x32_bf16 a[212:215], a[244:247], a[104:107], a[212:215]
buffer_load_dwordx4 v1, s[8:11], s39 offen offset:1024 lds
s_lshl_b32 s47, s32, 9
v_mfma_f32_16x16x32_bf16 a[212:215], a[244:247], a[112:115], a[212:215]
buffer_load_dwordx4 v2, s[8:11], s39 offen offset:2048 lds
s_add_u32 s46, s46, s47
v_mfma_f32_16x16x32_bf16 a[216:219], a[248:251], a[120:123], a[216:219]
v_xor_b32 v17, 64, v17
s_xor_b32 s45, s45, 1
v_mfma_f32_16x16x32_bf16 a[220:223], a[120:123], a[120:123], a[220:223]
buffer_load_dwordx4 v3, s[8:11], s39 offen offset:3072 lds
s_lshl_b32 s45, s45, 11
v_mfma_f32_16x16x32_bf16 a[212:215], a[244:247], a[116:119], a[212:215]
s_waitcnt lgkmcnt(15)
s_add_u32 s45, s45, s44
v_mfma_f32_16x16x32_bf16 v[88:91], a[68:71], a[32:35], v[88:91]
buffer_load_dwordx4 a[100:103], v20, s[56:59], s60 offen
s_lshl_b32 s47, s32, 5
v_mfma_f32_16x16x32_bf16 v[92:95], a[68:71], a[36:39], v[92:95]
ds_read_b128 a[24:27], v18 offset:0
s_add_u32 s45, s45, s47
v_mfma_f32_16x16x32_bf16 v[96:99], a[68:71], a[40:43], v[96:99]
s_mov_b32 m0, s3
buffer_load_dwordx4 a[104:107], v21, s[56:59], s60 offen
v_lshrrev_b32 v48, 4, v19
v_mfma_f32_16x16x32_bf16 v[100:103], a[68:71], a[44:47], v[100:103]
v_mul_u32_u24 v49, 73728, v48
v_mfma_f32_16x16x32_bf16 v[104:107], a[68:71], a[48:51], v[104:107]
buffer_load_dwordx4 v8, s[12:15], s38 offen lds
buffer_load_dwordx4 a[108:111], v22, s[8:11], s61 offen
v_cmp_eq_u32 vcc, 3, v48
v_mfma_f32_16x16x32_bf16 v[108:111], a[68:71], a[52:55], v[108:111]
v_mov_b32 v50, 1073741824
v_mfma_f32_16x16x32_bf16 v[112:115], a[68:71], a[56:59], v[112:115]
s_waitcnt vmcnt(16)
s_add_u32 s60, s60, 442368
v_mfma_f32_16x16x32_bf16 v[116:119], a[68:71], a[60:63], v[116:119]
ds_read_b64_tr_b16 a[68:69], v10 offset:4096
v_and_b32 v51, 15, v19
v_mfma_f32_16x16x32_bf16 v[152:155], a[76:79], a[32:35], v[152:155]
ds_read_b64_tr_b16 a[70:71], v10 offset:4608
s_add_u32 s61, s61, 64
v_cndmask_b32 v49, v49, v50, vcc
v_mfma_f32_16x16x32_bf16 v[156:159], a[76:79], a[36:39], v[156:159]
ds_read_b128 a[28:31], v18 offset:2048
v_lshl_add_u32 v52, v51, 3, v49
v_mfma_f32_16x16x32_bf16 a[188:191], a[76:79], a[40:43], a[188:191]
v_xor_b32 v18, 64, v18
v_add_u32 v34, s46, v52
v_mfma_f32_16x16x32_bf16 a[192:195], a[76:79], a[44:47], a[192:195]
s_add_u32 m0, m0, 4096
v_and_b32 v52, 3, v19
v_mfma_f32_16x16x32_bf16 a[196:199], a[76:79], a[48:51], a[196:199]
buffer_load_dwordx4 v8, s[16:19], s38 offen lds
v_lshlrev_b32 v37, 7, v52
v_mfma_f32_16x16x32_bf16 a[200:203], a[76:79], a[52:55], a[200:203]
s_add_u32 s38, s38, 589824
s_cmp_ge_u32 s61, 1152
s_cselect_b32 s61, 1073741824, s61
v_mfma_f32_16x16x32_bf16 a[204:207], a[76:79], a[56:59], a[204:207]
buffer_load_dwordx4 a[112:115], v20, s[56:59], s60 offen
v_lshl_add_u32 v49, v52, 3, v49
v_bfe_u32 v52, v19, 2, 1
v_mfma_f32_16x16x32_bf16 a[208:211], a[76:79], a[60:63], a[208:211]
ds_read_b64_tr_b16 a[76:77], v11 offset:4096
buffer_load_dwordx4 a[116:119], v21, s[56:59], s60 offen
v_lshl_add_u32 v49, v52, 7, v49
v_mfma_f32_16x16x32_bf16 a[124:127], a[84:87], a[32:35], a[124:127]
ds_read_b64_tr_b16 a[78:79], v11 offset:4608
buffer_load_dwordx4 a[120:123], v22, s[8:11], s61 offen
v_bfe_u32 v52, v19, 3, 1
v_mfma_f32_16x16x32_bf16 a[128:131], a[84:87], a[36:39], a[128:131]
s_add_u32 s39, s39, 128
v_mul_u32_u24 v52, 36864, v52
v_mfma_f32_16x16x32_bf16 a[132:135], a[84:87], a[40:43], a[132:135]
s_add_u32 s60, s60, 442368
v_mfma_f32_16x16x32_bf16 a[136:139], a[84:87], a[44:47], a[136:139]
s_cmp_eq_u32 s39, 1152
s_cselect_b32 s39, 1073741824, s39
v_add3_u32 v35, v49, v52, s45
v_mfma_f32_16x16x32_bf16 a[140:143], a[84:87], a[48:51], a[140:143]
s_add_u32 s61, s61, 320
v_lshlrev_b32 v48, 15, v48
v_mfma_f32_16x16x32_bf16 a[144:147], a[84:87], a[52:55], a[144:147]
s_lshl_b32 s44, s33, 2
v_mfma_f32_16x16x32_bf16 a[148:151], a[84:87], a[56:59], a[148:151]
s_xor_b32 s43, s43, 229376
s_add_u32 s44, s44, s32
v_mfma_f32_16x16x32_bf16 a[152:155], a[84:87], a[60:63], a[152:155]
ds_read_b64_tr_b16 a[84:85], v12 offset:4096
v_cndmask_b32 v48, v48, v50, vcc
v_mfma_f32_16x16x32_bf16 a[156:159], a[92:95], a[32:35], a[156:159]
ds_read_b64_tr_b16 a[86:87], v12 offset:4608
s_lshl_b32 s44, s44, 9
v_mfma_f32_16x16x32_bf16 a[160:163], a[92:95], a[36:39], a[160:163]
s_xor_b32 s3, s3, 229376
s_cmp_ge_u32 s61, 1152
s_cselect_b32 s61, 1073741824, s61
v_mfma_f32_16x16x32_bf16 a[164:167], a[92:95], a[40:43], a[164:167]
v_lshl_add_u32 v48, v51, 4, v48
v_add_u32 v36, s44, v48
v_mfma_f32_16x16x32_bf16 a[168:171], a[92:95], a[44:47], a[168:171]
v_mfma_f32_16x16x32_bf16 a[172:175], a[92:95], a[48:51], a[172:175]
v_mfma_f32_16x16x32_bf16 a[176:179], a[92:95], a[52:55], a[176:179]
v_mfma_f32_16x16x32_bf16 a[180:183], a[92:95], a[56:59], a[180:183]
v_mfma_f32_16x16x32_bf16 a[184:187], a[92:95], a[60:63], a[184:187]
s_waitcnt vmcnt(44)
v_readfirstlane_b32 s62, v33
s_nop 0
s_cmp_lg_u32 s62, 0
s_cbranch_scc0 L_nonce_l
L_nonce_l_r:
s_cmp_lg_u32 s63, 0
s_cbranch_scc1 L_not64
 buffer_load_dwordx2 a[228:229], v38, s[24:27], 0 offen offset:0
 buffer_load_dwordx2 a[230:231], v39, s[28:31], 0 offen offset:0
 buffer_load_dwordx2 a[232:233], v38, s[24:27], 0 offen offset:32
 buffer_load_dwordx2 a[234:235], v39, s[28:31], 0 offen offset:32
 buffer_load_dwordx2 a[236:237], v38, s[24:27], 0 offen offset:64
 buffer_load_dwordx2 a[238:239], v39, s[28:31], 0 offen offset:64
 buffer_load_dwordx2 a[240:241], v38, s[24:27], 0 offen offset:96
 buffer_load_dwordx2 a[242:243], v39, s[28:31], 0 offen offset:96
L_not64:
.p2align 6
L_g1_l:
s_waitcnt lgkmcnt(4)
v_mfma_f32_16x16x32_bf16 v[56:59], a[64:67], a[0:3], v[56:59]
ds_read_b64_tr_b16 a[92:93], v13 offset:4096
v_mfma_f32_16x16x32_bf16 v[60:63], a[64:67], a[4:7], v[60:63]
ds_read_b64_tr_b16 a[94:95], v13 offset:4608
v_mfma_f32_16x16x32_bf16 v[64:67], a[64:67], a[8:11], v[64:67]
s_mov_b32 m0, s49
v_mfma_f32_16x16x32_bf16 v[68:71], a[64:67], a[12:15], v[68:71]
v_mfma_f32_16x16x32_bf16 v[72:75], a[64:67], a[16:19], v[72:75]
v_mfma_f32_16x16x32_bf16 v[76:79], a[64:67], a[20:23], v[76:79]
buffer_load_dwordx4 v4, s[12:15], s37 offen lds
v_mfma_f32_16x16x32_bf16 v[80:83], a[64:67], a[24:27], v[80:83]
s_waitcnt vmcnt(14)
v_mfma_f32_16x16x32_bf16 v[84:87], a[64:67], a[28:31], v[84:87]
ds_read_b64_tr_b16 a[64:65], v10 offset:32768
v_mfma_f32_16x16x32_bf16 v[120:123], a[72:75], a[0:3], v[120:123]
ds_read_b64_tr_b16 a[66:67], v10 offset:33280
v_mfma_f32_16x16x32_bf16 v[124:127], a[72:75], a[4:7], v[124:127]
buffer_load_dwordx4 v5, s[12:15], s37 offen offset:1024 lds
v_mfma_f32_16x16x32_bf16 v[128:131], a[72:75], a[8:11], v[128:131]
ds_read_b128 a[32:35], v15 offset:0
v_mfma_f32_16x16x32_bf16 v[132:135], a[72:75], a[12:15], v[132:135]
v_mfma_f32_16x16x32_bf16 v[136:139], a[72:75], a[16:19], v[136:139]
v_mfma_f32_16x16x32_bf16 v[140:143], a[72:75], a[20:23], v[140:143]
buffer_load_dwordx4 v6, s[12:15], s37 offen offset:2048 lds
v_mfma_f32_16x16x32_bf16 v[144:147], a[72:75], a[24:27], v[144:147]
ds_read_b128 a[36:39], v15 offset:2048
v_mfma_f32_16x16x32_bf16 v[148:151], a[72:75], a[28:31], v[148:151]
ds_read_b64_tr_b16 a[72:73], v11 offset:32768
v_mfma_f32_16x16x32_bf16 v[160:163], a[80:83], a[0:3], v[160:163]
ds_read_b64_tr_b16 a[74:75], v11 offset:33280
v_mfma_f32_16x16x32_bf16 v[164:167], a[80:83], a[4:7], v[164:167]
buffer_load_dwordx4 v7, s[12:15], s37 offen offset:3072 lds
v_mfma_f32_16x16x32_bf16 v[168:171], a[80:83], a[8:11], v[168:171]
v_xor_b32 v15, 229440, v15
v_mfma_f32_16x16x32_bf16 v[172:175], a[80:83], a[12:15], v[172:175]
v_mfma_f32_16x16x32_bf16 v[176:179], a[80:83], a[16:19], v[176:179]
s_waitcnt lgkmcnt(6)
s_add_u32 m0, m0, 4096
v_mfma_f32_16x16x32_bf16 v[180:183], a[80:83], a[20:23], v[180:183]
v_mfma_f32_16x16x32_bf16 v[184:187], a[80:83], a[24:27], v[184:187]
v_mfma_f32_16x16x32_bf16 v[188:191], a[80:83], a[28:31], v[188:191]
ds_read_b64_tr_b16 a[80:81], v12 offset:32768
v_mfma_f32_16x16x32_bf16 v[192:195], a[88:91], a[0:3], v[192:195]
ds_read_b64_tr_b16 a[82:83], v12 offset:33280
v_mfma_f32_16x16x32_bf16 v[196:199], a[88:91], a[4:7], v[196:199]
ds_read_b128 a[40:43], v16 offset:0
v_mfma_f32_16x16x32_bf16 v[200:203], a[88:91], a[8:11], v[200:203]
buffer_load_dwordx4 v4, s[16:19], s37 offen lds
v_mfma_f32_16x16x32_bf16 v[204:207], a[88:91], a[12:15], v[204:207]
ds_read_b128 a[44:47], v16 offset:2048
v_mfma_f32_16x16x32_bf16 v[208:211], a[88:91], a[16:19], v[208:211]
buffer_load_dwordx4 v5, s[16:19], s37 offen offset:1024 lds
v_mfma_f32_16x16x32_bf16 v[212:215], a[88:91], a[20:23], v[212:215]
v_mfma_f32_16x16x32_bf16 v[216:219], a[88:91], a[24:27], v[216:219]
v_mfma_f32_16x16x32_bf16 v[220:223], a[88:91], a[28:31], v[220:223]
ds_read_b64_tr_b16 a[88:89], v13 offset:32768
v_mfma_f32_16x16x32_bf16 v[224:227], a[96:99], a[0:3], v[224:227]
ds_read_b64_tr_b16 a[90:91], v13 offset:33280
v_mfma_f32_16x16x32_bf16 v[228:231], a[96:99], a[4:7], v[228:231]
v_xor_b32 v16, 229440, v16
v_mfma_f32_16x16x32_bf16 v[232:235], a[96:99], a[8:11], v[232:235]
buffer_load_dwordx4 v6, s[16:19], s37 offen offset:2048 lds
v_mfma_f32_16x16x32_bf16 v[236:239], a[96:99], a[12:15], v[236:239]
buffer_load_dwordx4 v7, s[16:19], s37 offen offset:3072 lds
v_mfma_f32_16x16x32_bf16 v[240:243], a[96:99], a[16:19], v[240:243]
ds_read_b128 a[48:51], v17 offset:0
v_mfma_f32_16x16x32_bf16 v[244:247], a[96:99], a[20:23], v[244:247]
v_mfma_f32_16x16x32_bf16 v[248:251], a[96:99], a[24:27], v[248:251]
v_mfma_f32_16x16x32_bf16 v[252:255], a[96:99], a[28:31], v[252:255]
s_waitcnt vmcnt(12)
v_mfma_f32_16x16x32_bf16 a[212:215], a[244:247], a[100:103], a[212:215]
ds_read_b64_tr_b16 a[96:97], v14 offset:18432
v_mfma_f32_16x16x32_bf16 a[216:219], a[248:251], a[108:111], a[216:219]
ds_read_b64_tr_b16 a[98:99], v14 offset:18688
v_mfma_f32_16x16x32_bf16 a[220:223], a[108:111], a[108:111], a[220:223]
ds_read_b128 a[52:55], v17 offset:2048
v_mfma_f32_16x16x32_bf16 a[212:215], a[244:247], a[104:107], a[212:215]
s_waitcnt lgkmcnt(15)
v_mfma_f32_16x16x32_bf16 v[88:91], a[68:71], a[0:3], v[88:91]
s_add_u32 s37, s37, 294912
v_mfma_f32_16x16x32_bf16 v[92:95], a[68:71], a[4:7], v[92:95]
v_xor_b32 v17, 229440, v17
v_mfma_f32_16x16x32_bf16 v[96:99], a[68:71], a[8:11], v[96:99]
buffer_load_dwordx4 a[100:103], v20, s[56:59], s60 offen
v_mfma_f32_16x16x32_bf16 v[100:103], a[68:71], a[12:15], v[100:103]
buffer_load_dwordx4 a[104:107], v21, s[56:59], s60 offen
v_mfma_f32_16x16x32_bf16 v[104:107], a[68:71], a[16:19], v[104:107]
v_mfma_f32_16x16x32_bf16 v[108:111], a[68:71], a[20:23], v[108:111]
ds_read_b128 a[56:59], v18 offset:0
v_mfma_f32_16x16x32_bf16 v[112:115], a[68:71], a[24:27], v[112:115]
s_waitcnt vmcnt(19)
v_mfma_f32_16x16x32_bf16 v[116:119], a[68:71], a[28:31], v[116:119]
ds_read_b64_tr_b16 a[68:69], v10 offset:36864
v_mfma_f32_16x16x32_bf16 v[152:155], a[76:79], a[0:3], v[152:155]
ds_read_b64_tr_b16 a[70:71], v10 offset:37376
v_mfma_f32_16x16x32_bf16 v[156:159], a[76:79], a[4:7], v[156:159]
buffer_load_dwordx4 a[108:111], v22, s[8:11], s61 offen
v_mfma_f32_16x16x32_bf16 a[188:191], a[76:79], a[8:11], a[188:191]
ds_read_b128 a[60:63], v18 offset:2048
v_mfma_f32_16x16x32_bf16 a[192:195], a[76:79], a[12:15], a[192:195]
s_add_u32 s60, s60, 442368
v_mfma_f32_16x16x32_bf16 a[196:199], a[76:79], a[16:19], a[196:199]
s_add_u32 s61, s61, 64
v_mfma_f32_16x16x32_bf16 a[200:203], a[76:79], a[20:23], a[200:203]
v_mfma_f32_16x16x32_bf16 a[204:207], a[76:79], a[24:27], a[204:207]
v_xor_b32 v18, 229440, v18
v_mfma_f32_16x16x32_bf16 a[208:211], a[76:79], a[28:31], a[208:211]
ds_read_b64_tr_b16 a[76:77], v11 offset:36864
v_mfma_f32_16x16x32_bf16 a[124:127], a[84:87], a[0:3], a[124:127]
ds_read_b64_tr_b16 a[78:79], v11 offset:37376
v_mfma_f32_16x16x32_bf16 a[128:131], a[84:87], a[4:7], a[128:131]
s_cmp_ge_u32 s61, 1152
s_cselect_b32 s61, 1073741824, s61
v_mfma_f32_16x16x32_bf16 a[132:135], a[84:87], a[8:11], a[132:135]
v_mfma_f32_16x16x32_bf16 a[136:139], a[84:87], a[12:15], a[136:139]
v_mfma_f32_16x16x32_bf16 a[140:143], a[84:87], a[16:19], a[140:143]
v_mfma_f32_16x16x32_bf16 a[144:147], a[84:87], a[20:23], a[144:147]
v_mfma_f32_16x16x32_bf16 a[148:151], a[84:87], a[24:27], a[148:151]
v_mfma_f32_16x16x32_bf16 a[152:155], a[84:87], a[28:31], a[152:155]
ds_read_b64_tr_b16 a[84:85], v12 offset:36864
v_mfma_f32_16x16x32_bf16 a[156:159], a[92:95], a[0:3], a[156:159]
ds_read_b64_tr_b16 a[86:87], v12 offset:37376
v_mfma_f32_16x16x32_bf16 a[160:163], a[92:95], a[4:7], a[160:163]
v_mfma_f32_16x16x32_bf16 a[164:167], a[92:95], a[8:11], a[164:167]
v_mfma_f32_16x16x32_bf16 a[168:171], a[92:95], a[12:15], a[168:171]
v_mfma_f32_16x16x32_bf16 a[172:175], a[92:95], a[16:19], a[172:175]
v_mfma_f32_16x16x32_bf16 a[176:179], a[92:95], a[20:23], a[176:179]
v_mfma_f32_16x16x32_bf16 a[180:183], a[92:95], a[24:27], a[180:183]
v_mfma_f32_16x16x32_bf16 a[184:187], a[92:95], a[28:31], a[184:187]
s_waitcnt lgkmcnt(4)
v_mfma_f32_16x16x32_bf16 v[56:59], a[64:67], a[32:35], v[56:59]
ds_read_b64_tr_b16 a[92:93], v13 offset:36864
v_mfma_f32_16x16x32_bf16 v[60:63], a[64:67], a[36:39], v[60:63]
ds_read_b64_tr_b16 a[94:95], v13 offset:37376
v_mfma_f32_16x16x32_bf16 v[64:67], a[64:67], a[40:43], v[64:67]
s_mov_b32 m0, s50
v_mfma_f32_16x16x32_bf16 v[68:71], a[64:67], a[44:47], v[68:71]
v_mfma_f32_16x16x32_bf16 v[72:75], a[64:67], a[48:51], v[72:75]
buffer_load_dwordx4 v4, s[12:15], s37 offen lds
v_mfma_f32_16x16x32_bf16 v[76:79], a[64:67], a[52:55], v[76:79]
v_mfma_f32_16x16x32_bf16 v[80:83], a[64:67], a[56:59], v[80:83]
s_waitcnt vmcnt(8)
s_barrier
v_mfma_f32_16x16x32_bf16 v[84:87], a[64:67], a[60:63], v[84:87]
ds_read_b64_tr_b16 a[64:65], v10 offset:0
v_mfma_f32_16x16x32_bf16 v[120:123], a[72:75], a[32:35], v[120:123]
ds_read_b64_tr_b16 a[66:67], v10 offset:512
v_mfma_f32_16x16x32_bf16 v[124:127], a[72:75], a[36:39], v[124:127]
buffer_load_dwordx4 v5, s[12:15], s37 offen offset:1024 lds
v_mfma_f32_16x16x32_bf16 v[128:131], a[72:75], a[40:43], v[128:131]
ds_read_b128 a[0:3], v15 offset:0
v_mfma_f32_16x16x32_bf16 v[132:135], a[72:75], a[44:47], v[132:135]
buffer_load_dwordx4 v6, s[12:15], s37 offen offset:2048 lds
v_mfma_f32_16x16x32_bf16 v[136:139], a[72:75], a[48:51], v[136:139]
v_mfma_f32_16x16x32_bf16 v[140:143], a[72:75], a[52:55], v[140:143]
buffer_load_dwordx4 v7, s[12:15], s37 offen offset:3072 lds
v_mfma_f32_16x16x32_bf16 v[144:147], a[72:75], a[56:59], v[144:147]
ds_read_b128 a[4:7], v15 offset:2048
v_mfma_f32_16x16x32_bf16 v[148:151], a[72:75], a[60:63], v[148:151]
ds_read_b64_tr_b16 a[72:73], v11 offset:0
v_mfma_f32_16x16x32_bf16 v[160:163], a[80:83], a[32:35], v[160:163]
ds_read_b64_tr_b16 a[74:75], v11 offset:512
v_mfma_f32_16x16x32_bf16 v[164:167], a[80:83], a[36:39], v[164:167]
s_waitcnt lgkmcnt(6)
s_add_u32 m0, m0, 4096
v_mfma_f32_16x16x32_bf16 v[168:171], a[80:83], a[40:43], v[168:171]
v_xor_b32 v15, 64, v15
v_mfma_f32_16x16x32_bf16 v[172:175], a[80:83], a[44:47], v[172:175]
buffer_load_dwordx4 v4, s[16:19], s37 offen lds
v_mfma_f32_16x16x32_bf16 v[176:179], a[80:83], a[48:51], v[176:179]
v_mfma_f32_16x16x32_bf16 v[180:183], a[80:83], a[52:55], v[180:183]
buffer_load_dwordx4 v5, s[16:19], s37 offen offset:1024 lds
v_mfma_f32_16x16x32_bf16 v[184:187], a[80:83], a[56:59], v[184:187]
v_mfma_f32_16x16x32_bf16 v[188:191], a[80:83], a[60:63], v[188:191]
ds_read_b64_tr_b16 a[80:81], v12 offset:0
v_mfma_f32_16x16x32_bf16 v[192:195], a[88:91], a[32:35], v[192:195]
ds_read_b64_tr_b16 a[82:83], v12 offset:512
v_mfma_f32_16x16x32_bf16 v[196:199], a[88:91], a[36:39], v[196:199]
ds_read_b128 a[8:11], v16 offset:0
v_mfma_f32_16x16x32_bf16 v[200:203], a[88:91], a[40:43], v[200:203]
buffer_load_dwordx4 v6, s[16:19], s37 offen offset:2048 lds
v_mfma_f32_16x16x32_bf16 v[204:207], a[88:91], a[44:47], v[204:207]
ds_read_b128 a[12:15], v16 offset:2048
v_mfma_f32_16x16x32_bf16 v[208:211], a[88:91], a[48:51], v[208:211]
buffer_load_dwordx4 v7, s[16:19], s37 offen offset:3072 lds
v_mfma_f32_16x16x32_bf16 v[212:215], a[88:91], a[52:55], v[212:215]
v_mfma_f32_16x16x32_bf16 v[216:219], a[88:91], a[56:59], v[216:219]
s_add_u32 s37, s37, 294912
v_mfma_f32_16x16x32_bf16 v[220:223], a[88:91], a[60:63], v[220:223]
ds_read_b64_tr_b16 a[88:89], v13 offset:0
v_mfma_f32_16x16x32_bf16 v[224:227], a[96:99], a[32:35], v[224:227]
ds_read_b64_tr_b16 a[90:91], v13 offset:512
v_mfma_f32_16x16x32_bf16 v[228:231], a[96:99], a[36:39], v[228:231]
v_xor_b32 v14, 229376, v14
v_mfma_f32_16x16x32_bf16 v[232:235], a[96:99], a[40:43], v[232:235]
v_xor_b32 v16, 64, v16
v_mfma_f32_16x16x32_bf16 v[236:239], a[96:99], a[44:47], v[236:239]
s_mov_b32 m0, s43
v_mfma_f32_16x16x32_bf16 v[240:243], a[96:99], a[48:51], v[240:243]
ds_read_b128 a[16:19], v17 offset:0
v_mfma_f32_16x16x32_bf16 v[244:247], a[96:99], a[52:55], v[244:247]
buffer_load_dwordx4 v0, s[8:11], s39 offen lds
v_mfma_f32_16x16x32_bf16 v[248:251], a[96:99], a[56:59], v[248:251]
buffer_load_dwordx4 v1, s[8:11], s39 offen offset:1024 lds
v_mfma_f32_16x16x32_bf16 v[252:255], a[96:99], a[60:63], v[252:255]
s_waitcnt vmcnt(21)
v_mfma_f32_16x16x32_bf16 a[212:215], a[244:247], a[112:115], a[212:215]
ds_read_b64_tr_b16 a[96:97], v14 offset:16384
v_mfma_f32_16x16x32_bf16 a[216:219], a[248:251], a[120:123], a[216:219]
ds_read_b64_tr_b16 a[98:99], v14 offset:16640
v_mfma_f32_16x16x32_bf16 a[220:223], a[120:123], a[120:123], a[220:223]
ds_read_b128 a[20:23], v17 offset:2048
v_mfma_f32_16x16x32_bf16 a[212:215], a[244:247], a[116:119], a[212:215]
s_waitcnt lgkmcnt(15)
v_mfma_f32_16x16x32_bf16 v[88:91], a[68:71], a[32:35], v[88:91]
buffer_load_dwordx4 v2, s[8:11], s39 offen offset:2048 lds
v_mfma_f32_16x16x32_bf16 v[92:95], a[68:71], a[36:39], v[92:95]
v_xor_b32 v17, 64, v17
v_mfma_f32_16x16x32_bf16 v[96:99], a[68:71], a[40:43], v[96:99]
buffer_load_dwordx4 v3, s[8:11], s39 offen offset:3072 lds
v_mfma_f32_16x16x32_bf16 v[100:103], a[68:71], a[44:47], v[100:103]
s_mov_b32 m0, s3
v_mfma_f32_16x16x32_bf16 v[104:107], a[68:71], a[48:51], v[104:107]
buffer_load_dwordx4 a[112:115], v20, s[56:59], s60 offen
v_mfma_f32_16x16x32_bf16 v[108:111], a[68:71], a[52:55], v[108:111]
ds_read_b128 a[24:27], v18 offset:0
v_mfma_f32_16x16x32_bf16 v[112:115], a[68:71], a[56:59], v[112:115]
s_waitcnt vmcnt(16)
v_mfma_f32_16x16x32_bf16 v[116:119], a[68:71], a[60:63], v[116:119]
ds_read_b64_tr_b16 a[68:69], v10 offset:4096
v_mfma_f32_16x16x32_bf16 v[152:155], a[76:79], a[32:35], v[152:155]
ds_read_b64_tr_b16 a[70:71], v10 offset:4608
v_mfma_f32_16x16x32_bf16 v[156:159], a[76:79], a[36:39], v[156:159]
buffer_load_dwordx4 v8, s[12:15], s38 offen lds
v_mfma_f32_16x16x32_bf16 a[188:191], a[76:79], a[40:43], a[188:191]
ds_read_b128 a[28:31], v18 offset:2048
v_mfma_f32_16x16x32_bf16 a[192:195], a[76:79], a[44:47], a[192:195]
s_add_u32 m0, m0, 4096
v_mfma_f32_16x16x32_bf16 a[196:199], a[76:79], a[48:51], a[196:199]
buffer_load_dwordx4 v8, s[16:19], s38 offen lds
v_mfma_f32_16x16x32_bf16 a[200:203], a[76:79], a[52:55], a[200:203]
buffer_load_dwordx4 a[116:119], v21, s[56:59], s60 offen
v_mfma_f32_16x16x32_bf16 a[204:207], a[76:79], a[56:59], a[204:207]
v_xor_b32 v18, 64, v18
v_mfma_f32_16x16x32_bf16 a[208:211], a[76:79], a[60:63], a[208:211]
ds_read_b64_tr_b16 a[76:77], v11 offset:4096
v_mfma_f32_16x16x32_bf16 a[124:127], a[84:87], a[32:35], a[124:127]
ds_read_b64_tr_b16 a[78:79], v11 offset:4608
v_mfma_f32_16x16x32_bf16 a[128:131], a[84:87], a[36:39], a[128:131]
s_add_u32 s38, s38, 589824
v_mfma_f32_16x16x32_bf16 a[132:135], a[84:87], a[40:43], a[132:135]
s_add_u32 s39, s39, 128
v_mfma_f32_16x16x32_bf16 a[136:139], a[84:87], a[44:47], a[136:139]
s_cmp_eq_u32 s39, 1152
s_cselect_b32 s39, 1073741824, s39
v_mfma_f32_16x16x32_bf16 a[140:143], a[84:87], a[48:51], a[140:143]
buffer_load_dwordx4 a[120:123], v22, s[8:11], s61 offen
v_mfma_f32_16x16x32_bf16 a[144:147], a[84:87], a[52:55], a[144:147]
s_add_u32 s60, s60, 442368
v_mfma_f32_16x16x32_bf16 a[148:151], a[84:87], a[56:59], a[148:151]
s_xor_b32 s43, s43, 229376
v_mfma_f32_16x16x32_bf16 a[152:155], a[84:87], a[60:63], a[152:155]
ds_read_b64_tr_b16 a[84:85], v12 offset:4096
v_mfma_f32_16x16x32_bf16 a[156:159], a[92:95], a[32:35], a[156:159]
ds_read_b64_tr_b16 a[86:87], v12 offset:4608
v_mfma_f32_16x16x32_bf16 a[160:163], a[92:95], a[36:39], a[160:163]
s_xor_b32 s3, s3, 229376
v_mfma_f32_16x16x32_bf16 a[164:167], a[92:95], a[40:43], a[164:167]
s_add_u32 s61, s61, 320
v_mfma_f32_16x16x32_bf16 a[168:171], a[92:95], a[44:47], a[168:171]
s_cmp_ge_u32 s61, 1152
s_cselect_b32 s61, 1073741824, s61
v_mfma_f32_16x16x32_bf16 a[172:175], a[92:95], a[48:51], a[172:175]
v_mfma_f32_16x16x32_bf16 a[176:179], a[92:95], a[52:55], a[176:179]
v_mfma_f32_16x16x32_bf16 a[180:183], a[92:95], a[56:59], a[180:183]
v_mfma_f32_16x16x32_bf16 a[184:187], a[92:95], a[60:63], a[184:187]
s_cmp_eq_u32 s42, 2
s_cbranch_scc1 L_pub
L_pub_rl:
s_cmp_eq_u32 s42, s41
s_cbranch_scc1 L_midl
L_mid_rl:
s_sub_u32 s42, s42, 1
s_cbranch_scc0 L_g1_l
s_mov_b32 s37, 21233664
s_mov_b32 s38, 21270528
s_mov_b32 s39, 21463040
s_mov_b32 s42, 21577728
s_waitcnt lgkmcnt(4)
v_mfma_f32_16x16x32_bf16 v[56:59], a[64:67], a[0:3], v[56:59]
ds_read_b64_tr_b16 a[92:93], v13 offset:4096
v_mfma_f32_16x16x32_bf16 v[60:63], a[64:67], a[4:7], v[60:63]
ds_read_b64_tr_b16 a[94:95], v13 offset:4608
buffer_load_dwordx3 v[0:2], v36, s[20:23], s39 offen offset:0 sc1
v_mfma_f32_16x16x32_bf16 v[64:67], a[64:67], a[8:11], v[64:67]
buffer_load_dwordx3 v[4:6], v36, s[20:23], s39 offen offset:256 sc1
v_mfma_f32_16x16x32_bf16 v[68:71], a[64:67], a[12:15], v[68:71]
buffer_load_dwordx2 v[38:39], v34, s[20:23], s37 offen offset:0 sc1
v_mfma_f32_16x16x32_bf16 v[72:75], a[64:67], a[16:19], v[72:75]
buffer_load_dwordx2 v[40:41], v34, s[20:23], s38 offen offset:0 sc1
v_mfma_f32_16x16x32_bf16 v[76:79], a[64:67], a[20:23], v[76:79]
buffer_load_dwordx2 v[42:43], v34, s[20:23], s37 offen offset:128 sc1
v_mfma_f32_16x16x32_bf16 v[80:83], a[64:67], a[24:27], v[80:83]
s_waitcnt vmcnt(18)
buffer_load_dwordx2 v[44:45], v34, s[20:23], s38 offen offset:128 sc1
v_mfma_f32_16x16x32_bf16 v[84:87], a[64:67], a[28:31], v[84:87]
ds_read_b64_tr_b16 a[64:65], v10 offset:32768
buffer_load_dwordx2 v[46:47], v34, s[20:23], s37 offen offset:256 sc1
v_mfma_f32_16x16x32_bf16 v[120:123], a[72:75], a[0:3], v[120:123]
ds_read_b64_tr_b16 a[66:67], v10 offset:33280
buffer_load_dwordx2 v[48:49], v34, s[20:23], s38 offen offset:256 sc1
v_mfma_f32_16x16x32_bf16 v[124:127], a[72:75], a[4:7], v[124:127]
buffer_load_dwordx2 v[50:51], v34, s[20:23], s37 offen offset:384 sc1
v_mfma_f32_16x16x32_bf16 v[128:131], a[72:75], a[8:11], v[128:131]
ds_read_b128 a[32:35], v15 offset:0
buffer_load_dwordx2 v[8:9], v34, s[20:23], s38 offen offset:384 sc1
v_mfma_f32_16x16x32_bf16 v[132:135], a[72:75], a[12:15], v[132:135]
buffer_load_dwordx2 v[32:33], v35, s[20:23], s37 offen sc1
v_mfma_f32_16x16x32_bf16 v[136:139], a[72:75], a[16:19], v[136:139]
buffer_load_dword v23, v37, s[20:23], s42 offen sc1
v_mfma_f32_16x16x32_bf16 v[140:143], a[72:75], a[20:23], v[140:143]
v_mfma_f32_16x16x32_bf16 v[144:147], a[72:75], a[24:27], v[144:147]
ds_read_b128 a[36:39], v15 offset:2048
s_add_u32 m0, s49, 65536
v_mfma_f32_16x16x32_bf16 v[148:151], a[72:75], a[28:31], v[148:151]
ds_read_b64_tr_b16 a[72:73], v11 offset:32768
v_mfma_f32_16x16x32_bf16 v[160:163], a[80:83], a[0:3], v[160:163]
ds_read_b64_tr_b16 a[74:75], v11 offset:33280
v_mfma_f32_16x16x32_bf16 v[164:167], a[80:83], a[4:7], v[164:167]
v_mfma_f32_16x16x32_bf16 v[168:171], a[80:83], a[8:11], v[168:171]
v_xor_b32 v15, 229440, v15
v_mfma_f32_16x16x32_bf16 v[172:175], a[80:83], a[12:15], v[172:175]
buffer_load_dwordx4 v24, s[4:7], s66 offen lds
v_mfma_f32_16x16x32_bf16 v[176:179], a[80:83], a[16:19], v[176:179]
v_mov_b32 v20, 0
v_mfma_f32_16x16x32_bf16 v[180:183], a[80:83], a[20:23], v[180:183]
v_or_b32 v21, s32, v19
v_mfma_f32_16x16x32_bf16 v[184:187], a[80:83], a[24:27], v[184:187]
v_cmp_eq_u32 vcc, 0, v21
v_mfma_f32_16x16x32_bf16 v[188:191], a[80:83], a[28:31], v[188:191]
ds_read_b64_tr_b16 a[80:81], v12 offset:32768
v_mov_b32 v21, 1073741824
v_mfma_f32_16x16x32_bf16 v[192:195], a[88:91], a[0:3], v[192:195]
ds_read_b64_tr_b16 a[82:83], v12 offset:33280
buffer_load_dwordx4 v25, s[4:7], s66 offen offset:1024 lds
v_mfma_f32_16x16x32_bf16 v[196:199], a[88:91], a[4:7], v[196:199]
ds_read_b128 a[40:43], v16 offset:0
v_mov_b32 v53, 1.0
v_mfma_f32_16x16x32_bf16 v[200:203], a[88:91], a[8:11], v[200:203]
v_cndmask_b32 v21, v21, v20, vcc
v_mfma_f32_16x16x32_bf16 v[204:207], a[88:91], a[12:15], v[204:207]
ds_read_b128 a[44:47], v16 offset:2048
v_mfma_f32_16x16x32_bf16 v[208:211], a[88:91], a[16:19], v[208:211]
v_mfma_f32_16x16x32_bf16 v[212:215], a[88:91], a[20:23], v[212:215]
v_mfma_f32_16x16x32_bf16 v[216:219], a[88:91], a[24:27], v[216:219]
buffer_load_dwordx4 v26, s[4:7], s66 offen offset:2048 lds
v_mfma_f32_16x16x32_bf16 v[220:223], a[88:91], a[28:31], v[220:223]
ds_read_b64_tr_b16 a[88:89], v13 offset:32768
v_mfma_f32_16x16x32_bf16 v[224:227], a[96:99], a[0:3], v[224:227]
ds_read_b64_tr_b16 a[90:91], v13 offset:33280
v_mfma_f32_16x16x32_bf16 v[228:231], a[96:99], a[4:7], v[228:231]
v_xor_b32 v16, 229440, v16
v_mfma_f32_16x16x32_bf16 v[232:235], a[96:99], a[8:11], v[232:235]
v_mfma_f32_16x16x32_bf16 v[236:239], a[96:99], a[12:15], v[236:239]
buffer_load_dwordx4 v27, s[4:7], s66 offen offset:3072 lds
v_mfma_f32_16x16x32_bf16 v[240:243], a[96:99], a[16:19], v[240:243]
ds_read_b128 a[48:51], v17 offset:0
v_mfma_f32_16x16x32_bf16 v[244:247], a[96:99], a[20:23], v[244:247]
v_mfma_f32_16x16x32_bf16 v[248:251], a[96:99], a[24:27], v[248:251]
v_mfma_f32_16x16x32_bf16 v[252:255], a[96:99], a[28:31], v[252:255]
s_waitcnt lgkmcnt(13)
v_mfma_f32_16x16x32_bf16 v[88:91], a[68:71], a[0:3], v[88:91]
ds_read_b64_tr_b16 a[96:97], v14 offset:18432
v_mfma_f32_16x16x32_bf16 v[92:95], a[68:71], a[4:7], v[92:95]
ds_read_b64_tr_b16 a[98:99], v14 offset:18688
v_mfma_f32_16x16x32_bf16 v[96:99], a[68:71], a[8:11], v[96:99]
ds_read_b128 a[52:55], v17 offset:2048
v_mfma_f32_16x16x32_bf16 v[100:103], a[68:71], a[12:15], v[100:103]
s_add_u32 m0, m0, 4096
s_add_u32 s66, s66, 18432
v_mfma_f32_16x16x32_bf16 v[104:107], a[68:71], a[16:19], v[104:107]
v_mfma_f32_16x16x32_bf16 v[108:111], a[68:71], a[20:23], v[108:111]
v_xor_b32 v17, 229440, v17
v_mfma_f32_16x16x32_bf16 v[112:115], a[68:71], a[24:27], v[112:115]
s_waitcnt vmcnt(25)
buffer_load_dwordx4 v24, s[4:7], s66 offen lds
v_mfma_f32_16x16x32_bf16 v[116:119], a[68:71], a[28:31], v[116:119]
ds_read_b64_tr_b16 a[68:69], v10 offset:36864
v_mfma_f32_16x16x32_bf16 v[152:155], a[76:79], a[0:3], v[152:155]
ds_read_b64_tr_b16 a[70:71], v10 offset:37376
v_mfma_f32_16x16x32_bf16 v[156:159], a[76:79], a[4:7], v[156:159]
ds_read_b128 a[56:59], v18 offset:0
v_mfma_f32_16x16x32_bf16 a[188:191], a[76:79], a[8:11], a[188:191]
v_mfma_f32_16x16x32_bf16 a[192:195], a[76:79], a[12:15], a[192:195]
buffer_load_dwordx4 v25, s[4:7], s66 offen offset:1024 lds
v_mfma_f32_16x16x32_bf16 a[196:199], a[76:79], a[16:19], a[196:199]
v_mfma_f32_16x16x32_bf16 a[200:203], a[76:79], a[20:23], a[200:203]
v_mfma_f32_16x16x32_bf16 a[204:207], a[76:79], a[24:27], a[204:207]
ds_read_b128 a[60:63], v18 offset:2048
v_mfma_f32_16x16x32_bf16 a[208:211], a[76:79], a[28:31], a[208:211]
ds_read_b64_tr_b16 a[76:77], v11 offset:36864
v_mfma_f32_16x16x32_bf16 a[124:127], a[84:87], a[0:3], a[124:127]
ds_read_b64_tr_b16 a[78:79], v11 offset:37376
v_mfma_f32_16x16x32_bf16 a[128:131], a[84:87], a[4:7], a[128:131]
buffer_load_dwordx4 v26, s[4:7], s66 offen offset:2048 lds
v_mfma_f32_16x16x32_bf16 a[132:135], a[84:87], a[8:11], a[132:135]
v_xor_b32 v18, 229440, v18
s_waitcnt vmcnt(7)
v_mfma_f32_16x16x32_bf16 a[136:139], a[84:87], a[12:15], a[136:139]
v_bfe_i32 v52, v34, 30, 1
v_xor_b32 v23, s62, v23
v_mfma_f32_16x16x32_bf16 a[140:143], a[84:87], a[16:19], a[140:143]
v_bitop3_b32 v23, v23, v2, s62 bitop3:0xf6
v_mfma_f32_16x16x32_bf16 a[144:147], a[84:87], a[20:23], a[144:147]
v_bitop3_b32 v23, v23, v6, s62 bitop3:0xf6
v_bitop3_b32 v23, v23, v39, s62 bitop3:0xf6
v_mfma_f32_16x16x32_bf16 a[148:151], a[84:87], a[24:27], a[148:151]
buffer_load_dwordx4 v27, s[4:7], s66 offen offset:3072 lds
v_bitop3_b32 v23, v23, v41, s62 bitop3:0xf6
v_mfma_f32_16x16x32_bf16 a[152:155], a[84:87], a[28:31], a[152:155]
ds_read_b64_tr_b16 a[84:85], v12 offset:36864
v_bitop3_b32 v23, v23, v43, s62 bitop3:0xf6
v_bitop3_b32 v23, v23, v45, s62 bitop3:0xf6
v_mfma_f32_16x16x32_bf16 a[156:159], a[92:95], a[0:3], a[156:159]
ds_read_b64_tr_b16 a[86:87], v12 offset:37376
v_bitop3_b32 v23, v23, v47, s62 bitop3:0xf6
v_mfma_f32_16x16x32_bf16 a[160:163], a[92:95], a[4:7], a[160:163]
v_bitop3_b32 v23, v23, v49, s62 bitop3:0xf6
v_mfma_f32_16x16x32_bf16 a[164:167], a[92:95], a[8:11], a[164:167]
v_bitop3_b32 v23, v23, v51, s62 bitop3:0xf6
v_bitop3_b32 v23, v23, v9, s62 bitop3:0xf6
v_mfma_f32_16x16x32_bf16 a[168:171], a[92:95], a[12:15], a[168:171]
v_bitop3_b32 v23, v23, v33, s62 bitop3:0xf6
v_mfma_f32_16x16x32_bf16 a[172:175], a[92:95], a[16:19], a[172:175]
v_bfi_b32 v23, v52, 0, v23
v_cmp_ne_u32 vcc, 0, v23
v_mfma_f32_16x16x32_bf16 a[176:179], a[92:95], a[20:23], a[176:179]
v_mfma_f32_16x16x32_bf16 a[180:183], a[92:95], a[24:27], a[180:183]
v_mfma_f32_16x16x32_bf16 a[184:187], a[92:95], a[28:31], a[184:187]
s_cbranch_vccnz L_side_l
L_side_l_r:
v_mfma_f32_16x16x4_f32 a[108:111], v53, v0, 0
v_mfma_f32_16x16x4_f32 a[112:115], v53, v1, 0
v_mfma_f32_16x16x4_f32 a[116:119], v53, v4, 0
v_mfma_f32_16x16x4_f32 a[120:123], v53, v5, 0
s_waitcnt lgkmcnt(4)
v_mfma_f32_16x16x32_bf16 v[56:59], a[64:67], a[32:35], v[56:59]
ds_read_b64_tr_b16 a[92:93], v13 offset:36864
v_mfma_f32_16x16x32_bf16 v[60:63], a[64:67], a[36:39], v[60:63]
ds_read_b64_tr_b16 a[94:95], v13 offset:37376
v_mfma_f32_16x16x32_bf16 v[64:67], a[64:67], a[40:43], v[64:67]
s_mov_b32 s37, 0x3ae38e39
s_mov_b32 s38, 0x3727c5ac
v_mfma_f32_16x16x32_bf16 v[68:71], a[64:67], a[44:47], v[68:71]
v_and_b32 v15, 15, v19
s_lshl_b32 s39, s32, 9
v_mfma_f32_16x16x32_bf16 v[72:75], a[64:67], a[48:51], v[72:75]
s_add_u32 s39, s39, 151552
v_lshl_add_u32 v16, v15, 4, s39
v_mfma_f32_16x16x32_bf16 v[76:79], a[64:67], a[52:55], v[76:79]
s_lshl_b32 s39, s32, 7
s_add_u32 s39, s39, 153600
v_mfma_f32_16x16x32_bf16 v[80:83], a[64:67], a[56:59], v[80:83]
v_lshl_add_u32 v17, v15, 2, s39
v_accvgpr_read_b32 v0, a108
v_mfma_f32_16x16x32_bf16 v[84:87], a[64:67], a[60:63], v[84:87]
v_accvgpr_read_b32 v1, a112
v_mfma_f32_16x16x32_bf16 v[120:123], a[72:75], a[32:35], v[120:123]
v_accvgpr_read_b32 v4, a116
v_accvgpr_read_b32 v5, a120
v_mfma_f32_16x16x32_bf16 v[124:127], a[72:75], a[36:39], v[124:127]
s_waitcnt vmcnt(22) lgkmcnt(0)
s_barrier
v_mfma_f32_16x16x32_bf16 v[128:131], a[72:75], a[40:43], v[128:131]
v_mul_f32 v0, s37, v0
v_mul_f32 v4, s37, v4
s_mov_b32 s50, 77824
v_mfma_f32_16x16x32_bf16 v[132:135], a[72:75], a[44:47], v[132:135]
v_mul_f32 v1, s37, v1
v_mul_f32 v5, s37, v5
v_mfma_f32_16x16x32_bf16 v[136:139], a[72:75], a[48:51], v[136:139]
v_fma_f32 v1, -v0, v0, v1
v_fma_f32 v5, -v4, v4, v5
v_mfma_f32_16x16x32_bf16 v[140:143], a[72:75], a[52:55], v[140:143]
v_max_f32 v1, 0, v1
v_max_f32 v5, 0, v5
v_mfma_f32_16x16x32_bf16 v[144:147], a[72:75], a[56:59], v[144:147]
v_cvt_pk_bf16_f32 v1, v1, v1
v_cvt_pk_bf16_f32 v5, v5, v5
v_mfma_f32_16x16x32_bf16 v[148:151], a[72:75], a[60:63], v[148:151]
v_cvt_pk_bf16_f32 v0, -v0, -v0
v_cvt_pk_bf16_f32 v4, -v4, -v4
s_mul_i32 s46, s32, 10
s_lshl_b32 s47, s32, 3
v_mfma_f32_16x16x32_bf16 v[160:163], a[80:83], a[32:35], v[160:163]
v_lshlrev_b32 v1, 16, v1
v_lshlrev_b32 v5, 16, v5
v_mfma_f32_16x16x32_bf16 v[164:167], a[80:83], a[36:39], v[164:167]
v_add_f32 v1, s38, v1
v_add_f32 v5, s38, v5
v_mfma_f32_16x16x32_bf16 v[168:171], a[80:83], a[40:43], v[168:171]
v_cvt_pk_bf16_f32 v1, v1, v1
v_cvt_pk_bf16_f32 v5, v5, v5
v_mfma_f32_16x16x32_bf16 v[172:175], a[80:83], a[44:47], v[172:175]
v_lshlrev_b32 v1, 16, v1
v_lshlrev_b32 v5, 16, v5
s_add_u32 s47, s47, 4
s_min_u32 s46, s46, s47
v_mfma_f32_16x16x32_bf16 v[176:179], a[80:83], a[48:51], v[176:179]
v_sqrt_f32 v1, v1
v_sqrt_f32 v5, v5
v_mfma_f32_16x16x32_bf16 v[180:183], a[80:83], a[52:55], v[180:183]
v_cvt_pk_bf16_f32 v1, v1, v1
v_cvt_pk_bf16_f32 v5, v5, v5
v_mfma_f32_16x16x32_bf16 v[184:187], a[80:83], a[56:59], v[184:187]
v_lshlrev_b32 v1, 16, v1
v_lshlrev_b32 v5, 16, v5
v_mfma_f32_16x16x32_bf16 v[188:191], a[80:83], a[60:63], v[188:191]
v_rcp_f32 v1, v1
s_lshl_b32 s47, s46, 10
s_mul_i32 s46, s46, 9216
v_mfma_f32_16x16x32_bf16 v[192:195], a[88:91], a[32:35], v[192:195]
v_rcp_f32 v5, v5
ds_write2_b32 v16, v0, v20 offset0:0 offset1:1
v_mfma_f32_16x16x32_bf16 v[196:199], a[88:91], a[36:39], v[196:199]
ds_write2_b32 v16, v20, v0 offset0:2 offset1:3
ds_write2_b32 v16, v4, v20 offset0:64 offset1:65
v_mfma_f32_16x16x32_bf16 v[200:203], a[88:91], a[40:43], v[200:203]
ds_write2_b32 v16, v20, v4 offset0:66 offset1:67
ds_write2_b32 v17, v1, v5 offset0:0 offset1:16
v_mfma_f32_16x16x32_bf16 v[204:207], a[88:91], a[44:47], v[204:207]
v_mul_f32 v33, v1, v1
v_mul_f32 v22, v5, v5
s_cmp_lt_u32 s32, 2
s_cselect_b32 s45, 131072, s50
s_cselect_b32 s50, 0, 1073741824
v_mfma_f32_16x16x32_bf16 v[208:211], a[88:91], a[48:51], v[208:211]
s_add_u32 m0, s47, s45
s_add_u32 s46, s46, s51
v_mfma_f32_16x16x32_bf16 v[212:215], a[88:91], a[52:55], v[212:215]
buffer_load_dwordx4 v28, s[4:7], s46 offen lds
v_cvt_pk_bf16_f32 v52, v38, v38
v_mfma_f32_16x16x32_bf16 v[216:219], a[88:91], a[56:59], v[216:219]
s_add_u32 s46, s46, 8192
v_lshlrev_b32 v52, 16, v52
v_mfma_f32_16x16x32_bf16 v[220:223], a[88:91], a[60:63], v[220:223]
s_nop 0
s_waitcnt lgkmcnt(0)
s_barrier
v_mfma_f32_16x16x32_bf16 v[224:227], a[96:99], a[32:35], v[224:227]
v_xor_b32 v18, 0, v16
ds_read_b128 a[0:3], v18 offset:0
buffer_load_dwordx4 v28, s[4:7], s46 offen offset:1024 lds
v_mfma_f32_16x16x32_bf16 v[228:231], a[96:99], a[36:39], v[228:231]
ds_read_b128 a[4:7], v18 offset:256
s_add_u32 s46, s46, 8192
v_mfma_f32_16x16x32_bf16 v[232:235], a[96:99], a[40:43], v[232:235]
v_xor_b32 v18, 512, v16
ds_read_b128 a[8:11], v18 offset:0
buffer_load_dwordx4 v28, s[4:7], s46 offen offset:2048 lds
v_mfma_f32_16x16x32_bf16 v[236:239], a[96:99], a[44:47], v[236:239]
ds_read_b128 a[12:15], v18 offset:256
s_add_u32 s46, s46, 8192
v_mfma_f32_16x16x32_bf16 v[240:243], a[96:99], a[48:51], v[240:243]
v_xor_b32 v18, 1024, v16
ds_read_b128 a[16:19], v18 offset:0
buffer_load_dwordx4 v28, s[4:7], s46 offen offset:3072 lds
v_mfma_f32_16x16x32_bf16 v[244:247], a[96:99], a[52:55], v[244:247]
ds_read_b128 a[20:23], v18 offset:256
v_sub_f32 v52, v38, v52
v_mfma_f32_16x16x32_bf16 v[248:251], a[96:99], a[56:59], v[248:251]
v_xor_b32 v18, 1536, v16
s_add_u32 m0, m0, 4096
s_add_u32 s46, s46, 12288
v_mfma_f32_16x16x32_bf16 v[252:255], a[96:99], a[60:63], v[252:255]
ds_read_b128 a[24:27], v18 offset:0
ds_read_b128 a[28:31], v18 offset:256
v_mfma_f32_16x16x32_bf16 v[88:91], a[68:71], a[32:35], v[88:91]
buffer_load_dwordx4 v28, s[4:7], s46 offen lds
v_cvt_pk_bf16_f32 v38, v38, v52
v_mfma_f32_16x16x32_bf16 v[92:95], a[68:71], a[36:39], v[92:95]
v_cvt_pk_bf16_f32 v52, v40, v40
v_lshlrev_b32 v52, 16, v52
v_mfma_f32_16x16x32_bf16 v[96:99], a[68:71], a[40:43], v[96:99]
v_sub_f32 v52, v40, v52
v_cvt_pk_bf16_f32 v39, v40, v52
v_mfma_f32_16x16x32_bf16 v[100:103], a[68:71], a[44:47], v[100:103]
s_add_u32 s46, s46, 8192
v_cvt_pk_bf16_f32 v52, v42, v42
v_mfma_f32_16x16x32_bf16 v[104:107], a[68:71], a[48:51], v[104:107]
v_lshlrev_b32 v52, 16, v52
v_sub_f32 v52, v42, v52
v_mfma_f32_16x16x32_bf16 v[108:111], a[68:71], a[52:55], v[108:111]
buffer_load_dwordx4 v28, s[4:7], s46 offen offset:1024 lds
v_cvt_pk_bf16_f32 v40, v42, v52
v_mfma_f32_16x16x32_bf16 v[112:115], a[68:71], a[56:59], v[112:115]
v_cvt_pk_bf16_f32 v52, v44, v44
v_lshlrev_b32 v52, 16, v52
v_mfma_f32_16x16x32_bf16 v[116:119], a[68:71], a[60:63], v[116:119]
s_add_u32 s46, s46, 8192
v_sub_f32 v52, v44, v52
v_mfma_f32_16x16x32_bf16 v[152:155], a[76:79], a[32:35], v[152:155]
v_cvt_pk_bf16_f32 v41, v44, v52
v_cvt_pk_bf16_f32 v52, v46, v46
v_mfma_f32_16x16x32_bf16 v[156:159], a[76:79], a[36:39], v[156:159]
buffer_load_dwordx4 v28, s[4:7], s46 offen offset:2048 lds
v_lshlrev_b32 v52, 16, v52
v_mfma_f32_16x16x32_bf16 a[188:191], a[76:79], a[40:43], a[188:191]
v_sub_f32 v52, v46, v52
v_cvt_pk_bf16_f32 v42, v46, v52
v_mfma_f32_16x16x32_bf16 a[192:195], a[76:79], a[44:47], a[192:195]
s_add_u32 s46, s46, 8192
v_cvt_pk_bf16_f32 v52, v48, v48
v_mfma_f32_16x16x32_bf16 a[196:199], a[76:79], a[48:51], a[196:199]
v_lshlrev_b32 v52, 16, v52
v_sub_f32 v52, v48, v52
v_mfma_f32_16x16x32_bf16 a[200:203], a[76:79], a[52:55], a[200:203]
v_cvt_pk_bf16_f32 v43, v48, v52
v_cvt_pk_bf16_f32 v52, v50, v50
v_mfma_f32_16x16x32_bf16 a[204:207], a[76:79], a[56:59], a[204:207]
buffer_load_dwordx4 v28, s[4:7], s46 offen offset:3072 lds
v_lshlrev_b32 v52, 16, v52
v_mfma_f32_16x16x32_bf16 a[208:211], a[76:79], a[60:63], a[208:211]
v_sub_f32 v52, v50, v52
v_cvt_pk_bf16_f32 v44, v50, v52
v_mfma_f32_16x16x32_bf16 a[124:127], a[84:87], a[32:35], a[124:127]
s_add_u32 s46, s46, 12288
s_add_u32 m0, m0, 4096
v_mfma_f32_16x16x32_bf16 a[128:131], a[84:87], a[36:39], a[128:131]
v_cvt_pk_bf16_f32 v52, v8, v8
v_lshlrev_b32 v52, 16, v52
v_mfma_f32_16x16x32_bf16 a[132:135], a[84:87], a[40:43], a[132:135]
s_lshr_b32 s47, s50, 13
s_or_b32 m0, m0, s47
v_mfma_f32_16x16x32_bf16 a[136:139], a[84:87], a[44:47], a[136:139]
v_sub_f32 v52, v8, v52
v_cvt_pk_bf16_f32 v45, v8, v52
v_mfma_f32_16x16x32_bf16 a[140:143], a[84:87], a[48:51], a[140:143]
s_or_b32 s46, s46, s50
v_cvt_pk_bf16_f32 v52, v32, v32
v_mfma_f32_16x16x32_bf16 a[144:147], a[84:87], a[52:55], a[144:147]
v_lshlrev_b32 v52, 16, v52
v_sub_f32 v52, v32, v52
v_mfma_f32_16x16x32_bf16 a[148:151], a[84:87], a[56:59], a[148:151]
buffer_load_dwordx4 v28, s[4:7], s46 offen lds
v_cvt_pk_bf16_f32 v46, v32, v52
v_mfma_f32_16x16x32_bf16 a[152:155], a[84:87], a[60:63], a[152:155]
v_mov_b32 v47, 0
v_mfma_f32_16x16x32_bf16 a[156:159], a[92:95], a[32:35], a[156:159]
s_mul_i32 s3, s33, 144
s_mul_i32 s42, s34, 9
s_add_u32 s3, s3, s42
v_mfma_f32_16x16x32_bf16 a[160:163], a[92:95], a[36:39], a[160:163]
s_add_u32 s46, s46, 8192
s_lshl_b32 s3, s3, 13
s_and_b32 s42, s34, 1
v_mfma_f32_16x16x32_bf16 a[164:167], a[92:95], a[40:43], a[164:167]
s_lshl_b32 s40, s42, 13
s_lshl_b32 s41, s32, 14
s_add_u32 s40, s40, s41
v_mfma_f32_16x16x32_bf16 a[168:171], a[92:95], a[44:47], a[168:171]
buffer_load_dwordx4 v28, s[4:7], s46 offen offset:1024 lds
s_add_u32 s41, s40, 8192
s_add_u32 s37, s3, s40
v_mfma_f32_16x16x32_bf16 a[172:175], a[92:95], a[48:51], a[172:175]
s_add_u32 s38, s3, s41
s_xor_b32 s42, s42, 1
s_mul_i32 s43, s42, 114688
v_mfma_f32_16x16x32_bf16 a[176:179], a[92:95], a[52:55], a[176:179]
s_lshl_b32 s42, s42, 16
s_add_u32 s39, s3, s42
v_mfma_f32_16x16x32_bf16 a[180:183], a[92:95], a[56:59], a[180:183]
s_cmp_eq_u32 s41, 0x10000
s_cselect_b32 s41, 114688, s41
s_lshl_b32 s3, s32, 11
v_mfma_f32_16x16x32_bf16 a[184:187], a[92:95], a[60:63], a[184:187]
v_lshl_add_u32 v4, v19, 4, s3
v_xor_b32 v5, 0x800, v4
v_xor_b32 v6, 0x1000, v4
v_xor_b32 v7, 0x1800, v4
v_mov_b32 v11, v4
v_lshrrev_b32 v53, 5, v19
v_and_b32 v52, 15, v19
v_lshlrev_b32 v52, 4, v52
v_lshl_add_u32 v52, v53, 10, v52
v_bfe_u32 v53, v19, 4, 1
v_xor_b32 v53, s32, v53
v_lshl_add_u32 v52, v53, 11, v52
s_lshl_b32 s42, s32, 8
v_add_u32 v15, s42, v52
v_xor_b32 v16, 0x1000, v15
s_lshl_b32 s3, s33, 2
s_add_u32 s3, s3, s32
s_mul_i32 s3, s3, 1152
s_lshl_b32 s42, s36, 8
s_add_u32 s42, s42, s3
v_and_b32 v52, 15, v19
v_mul_u32_u24 v52, 73728, v52
v_lshrrev_b32 v53, 4, v19
v_lshl_add_u32 v34, v53, 3, v52
v_add_u32 v34, s42, v34
s_lshl_b32 s42, s35, 6
v_add_u32 v34, s42, v34
s_lshl_b32 s42, s34, 3
s_add_u32 s3, s3, s42
s_add_u32 s3, s3, 1024
v_and_b32 v53, 1, v53
v_lshl_add_u32 v52, v53, 2, v52
v_lshrrev_b32 v53, 5, v19
v_mul_u32_u24 v53, 1179648, v53
v_add3_u32 v35, v52, v53, s3
s_mov_b32 s51, 1179648
buffer_load_dwordx2 a[96:97], v34, s[8:11], 0 offen offset:0
buffer_load_dwordx2 a[98:99], v34, s[8:11], s51 offen offset:0
buffer_load_dwordx2 a[252:253], v34, s[8:11], 0 offen offset:32
buffer_load_dwordx2 a[254:255], v34, s[8:11], s51 offen offset:32
buffer_load_dword v2, v35, s[8:11], 0 offen
s_waitcnt lgkmcnt(0)
v_mfma_f32_16x16x16_bf16 v[56:59], v[38:39], a[0:1], v[56:59]
v_mfma_f32_16x16x16_bf16 v[88:91], v[38:39], a[2:3], v[88:91]
v_mfma_f32_16x16x16_bf16 v[120:123], v[40:41], a[0:1], v[120:123]
v_mfma_f32_16x16x16_bf16 v[152:155], v[40:41], a[2:3], v[152:155]
v_mfma_f32_16x16x16_bf16 v[60:63], v[38:39], a[4:5], v[60:63]
v_mfma_f32_16x16x16_bf16 v[92:95], v[38:39], a[6:7], v[92:95]
v_mfma_f32_16x16x16_bf16 v[124:127], v[40:41], a[4:5], v[124:127]
v_mfma_f32_16x16x16_bf16 v[156:159], v[40:41], a[6:7], v[156:159]
s_nop 4
v_max_f32 v56, 0, v56
v_add_u32 v52, s40, v4
v_max_f32 v57, 0, v57
v_max_f32 v58, 0, v58
v_mfma_f32_16x16x16_bf16 v[64:67], v[38:39], a[8:9], v[64:67]
v_max_f32 v59, 0, v59
v_mul_f32 v56, v56, v88
v_mul_f32 v57, v57, v89
v_mul_f32 v58, v58, v90
v_mfma_f32_16x16x16_bf16 v[96:99], v[38:39], a[10:11], v[96:99]
v_mul_f32 v59, v59, v91
v_cvt_pk_bf16_f32 v56, v56, v57
v_cvt_pk_bf16_f32 v57, v58, v59
v_max_f32 v120, 0, v120
v_mfma_f32_16x16x16_bf16 v[128:131], v[40:41], a[8:9], v[128:131]
v_max_f32 v121, 0, v121
v_max_f32 v122, 0, v122
v_max_f32 v123, 0, v123
v_mul_f32 v120, v120, v152
v_mfma_f32_16x16x16_bf16 a[188:191], v[40:41], a[10:11], a[188:191]
v_mul_f32 v121, v121, v153
v_mul_f32 v122, v122, v154
v_mul_f32 v123, v123, v155
v_cvt_pk_bf16_f32 v58, v120, v121
v_cvt_pk_bf16_f32 v59, v122, v123
buffer_store_dwordx4 v[56:59], v4, s[20:23], s37 offen sc1
ds_write_b128 v52, v[56:59] offset:0
v_max_f32 v60, 0, v60
v_max_f32 v61, 0, v61
v_max_f32 v62, 0, v62
v_max_f32 v63, 0, v63
v_mfma_f32_16x16x16_bf16 v[68:71], v[38:39], a[12:13], v[68:71]
v_mul_f32 v60, v60, v92
v_mul_f32 v61, v61, v93
v_mul_f32 v62, v62, v94
v_mul_f32 v63, v63, v95
v_mfma_f32_16x16x16_bf16 v[100:103], v[38:39], a[14:15], v[100:103]
v_cvt_pk_bf16_f32 v60, v60, v61
v_cvt_pk_bf16_f32 v61, v62, v63
v_max_f32 v124, 0, v124
v_max_f32 v125, 0, v125
v_mfma_f32_16x16x16_bf16 v[132:135], v[40:41], a[12:13], v[132:135]
v_max_f32 v126, 0, v126
v_max_f32 v127, 0, v127
v_mul_f32 v124, v124, v156
v_mul_f32 v125, v125, v157
v_mfma_f32_16x16x16_bf16 a[192:195], v[40:41], a[14:15], a[192:195]
v_mul_f32 v126, v126, v158
v_mul_f32 v127, v127, v159
v_cvt_pk_bf16_f32 v62, v124, v125
v_cvt_pk_bf16_f32 v63, v126, v127
buffer_store_dwordx4 v[60:63], v4, s[20:23], s37 offen offset:1024 sc1
ds_write_b128 v52, v[60:63] offset:1024
v_max_f32 v64, 0, v64
v_add_u32 v52, s40, v5
v_max_f32 v65, 0, v65
v_max_f32 v66, 0, v66
v_max_f32 v67, 0, v67
v_mfma_f32_16x16x16_bf16 v[72:75], v[38:39], a[16:17], v[72:75]
v_mul_f32 v64, v64, v96
v_mul_f32 v65, v65, v97
v_mul_f32 v66, v66, v98
v_mul_f32 v67, v67, v99
v_cvt_pk_bf16_f32 v64, v64, v65
v_mfma_f32_16x16x16_bf16 v[104:107], v[38:39], a[18:19], v[104:107]
v_cvt_pk_bf16_f32 v65, v66, v67
v_max_f32 v128, 0, v128
v_max_f32 v129, 0, v129
v_max_f32 v130, 0, v130
v_max_f32 v131, 0, v131
v_mfma_f32_16x16x16_bf16 v[136:139], v[40:41], a[16:17], v[136:139]
v_accvgpr_read_b32 v48, a188
v_accvgpr_read_b32 v49, a189
v_accvgpr_read_b32 v50, a190
v_accvgpr_read_b32 v51, a191
v_mul_f32 v128, v128, v48
v_mfma_f32_16x16x16_bf16 a[196:199], v[40:41], a[18:19], a[196:199]
v_mul_f32 v129, v129, v49
v_mul_f32 v130, v130, v50
v_mul_f32 v131, v131, v51
v_cvt_pk_bf16_f32 v66, v128, v129
v_cvt_pk_bf16_f32 v67, v130, v131
buffer_store_dwordx4 v[64:67], v5, s[20:23], s37 offen sc1
ds_write_b128 v52, v[64:67] offset:0
v_max_f32 v68, 0, v68
v_max_f32 v69, 0, v69
v_max_f32 v70, 0, v70
v_max_f32 v71, 0, v71
v_mul_f32 v68, v68, v100
v_mfma_f32_16x16x16_bf16 v[76:79], v[38:39], a[20:21], v[76:79]
v_mul_f32 v69, v69, v101
v_mul_f32 v70, v70, v102
v_mul_f32 v71, v71, v103
v_cvt_pk_bf16_f32 v68, v68, v69
v_cvt_pk_bf16_f32 v69, v70, v71
v_mfma_f32_16x16x16_bf16 v[108:111], v[38:39], a[22:23], v[108:111]
v_max_f32 v132, 0, v132
v_max_f32 v133, 0, v133
v_max_f32 v134, 0, v134
v_max_f32 v135, 0, v135
v_accvgpr_read_b32 v48, a192
v_mfma_f32_16x16x16_bf16 v[140:143], v[40:41], a[20:21], v[140:143]
v_accvgpr_read_b32 v49, a193
v_accvgpr_read_b32 v50, a194
v_accvgpr_read_b32 v51, a195
v_mul_f32 v132, v132, v48
v_mul_f32 v133, v133, v49
v_mfma_f32_16x16x16_bf16 a[200:203], v[40:41], a[22:23], a[200:203]
v_mul_f32 v134, v134, v50
v_mul_f32 v135, v135, v51
v_cvt_pk_bf16_f32 v70, v132, v133
v_cvt_pk_bf16_f32 v71, v134, v135
buffer_store_dwordx4 v[68:71], v5, s[20:23], s37 offen offset:1024 sc1
ds_write_b128 v52, v[68:71] offset:1024
s_mul_i32 s44, s33, 144
s_mul_i32 s45, s35, 36
s_add_u32 s44, s44, s45
s_and_b32 s46, s2, 0xe7
s_lshl_b32 s46, s46, 7
s_add_u32 s46, s46, 21594112
s_bfe_u32 s45, s75, 131072
s_lshl_b32 s47, s45, 10
s_add_u32 s90, s47, s46
s_bfe_u32 s45, s75, 131080
s_lshl_b32 s47, s45, 10
s_add_u32 s91, s47, s46
s_mul_i32 s45, s45, 9
s_add_u32 s45, s45, s44
s_lshl_b32 s61, s45, 13
s_bfe_u32 s45, s75, 131088
s_lshl_b32 s47, s45, 10
s_add_u32 s92, s47, s46
s_mul_i32 s45, s45, 9
s_add_u32 s45, s45, s44
s_lshl_b32 s63, s45, 13
s_bfe_u32 s45, s75, 131096
s_lshl_b32 s47, s45, 10
s_add_u32 s93, s47, s46
s_mul_i32 s45, s45, 9
s_add_u32 s45, s45, s44
s_lshl_b32 s101, s45, 13
s_lshl_b32 s82, s65, 13
s_add_u32 s83, s82, 8192
v_max_f32 v72, 0, v72
v_add_u32 v52, s40, v6
v_max_f32 v73, 0, v73
v_max_f32 v74, 0, v74
v_max_f32 v75, 0, v75
v_mfma_f32_16x16x16_bf16 v[80:83], v[38:39], a[24:25], v[80:83]
v_mul_f32 v72, v72, v104
v_mul_f32 v73, v73, v105
v_mul_f32 v74, v74, v106
v_mul_f32 v75, v75, v107
v_cvt_pk_bf16_f32 v72, v72, v73
v_mfma_f32_16x16x16_bf16 v[112:115], v[38:39], a[26:27], v[112:115]
v_cvt_pk_bf16_f32 v73, v74, v75
v_max_f32 v136, 0, v136
v_max_f32 v137, 0, v137
v_max_f32 v138, 0, v138
v_max_f32 v139, 0, v139
v_mfma_f32_16x16x16_bf16 v[144:147], v[40:41], a[24:25], v[144:147]
v_accvgpr_read_b32 v48, a196
v_accvgpr_read_b32 v49, a197
v_accvgpr_read_b32 v50, a198
v_accvgpr_read_b32 v51, a199
v_mul_f32 v136, v136, v48
v_mfma_f32_16x16x16_bf16 a[204:207], v[40:41], a[26:27], a[204:207]
v_mul_f32 v137, v137, v49
v_mul_f32 v138, v138, v50
v_mul_f32 v139, v139, v51
v_cvt_pk_bf16_f32 v74, v136, v137
v_cvt_pk_bf16_f32 v75, v138, v139
buffer_store_dwordx4 v[72:75], v6, s[20:23], s37 offen sc1
ds_write_b128 v52, v[72:75] offset:0
s_cmp_eq_u32 s83, 73728
s_cselect_b32 s83, 0, s83
s_add_u32 s84, s83, 8192
s_cmp_eq_u32 s84, 73728
s_cselect_b32 s84, 0, s84
s_add_u32 s86, s84, 8192
s_cmp_eq_u32 s86, 73728
s_cselect_b32 s86, 0, s86
s_add_u32 s87, s86, 8192
s_cmp_eq_u32 s87, 73728
s_cselect_b32 s87, 0, s87
s_add_u32 s88, s87, 8192
s_cmp_eq_u32 s88, 73728
s_cselect_b32 s88, 0, s88
s_add_u32 s89, s88, 8192
s_cmp_eq_u32 s89, 73728
s_cselect_b32 s89, 0, s89
s_add_u32 s64, s89, 8192
s_cmp_eq_u32 s64, 73728
s_cselect_b32 s64, 0, s64
s_add_u32 s50, s64, 8192
s_cmp_eq_u32 s50, 73728
s_cselect_b32 s50, 0, s50
v_lshrrev_b32 v120, 4, v19
v_and_b32 v121, 15, v19
s_lshl_b32 s44, s33, 2
s_add_u32 s44, s44, s32
s_and_b32 s45, s44, 31
s_lshr_b32 s46, s33, 3
s_lshl_b32 s42, s36, 7
v_max_f32 v76, 0, v76
v_max_f32 v77, 0, v77
v_max_f32 v78, 0, v78
v_max_f32 v79, 0, v79
v_mul_f32 v76, v76, v108
v_mfma_f32_16x16x16_bf16 v[84:87], v[38:39], a[28:29], v[84:87]
v_mul_f32 v77, v77, v109
v_mul_f32 v78, v78, v110
v_mul_f32 v79, v79, v111
v_cvt_pk_bf16_f32 v76, v76, v77
v_cvt_pk_bf16_f32 v77, v78, v79
v_mfma_f32_16x16x16_bf16 v[116:119], v[38:39], a[30:31], v[116:119]
v_max_f32 v140, 0, v140
v_max_f32 v141, 0, v141
v_max_f32 v142, 0, v142
v_max_f32 v143, 0, v143
v_accvgpr_read_b32 v48, a200
v_mfma_f32_16x16x16_bf16 v[148:151], v[40:41], a[28:29], v[148:151]
v_accvgpr_read_b32 v49, a201
v_accvgpr_read_b32 v50, a202
v_accvgpr_read_b32 v51, a203
v_mul_f32 v140, v140, v48
v_mul_f32 v141, v141, v49
v_mfma_f32_16x16x16_bf16 a[208:211], v[40:41], a[30:31], a[208:211]
v_mul_f32 v142, v142, v50
v_mul_f32 v143, v143, v51
v_cvt_pk_bf16_f32 v78, v140, v141
v_cvt_pk_bf16_f32 v79, v142, v143
buffer_store_dwordx4 v[76:79], v6, s[20:23], s37 offen offset:1024 sc1
ds_write_b128 v52, v[76:79] offset:1024
s_lshl_b32 s47, s35, 5
s_add_u32 s42, s42, s47
s_cmp_ge_u32 s42, 288
s_cselect_b64 vcc, -1, 0
s_cmp_lg_u32 s45, 0
s_cselect_b32 s47, 63, 64
v_lshl_add_u32 v122, v121, 1, s46
v_lshlrev_b32 v125, 4, v120
v_add_u32 v125, 147456, v125
v_sub_u32 v123, s47, v122
v_and_b32 v123, 63, v123
v_lshrrev_b32 v31, 1, v123
v_lshl_add_u32 v31, v31, 6, v125
v_and_b32 v124, 1, v123
v_lshl_add_u32 v31, v124, 13, v31
v_cndmask_b32 v123, v122, v123, vcc
v_lshrrev_b32 v29, 1, v123
v_lshl_add_u32 v29, v29, 6, v125
v_and_b32 v124, 1, v123
v_lshl_add_u32 v29, v124, 13, v29
v_add_u32 v122, 32, v122
v_sub_u32 v123, s47, v122
v_and_b32 v123, 63, v123
v_lshrrev_b32 v32, 1, v123
v_lshl_add_u32 v32, v32, 6, v125
v_and_b32 v124, 1, v123
v_lshl_add_u32 v32, v124, 13, v32
v_cndmask_b32 v123, v122, v123, vcc
v_lshrrev_b32 v30, 1, v123
v_max_f32 v80, 0, v80
v_add_u32 v52, s40, v7
v_max_f32 v81, 0, v81
v_max_f32 v82, 0, v82
v_max_f32 v83, 0, v83
v_mfma_f32_16x16x16_bf16 v[160:163], v[42:43], a[0:1], v[160:163]
v_mul_f32 v80, v80, v112
v_mul_f32 v81, v81, v113
v_mul_f32 v82, v82, v114
v_mul_f32 v83, v83, v115
v_cvt_pk_bf16_f32 v80, v80, v81
v_mfma_f32_16x16x16_bf16 a[124:127], v[42:43], a[2:3], a[124:127]
v_cvt_pk_bf16_f32 v81, v82, v83
v_max_f32 v144, 0, v144
v_max_f32 v145, 0, v145
v_max_f32 v146, 0, v146
v_max_f32 v147, 0, v147
v_mfma_f32_16x16x16_bf16 v[192:195], v[44:45], a[0:1], v[192:195]
v_accvgpr_read_b32 v48, a204
v_accvgpr_read_b32 v49, a205
v_accvgpr_read_b32 v50, a206
v_accvgpr_read_b32 v51, a207
v_mul_f32 v144, v144, v48
v_mfma_f32_16x16x16_bf16 a[156:159], v[44:45], a[2:3], a[156:159]
v_mul_f32 v145, v145, v49
v_mul_f32 v146, v146, v50
v_mul_f32 v147, v147, v51
v_cvt_pk_bf16_f32 v82, v144, v145
v_cvt_pk_bf16_f32 v83, v146, v147
buffer_store_dwordx4 v[80:83], v7, s[20:23], s37 offen sc1
ds_write_b128 v52, v[80:83] offset:0
v_lshl_add_u32 v30, v30, 6, v125
v_and_b32 v124, 1, v123
v_lshl_add_u32 v30, v124, 13, v30
s_sub_u32 s46, 32, s45
s_and_b32 s46, s46, 31
s_mul_i32 s77, s46, 4608
s_add_u32 s77, s77, 18874368
s_cmp_ge_u32 s42, 288
s_cselect_b32 s46, s46, s45
s_movk_i32 s45, 256
s_cselect_b32 s45, -256, s45
s_mul_i32 s46, s46, 4608
s_add_u32 s76, s46, 18874368
v_add_u32 v122, s42, v121
v_subrev_u32 v123, 1, v122
v_sub_u32 v124, 575, v122
v_cndmask_b32 v123, v123, v124, vcc
v_mul_u32_u24 v124, 147456, v120
v_lshl_add_u32 v36, v123, 4, v124
v_add_u32 v37, s45, v36
s_lshl_b32 s46, s34, 2
s_sub_u32 s47, 63, s46
v_and_b32 v123, 3, v19
v_sub_u32 v123, s47, v123
v_lshl_add_u32 v8, v123, 4, v124
v_cmp_eq_u32 vcc, 0, v122
v_mov_b32 v124, 1073741824
s_nop 0
v_cndmask_b32 v36, v36, v124, vcc
v_cmp_eq_u32 vcc, 0, v19
v_max_f32 v84, 0, v84
v_max_f32 v85, 0, v85
v_max_f32 v86, 0, v86
v_max_f32 v87, 0, v87
v_mul_f32 v84, v84, v116
v_mfma_f32_16x16x16_bf16 v[164:167], v[42:43], a[4:5], v[164:167]
v_mul_f32 v85, v85, v117
v_mul_f32 v86, v86, v118
v_mul_f32 v87, v87, v119
v_cvt_pk_bf16_f32 v84, v84, v85
v_cvt_pk_bf16_f32 v85, v86, v87
v_mfma_f32_16x16x16_bf16 a[128:131], v[42:43], a[6:7], a[128:131]
v_max_f32 v148, 0, v148
v_max_f32 v149, 0, v149
v_max_f32 v150, 0, v150
v_max_f32 v151, 0, v151
v_accvgpr_read_b32 v48, a208
v_mfma_f32_16x16x16_bf16 v[196:199], v[44:45], a[4:5], v[196:199]
v_accvgpr_read_b32 v49, a209
v_accvgpr_read_b32 v50, a210
v_accvgpr_read_b32 v51, a211
v_mul_f32 v148, v148, v48
v_mul_f32 v149, v149, v49
v_mfma_f32_16x16x16_bf16 a[160:163], v[44:45], a[6:7], a[160:163]
v_mul_f32 v150, v150, v50
v_mul_f32 v151, v151, v51
v_cvt_pk_bf16_f32 v86, v148, v149
v_cvt_pk_bf16_f32 v87, v150, v151
buffer_store_dwordx4 v[84:87], v7, s[20:23], s37 offen offset:1024 sc1
ds_write_b128 v52, v[84:87] offset:1024
s_sub_u32 s44, s42, 1
s_max_i32 s44, s44, 0
v_cndmask_b32 v3, v124, v20, vcc
s_sub_u32 s45, 544, s42
s_cmp_ge_u32 s42, 288
s_cselect_b32 s44, s45, s44
s_lshr_b32 s45, s44, 5
s_add_u32 s44, s44, 31
s_lshr_b32 s44, s44, 5
s_min_u32 s44, s44, 8
s_lshr_b32 s47, s47, 5
v_mov_b32 v123, s47
v_mov_b32 v125, s45
v_cmp_eq_u32 vcc, 0, v120
v_mov_b32 v121, s44
s_nop 0
v_cndmask_b32 v123, v123, v125, vcc
v_cmp_eq_u32 vcc, 1, v120
v_and_b32 v125, 7, v19
v_lshlrev_b32 v125, 5, v125
v_cndmask_b32 v123, v123, v121, vcc
v_bfe_u32 v120, v19, 3, 1
v_lshl_add_u32 v125, v120, 2, v125
v_and_b32 v120, 1, v123
v_lshl_add_u32 v125, v120, 3, v125
v_bfe_u32 v120, v123, 1, 2
v_add_u32 v125, v120, v125
v_lshrrev_b32 v120, 3, v123
v_lshl_add_u32 v125, v120, 4, v125
v_lshlrev_b32 v9, 7, v125
v_max_f32 v160, 0, v160
v_add_u32 v52, s41, v4
v_max_f32 v161, 0, v161
v_max_f32 v162, 0, v162
v_max_f32 v163, 0, v163
v_accvgpr_read_b32 v48, a124
v_mfma_f32_16x16x16_bf16 v[168:171], v[42:43], a[8:9], v[168:171]
v_accvgpr_read_b32 v49, a125
v_accvgpr_read_b32 v50, a126
v_accvgpr_read_b32 v51, a127
v_mul_f32 v160, v160, v48
v_mul_f32 v161, v161, v49
v_mul_f32 v162, v162, v50
v_mfma_f32_16x16x16_bf16 a[132:135], v[42:43], a[10:11], a[132:135]
v_mul_f32 v163, v163, v51
v_cvt_pk_bf16_f32 v160, v160, v161
v_cvt_pk_bf16_f32 v161, v162, v163
v_max_f32 v192, 0, v192
v_max_f32 v193, 0, v193
v_max_f32 v194, 0, v194
v_mfma_f32_16x16x16_bf16 v[200:203], v[44:45], a[8:9], v[200:203]
v_max_f32 v195, 0, v195
v_accvgpr_read_b32 v48, a156
v_accvgpr_read_b32 v49, a157
v_accvgpr_read_b32 v50, a158
v_accvgpr_read_b32 v51, a159
v_mul_f32 v192, v192, v48
v_mfma_f32_16x16x16_bf16 a[164:167], v[44:45], a[10:11], a[164:167]
v_mul_f32 v193, v193, v49
v_mul_f32 v194, v194, v50
v_mul_f32 v195, v195, v51
v_cvt_pk_bf16_f32 v162, v192, v193
v_cvt_pk_bf16_f32 v163, v194, v195
buffer_store_dwordx4 v[160:163], v4, s[20:23], s38 offen sc1
ds_write_b128 v52, v[160:163] offset:0
v_max_f32 v164, 0, v164
v_max_f32 v165, 0, v165
v_max_f32 v166, 0, v166
v_max_f32 v167, 0, v167
v_accvgpr_read_b32 v48, a128
v_accvgpr_read_b32 v49, a129
v_mfma_f32_16x16x16_bf16 v[172:175], v[42:43], a[12:13], v[172:175]
v_accvgpr_read_b32 v50, a130
v_accvgpr_read_b32 v51, a131
v_mul_f32 v164, v164, v48
v_mul_f32 v165, v165, v49
v_mul_f32 v166, v166, v50
v_mul_f32 v167, v167, v51
v_mfma_f32_16x16x16_bf16 a[136:139], v[42:43], a[14:15], a[136:139]
v_cvt_pk_bf16_f32 v164, v164, v165
v_cvt_pk_bf16_f32 v165, v166, v167
v_max_f32 v196, 0, v196
v_max_f32 v197, 0, v197
v_max_f32 v198, 0, v198
v_max_f32 v199, 0, v199
v_mfma_f32_16x16x16_bf16 v[204:207], v[44:45], a[12:13], v[204:207]
v_accvgpr_read_b32 v48, a160
v_accvgpr_read_b32 v49, a161
v_accvgpr_read_b32 v50, a162
v_accvgpr_read_b32 v51, a163
v_mul_f32 v196, v196, v48
v_mul_f32 v197, v197, v49
v_mfma_f32_16x16x16_bf16 a[168:171], v[44:45], a[14:15], a[168:171]
v_mul_f32 v198, v198, v50
v_mul_f32 v199, v199, v51
v_cvt_pk_bf16_f32 v166, v196, v197
v_cvt_pk_bf16_f32 v167, v198, v199
buffer_store_dwordx4 v[164:167], v4, s[20:23], s38 offen offset:1024 sc1
ds_write_b128 v52, v[164:167] offset:1024
v_max_f32 v168, 0, v168
v_add_u32 v52, s41, v5
v_max_f32 v169, 0, v169
v_max_f32 v170, 0, v170
v_max_f32 v171, 0, v171
v_accvgpr_read_b32 v48, a132
v_mfma_f32_16x16x16_bf16 v[176:179], v[42:43], a[16:17], v[176:179]
v_accvgpr_read_b32 v49, a133
v_accvgpr_read_b32 v50, a134
v_accvgpr_read_b32 v51, a135
v_mul_f32 v168, v168, v48
v_mul_f32 v169, v169, v49
v_mul_f32 v170, v170, v50
v_mfma_f32_16x16x16_bf16 a[140:143], v[42:43], a[18:19], a[140:143]
v_mul_f32 v171, v171, v51
v_cvt_pk_bf16_f32 v168, v168, v169
v_cvt_pk_bf16_f32 v169, v170, v171
v_max_f32 v200, 0, v200
v_max_f32 v201, 0, v201
v_max_f32 v202, 0, v202
v_mfma_f32_16x16x16_bf16 v[208:211], v[44:45], a[16:17], v[208:211]
v_max_f32 v203, 0, v203
v_accvgpr_read_b32 v48, a164
v_accvgpr_read_b32 v49, a165
v_accvgpr_read_b32 v50, a166
v_accvgpr_read_b32 v51, a167
v_mul_f32 v200, v200, v48
v_mfma_f32_16x16x16_bf16 a[172:175], v[44:45], a[18:19], a[172:175]
v_mul_f32 v201, v201, v49
v_mul_f32 v202, v202, v50
v_mul_f32 v203, v203, v51
v_cvt_pk_bf16_f32 v170, v200, v201
v_cvt_pk_bf16_f32 v171, v202, v203
buffer_store_dwordx4 v[168:171], v5, s[20:23], s38 offen sc1
ds_write_b128 v52, v[168:171] offset:0
v_max_f32 v172, 0, v172
v_max_f32 v173, 0, v173
v_max_f32 v174, 0, v174
v_max_f32 v175, 0, v175
v_accvgpr_read_b32 v48, a136
v_accvgpr_read_b32 v49, a137
v_mfma_f32_16x16x16_bf16 v[180:183], v[42:43], a[20:21], v[180:183]
v_accvgpr_read_b32 v50, a138
v_accvgpr_read_b32 v51, a139
v_mul_f32 v172, v172, v48
v_mul_f32 v173, v173, v49
v_mul_f32 v174, v174, v50
v_mul_f32 v175, v175, v51
v_mfma_f32_16x16x16_bf16 a[144:147], v[42:43], a[22:23], a[144:147]
v_cvt_pk_bf16_f32 v172, v172, v173
v_cvt_pk_bf16_f32 v173, v174, v175
v_max_f32 v204, 0, v204
v_max_f32 v205, 0, v205
v_max_f32 v206, 0, v206
v_max_f32 v207, 0, v207
v_mfma_f32_16x16x16_bf16 v[212:215], v[44:45], a[20:21], v[212:215]
v_accvgpr_read_b32 v48, a168
v_accvgpr_read_b32 v49, a169
v_accvgpr_read_b32 v50, a170
v_accvgpr_read_b32 v51, a171
v_mul_f32 v204, v204, v48
v_mul_f32 v205, v205, v49
v_mfma_f32_16x16x16_bf16 a[176:179], v[44:45], a[22:23], a[176:179]
v_mul_f32 v206, v206, v50
v_mul_f32 v207, v207, v51
v_cvt_pk_bf16_f32 v174, v204, v205
v_cvt_pk_bf16_f32 v175, v206, v207
buffer_store_dwordx4 v[172:175], v5, s[20:23], s38 offen offset:1024 sc1
ds_write_b128 v52, v[172:175] offset:1024
v_lshrrev_b32 v120, 2, v19
v_and_b32 v121, 3, v19
v_lshlrev_b32 v121, 3, v121
v_and_b32 v122, 7, v120
v_lshl_add_u32 v122, v122, 5, v121
v_max_f32 v176, 0, v176
v_add_u32 v52, s41, v6
v_max_f32 v177, 0, v177
v_max_f32 v178, 0, v178
v_max_f32 v179, 0, v179
v_accvgpr_read_b32 v48, a140
v_mfma_f32_16x16x16_bf16 v[184:187], v[42:43], a[24:25], v[184:187]
v_accvgpr_read_b32 v49, a141
v_accvgpr_read_b32 v50, a142
v_accvgpr_read_b32 v51, a143
v_mul_f32 v176, v176, v48
v_mul_f32 v177, v177, v49
v_mul_f32 v178, v178, v50
v_mfma_f32_16x16x16_bf16 a[148:151], v[42:43], a[26:27], a[148:151]
v_mul_f32 v179, v179, v51
v_cvt_pk_bf16_f32 v176, v176, v177
v_cvt_pk_bf16_f32 v177, v178, v179
v_max_f32 v208, 0, v208
v_max_f32 v209, 0, v209
v_max_f32 v210, 0, v210
v_mfma_f32_16x16x16_bf16 v[216:219], v[44:45], a[24:25], v[216:219]
v_max_f32 v211, 0, v211
v_accvgpr_read_b32 v48, a172
v_accvgpr_read_b32 v49, a173
v_accvgpr_read_b32 v50, a174
v_accvgpr_read_b32 v51, a175
v_mul_f32 v208, v208, v48
v_mfma_f32_16x16x16_bf16 a[180:183], v[44:45], a[26:27], a[180:183]
v_mul_f32 v209, v209, v49
v_mul_f32 v210, v210, v50
v_mul_f32 v211, v211, v51
v_cvt_pk_bf16_f32 v178, v208, v209
v_cvt_pk_bf16_f32 v179, v210, v211
buffer_store_dwordx4 v[176:179], v6, s[20:23], s38 offen sc1
ds_write_b128 v52, v[176:179] offset:0
v_lshl_add_u32 v152, v120, 8, v122
v_bfe_u32 v122, v120, 1, 2
v_lshl_add_u32 v122, v122, 5, v121
v_lshl_add_u32 v122, v120, 7, v122
v_add_u32 v168, 0x18000, v122
v_add_u32 v160, 0x10000, v152
v_max_f32 v180, 0, v180
v_max_f32 v181, 0, v181
v_max_f32 v182, 0, v182
v_max_f32 v183, 0, v183
v_accvgpr_read_b32 v48, a144
v_accvgpr_read_b32 v49, a145
v_mfma_f32_16x16x16_bf16 v[188:191], v[42:43], a[28:29], v[188:191]
v_accvgpr_read_b32 v50, a146
v_accvgpr_read_b32 v51, a147
v_mul_f32 v180, v180, v48
v_mul_f32 v181, v181, v49
v_mul_f32 v182, v182, v50
v_mul_f32 v183, v183, v51
v_mfma_f32_16x16x16_bf16 a[152:155], v[42:43], a[30:31], a[152:155]
v_cvt_pk_bf16_f32 v180, v180, v181
v_cvt_pk_bf16_f32 v181, v182, v183
v_max_f32 v212, 0, v212
v_max_f32 v213, 0, v213
v_max_f32 v214, 0, v214
v_max_f32 v215, 0, v215
v_mfma_f32_16x16x16_bf16 v[220:223], v[44:45], a[28:29], v[220:223]
v_accvgpr_read_b32 v48, a176
v_accvgpr_read_b32 v49, a177
v_accvgpr_read_b32 v50, a178
v_accvgpr_read_b32 v51, a179
v_mul_f32 v212, v212, v48
v_mul_f32 v213, v213, v49
v_mfma_f32_16x16x16_bf16 a[184:187], v[44:45], a[30:31], a[184:187]
v_mul_f32 v214, v214, v50
v_mul_f32 v215, v215, v51
v_cvt_pk_bf16_f32 v182, v212, v213
v_cvt_pk_bf16_f32 v183, v214, v215
buffer_store_dwordx4 v[180:183], v6, s[20:23], s38 offen offset:1024 sc1
ds_write_b128 v52, v[180:183] offset:1024
v_xor_b32 v153, 32, v152
v_xor_b32 v161, 32, v160
v_xor_b32 v154, 64, v152
v_xor_b32 v162, 64, v160
v_xor_b32 v155, 96, v152
v_max_f32 v184, 0, v184
v_add_u32 v52, s41, v7
v_max_f32 v185, 0, v185
v_max_f32 v186, 0, v186
v_max_f32 v187, 0, v187
v_accvgpr_read_b32 v48, a148
v_accvgpr_read_b32 v49, a149
v_accvgpr_read_b32 v50, a150
v_accvgpr_read_b32 v51, a151
v_mul_f32 v184, v184, v48
v_mfma_f32_16x16x16_bf16 v[224:227], v[46:47], a[0:1], v[224:227]
v_mul_f32 v185, v185, v49
v_mul_f32 v186, v186, v50
v_mul_f32 v187, v187, v51
v_cvt_pk_bf16_f32 v184, v184, v185
v_cvt_pk_bf16_f32 v185, v186, v187
v_max_f32 v216, 0, v216
v_max_f32 v217, 0, v217
v_max_f32 v218, 0, v218
v_max_f32 v219, 0, v219
v_accvgpr_read_b32 v48, a180
v_mfma_f32_16x16x16_bf16 v[228:231], v[46:47], a[4:5], v[228:231]
v_accvgpr_read_b32 v49, a181
v_accvgpr_read_b32 v50, a182
v_accvgpr_read_b32 v51, a183
v_mul_f32 v216, v216, v48
v_mul_f32 v217, v217, v49
v_mul_f32 v218, v218, v50
v_mul_f32 v219, v219, v51
v_cvt_pk_bf16_f32 v186, v216, v217
v_cvt_pk_bf16_f32 v187, v218, v219
buffer_store_dwordx4 v[184:187], v7, s[20:23], s38 offen sc1
ds_write_b128 v52, v[184:187] offset:0
v_xor_b32 v163, 96, v160
v_xor_b32 v156, 128, v152
v_xor_b32 v164, 128, v160
v_xor_b32 v157, 160, v152
v_xor_b32 v165, 160, v160
v_xor_b32 v158, 192, v152
v_max_f32 v188, 0, v188
v_max_f32 v189, 0, v189
v_max_f32 v190, 0, v190
v_max_f32 v191, 0, v191
v_accvgpr_read_b32 v48, a152
v_accvgpr_read_b32 v49, a153
v_accvgpr_read_b32 v50, a154
v_accvgpr_read_b32 v51, a155
v_mul_f32 v188, v188, v48
v_mul_f32 v189, v189, v49
v_mfma_f32_16x16x16_bf16 v[232:235], v[46:47], a[8:9], v[232:235]
v_mul_f32 v190, v190, v50
v_mul_f32 v191, v191, v51
v_cvt_pk_bf16_f32 v188, v188, v189
v_cvt_pk_bf16_f32 v189, v190, v191
v_max_f32 v220, 0, v220
v_max_f32 v221, 0, v221
v_max_f32 v222, 0, v222
v_max_f32 v223, 0, v223
v_accvgpr_read_b32 v48, a184
v_accvgpr_read_b32 v49, a185
v_mfma_f32_16x16x16_bf16 v[236:239], v[46:47], a[12:13], v[236:239]
v_accvgpr_read_b32 v50, a186
v_accvgpr_read_b32 v51, a187
v_mul_f32 v220, v220, v48
v_mul_f32 v221, v221, v49
v_mul_f32 v222, v222, v50
v_mul_f32 v223, v223, v51
v_cvt_pk_bf16_f32 v190, v220, v221
v_cvt_pk_bf16_f32 v191, v222, v223
buffer_store_dwordx4 v[188:191], v7, s[20:23], s38 offen offset:1024 sc1
ds_write_b128 v52, v[188:191] offset:1024
v_xor_b32 v166, 192, v160
v_xor_b32 v159, 224, v152
v_xor_b32 v167, 224, v160
v_xor_b32 v169, 32, v168
v_xor_b32 v170, 64, v168
v_xor_b32 v171, 96, v168
v_permlane32_swap_b32 v224, v228
v_permlane32_swap_b32 v225, v229
v_permlane32_swap_b32 v226, v230
v_permlane32_swap_b32 v227, v231
v_mfma_f32_16x16x16_bf16 v[240:243], v[46:47], a[16:17], v[240:243]
v_max_f32 v224, 0, v224
v_max_f32 v225, 0, v225
v_max_f32 v226, 0, v226
v_max_f32 v227, 0, v227
v_mfma_f32_16x16x16_bf16 v[244:247], v[46:47], a[20:21], v[244:247]
v_mul_f32 v224, v224, v228
v_mul_f32 v225, v225, v229
v_mul_f32 v226, v226, v230
v_mul_f32 v227, v227, v231
v_cvt_pk_bf16_f32 v224, v224, v225
v_cvt_pk_bf16_f32 v225, v226, v227
v_permlane32_swap_b32 v232, v236
v_permlane32_swap_b32 v233, v237
v_permlane32_swap_b32 v234, v238
v_permlane32_swap_b32 v235, v239
v_max_f32 v232, 0, v232
v_max_f32 v233, 0, v233
v_mfma_f32_16x16x16_bf16 v[248:251], v[46:47], a[24:25], v[248:251]
v_max_f32 v234, 0, v234
v_max_f32 v235, 0, v235
v_mul_f32 v232, v232, v236
v_mul_f32 v233, v233, v237
v_mul_f32 v234, v234, v238
v_mul_f32 v235, v235, v239
v_mfma_f32_16x16x16_bf16 v[252:255], v[46:47], a[28:29], v[252:255]
v_cvt_pk_bf16_f32 v226, v232, v233
v_cvt_pk_bf16_f32 v227, v234, v235
s_nop 1
v_permlane16_swap_b32 v224, v226
v_permlane16_swap_b32 v225, v227
buffer_store_dwordx4 v[224:227], v15, s[20:23], s39 offen sc1
v_add_u32 v52, s43, v15
ds_write_b128 v52, v[224:227]
v_permlane32_swap_b32 v240, v244
v_permlane32_swap_b32 v241, v245
v_permlane32_swap_b32 v242, v246
v_permlane32_swap_b32 v243, v247
v_max_f32 v240, 0, v240
v_max_f32 v241, 0, v241
v_max_f32 v242, 0, v242
v_max_f32 v243, 0, v243
v_mul_f32 v240, v240, v244
v_mul_f32 v241, v241, v245
v_mul_f32 v242, v242, v246
v_mul_f32 v243, v243, v247
v_cvt_pk_bf16_f32 v240, v240, v241
v_cvt_pk_bf16_f32 v241, v242, v243
v_permlane32_swap_b32 v248, v252
v_permlane32_swap_b32 v249, v253
v_permlane32_swap_b32 v250, v254
v_permlane32_swap_b32 v251, v255
v_max_f32 v248, 0, v248
v_max_f32 v249, 0, v249
v_max_f32 v250, 0, v250
v_max_f32 v251, 0, v251
v_mul_f32 v248, v248, v252
v_mul_f32 v249, v249, v253
v_mul_f32 v250, v250, v254
v_mul_f32 v251, v251, v255
v_cvt_pk_bf16_f32 v242, v248, v249
v_cvt_pk_bf16_f32 v243, v250, v251
s_nop 1
v_permlane16_swap_b32 v240, v242
v_permlane16_swap_b32 v241, v243
buffer_store_dwordx4 v[240:243], v16, s[20:23], s39 offen sc1
v_add_u32 v52, s43, v16
ds_write_b128 v52, v[240:243]
v_add_u32 v52, 114688, v11
s_waitcnt vmcnt(23)
s_waitcnt lgkmcnt(0)
s_barrier
ds_read_b128 a[100:103], v11 offset:0
ds_read_b128 a[104:107], v11 offset:1024
ds_read_b128 a[108:111], v11 offset:8192
ds_read_b128 a[112:115], v11 offset:9216
ds_read_b128 a[116:119], v11 offset:16384
ds_read_b128 a[120:123], v11 offset:17408
ds_read_b128 a[124:127], v11 offset:24576
ds_read_b128 a[128:131], v11 offset:25600
ds_read_b128 a[132:135], v11 offset:32768
ds_read_b128 a[136:139], v11 offset:33792
ds_read_b128 a[140:143], v11 offset:40960
ds_read_b128 a[144:147], v11 offset:41984
ds_read_b128 a[148:151], v11 offset:49152
ds_read_b128 a[152:155], v11 offset:50176
ds_read_b128 a[156:159], v11 offset:57344
ds_read_b128 a[160:163], v11 offset:58368
ds_read_b128 a[164:167], v52 offset:0
ds_read_b128 a[168:171], v52 offset:1024
ds_read_b64_tr_b16 a[64:65], v160 offset:0
ds_read_b64_tr_b16 a[66:67], v160 offset:4096
ds_read_b64_tr_b16 a[68:69], v161 offset:0
ds_read_b64_tr_b16 a[70:71], v161 offset:4096
ds_read_b64_tr_b16 a[72:73], v162 offset:0
ds_read_b64_tr_b16 a[74:75], v162 offset:4096
ds_read_b64_tr_b16 a[76:77], v163 offset:0
ds_read_b64_tr_b16 a[78:79], v163 offset:4096
ds_read_b64_tr_b16 a[80:81], v164 offset:0
ds_read_b64_tr_b16 a[82:83], v164 offset:4096
ds_read_b64_tr_b16 a[84:85], v165 offset:0
ds_read_b64_tr_b16 a[86:87], v165 offset:4096
ds_read_b64_tr_b16 a[88:89], v166 offset:0
ds_read_b64_tr_b16 a[90:91], v166 offset:4096
ds_read_b64_tr_b16 a[92:93], v167 offset:0
ds_read_b64_tr_b16 a[94:95], v167 offset:4096
ds_read_b64_tr_b16 a[196:197], v168 offset:32768
ds_read_b64_tr_b16 a[198:199], v168 offset:34816
ds_read_b64_tr_b16 a[200:201], v169 offset:32768
ds_read_b64_tr_b16 a[202:203], v169 offset:34816
ds_read_b64_tr_b16 a[204:205], v170 offset:32768
ds_read_b64_tr_b16 a[206:207], v170 offset:34816
ds_read_b64_tr_b16 a[208:209], v171 offset:32768
ds_read_b64_tr_b16 a[210:211], v171 offset:34816
v_mov_b32 v54, s62
v_add_u32 v244, 0xc000, v160
v_add_u32 v245, 0xc000, v161
v_add_u32 v246, 0xc000, v162
v_add_u32 v247, 0xc000, v163
v_add_u32 v248, 0xc000, v164
v_add_u32 v249, 0xc000, v165
v_add_u32 v250, 0xc000, v166
v_add_u32 v251, 0xc000, v167
s_lshl_b32 s46, s2, 2
s_add_u32 s46, s46, s32
s_lshl_b32 s47, s46, 7
s_add_u32 s85, s47, 21626880
s_add_u32 s94, s47, 21757952
s_lshl_b32 s47, s46, 12
s_add_u32 s95, s47, 31457280
s_lshl_b32 s46, s46, 13
s_add_u32 s37, s46, 22020096
s_add_u32 s38, s37, 4096
v_lshlrev_b32 v52, 4, v19
v_and_b32 v50, 3, v19
v_max_u32 v50, 1, v50
v_xor_b32 v50, s2, v50
s_lshl_b32 s47, s32, 7
v_lshl_add_u32 v50, v50, 9, s47
v_and_b32 v51, 3, v19
v_bfe_u32 v49, v19, 2, 2
v_lshl_or_b32 v51, v49, 3, v51
v_max_u32 v51, 1, v51
v_xor_b32 v51, s2, v51
v_lshl_add_u32 v51, v51, 9, s47
s_and_b32 s46, s2, 0xe4
s_lshl_b32 s46, s46, 14
s_lshl_b32 s47, s32, 12
s_add_u32 s46, s46, s47
s_lshl_b32 s47, s34, 8
s_add_u32 s46, s46, s47
s_add_u32 s39, s46, 31457280
v_and_b32 v48, 1, v19
v_lshlrev_b32 v48, 4, v48
v_mov_b32 v53, 0x3f80
v_lshlrev_b32 v48, v48, v53
v_cmp_eq_u32 vcc, 0, v49
s_nop 1
v_cndmask_b32 v252, 0, v48, vcc
v_cmp_eq_u32 vcc, 1, v49
s_nop 1
v_cndmask_b32 v253, 0, v48, vcc
v_cmp_eq_u32 vcc, 2, v49
s_nop 1
v_cndmask_b32 v254, 0, v48, vcc
v_cmp_eq_u32 vcc, 3, v49
s_nop 1
v_cndmask_b32 v255, 0, v48, vcc
v_lshrrev_b32 v53, 4, v19
v_cmp_eq_u32 vcc, v53, v49
v_bfe_u32 v49, v19, 1, 1
v_lshlrev_b32 v53, 14, v53
v_cndmask_b32 v48, 0, v48, vcc
v_cmp_eq_u32 vcc, 1, v49
v_and_b32 v49, 15, v19
v_lshl_add_u32 v53, v49, 4, v53
v_cndmask_b32 v13, 0, v48, vcc
v_cndmask_b32 v12, v48, v20, vcc
s_waitcnt vmcnt(0) lgkmcnt(15)
s_barrier
buffer_store_dword v54, v21, s[20:23], s90 offen sc1
s_add_u32 m0, s49, 0
s_nop 0
buffer_load_dwordx4 v24, s[4:7], s67 offen lds
buffer_load_dwordx4 v25, s[4:7], s67 offen offset:1024 lds
buffer_load_dwordx4 v26, s[4:7], s67 offen offset:2048 lds
buffer_load_dwordx4 v27, s[4:7], s67 offen offset:3072 lds
s_add_u32 m0, m0, 4096
s_add_u32 s67, s67, 18432
s_nop 0
buffer_load_dwordx4 v24, s[4:7], s67 offen lds
buffer_load_dwordx4 v25, s[4:7], s67 offen offset:1024 lds
buffer_load_dwordx4 v26, s[4:7], s67 offen offset:2048 lds
buffer_load_dwordx4 v27, s[4:7], s67 offen offset:3072 lds
s_branch L_g2
L_heavy:
s_lshl_b32 s44, s48, 2
s_add_u32 s44, s44, s32
s_lshl_b32 s44, s44, 3
s_add_u32 s44, s44, 1
s_mul_i32 s44, s44, 1152
v_and_b32 v48, 7, v19
v_mul_u32_u24 v48, 1152, v48
v_lshrrev_b32 v49, 4, v19
v_lshl_add_u32 v48, v49, 4, v48
v_add_u32 v48, s44, v48
v_and_b32 v49, 8, v19
v_cmp_eq_u32 vcc, 0, v49
v_mov_b32 v49, s82
v_mov_b32 v50, s84
v_mov_b32 v51, s83
v_mov_b32 v52, s85
v_cndmask_b32 v49, v50, v49, vcc
v_cndmask_b32 v51, v52, v51, vcc
v_add_co_u32 v20, vcc, v49, v48
s_nop 1
v_addc_co_u32 v21, vcc, 0, v51, vcc
global_load_dwordx4 a[100:103], v[20:21], off offset:0
global_load_dwordx4 a[104:107], v[20:21], off offset:64
s_add_u32 m0, s49, 32768
s_mov_b32 s37, 294912
buffer_load_dwordx4 v4, s[12:15], s37 offen lds
buffer_load_dwordx4 v5, s[12:15], s37 offen offset:1024 lds
buffer_load_dwordx4 v6, s[12:15], s37 offen offset:2048 lds
buffer_load_dwordx4 v7, s[12:15], s37 offen offset:3072 lds
buffer_load_dword v43, v43, s[52:55], 0 offen
s_lshl_b32 s44, s34, 3
s_lshl_b32 s45, s32, 1
s_add_u32 s44, s44, s45
s_lshr_b32 s45, s44, 5
s_and_b32 s44, s44, 31
s_lshl_b32 s44, s44, 6
s_add_u32 s44, s44, s45
s_lshl_b32 s45, s33, 2
s_add_u32 s44, s44, s45
s_mul_i32 s44, s44, 1152
s_add_u32 s44, s44, 128
v_and_b32 v48, 1, v19
v_mul_u32_u24 v48, 73728, v48
v_lshrrev_b32 v49, 1, v19
v_lshl_add_u32 v48, v49, 7, v48
v_cmp_gt_u32 vcc, 6, v19
v_add_u32 v48, s44, v48
v_mov_b32 v49, 1073741824
v_cndmask_b32 v44, v49, v48, vcc
buffer_load_dword v44, v44, s[8:11], 0 offen
s_mov_b32 s52, s94
s_mov_b32 s53, s95
s_mov_b32 s54, 2359296
s_mov_b32 s55, 0x20000
s_lshl_b32 s44, s48, 2
s_add_u32 s44, s44, s32
s_lshl_b32 s44, s44, 3
s_add_u32 s44, s44, 1
s_mul_i32 s44, s44, 1152
s_and_b32 s45, s33, 7
s_mul_i32 s45, s45, 1152
s_add_u32 s44, s44, s45
v_min_u32 v46, 8, v19
v_lshl_add_u32 v46, v46, 7, s44
s_cmp_lt_u32 s33, 8
s_cselect_b64 s[46:47], s[82:83], s[84:85]
global_load_dword v46, v46, s[46:47]
s_cmp_lt_u32 s32, 2
s_cselect_b32 s56, s88, s90
s_cselect_b32 s57, s89, s91
s_mov_b32 s58, 5308416
s_mov_b32 s59, 0x20000
s_and_b32 s44, s33, 14
s_add_u32 s44, s44, s36
s_mul_i32 s44, s44, 3
s_and_b32 s45, s33, 1
s_mul_i32 s45, s45, 48
s_add_u32 s44, s44, s45
s_mul_i32 s44, s44, 9216
s_mul_i32 s45, s35, 2304
s_add_u32 s44, s44, s45
s_and_b32 s45, s32, 1
s_mul_i32 s45, s45, 1152
s_add_u32 s44, s44, s45
v_mul_u32_u24 v48, 57, v19
v_lshrrev_b32 v48, 9, v48
v_mul_u32_u24 v49, 9, v48
v_sub_u32 v49, v19, v49
v_mul_u32_u24 v50, 9216, v48
v_lshl_add_u32 v50, v49, 7, v50
v_add_u32 v50, s44, v50
v_cmp_gt_u32 vcc, 3, v48
v_mov_b32 v51, 1073741824
s_mov_b32 s61, 1073741824
s_cmp_lt_u32 s36, 2
s_cselect_b32 s60, 1769472, s61
v_cndmask_b32 v22, v51, v50, vcc
s_bfe_u32 s41, s2, 0x20005
s_min_u32 s41, s41, 2
v_add_co_u32 v20, vcc, 128, v20
s_lshl_b32 s44, s33, 2
s_add_u32 s44, s44, s32
v_addc_co_u32 v21, vcc, 0, v21, vcc
s_lshl_b32 s44, s44, 12
v_lshrrev_b32 v48, 2, v19
v_lshlrev_b32 v48, 18, v48
v_add_u32 v48, s44, v48
v_and_b32 v49, 3, v19
v_bfe_u32 v50, v19, 4, 1
v_lshlrev_b32 v50, 1, v50
v_xor_b32 v49, v49, v50
v_lshl_add_u32 v30, v49, 4, v48
s_add_u32 s50, s49, 32768
s_mov_b32 s42, 6
s_waitcnt vmcnt(17)
s_barrier
ds_read_b128 a[0:3], v15 offset:0
ds_read_b128 a[4:7], v15 offset:2048
ds_read_b128 a[8:11], v16 offset:0
ds_read_b128 a[12:15], v16 offset:2048
ds_read_b128 a[16:19], v17 offset:0
ds_read_b128 a[20:23], v17 offset:2048
ds_read_b128 a[24:27], v18 offset:0
ds_read_b128 a[28:31], v18 offset:2048
ds_read_b64_tr_b16 a[64:65], v10 offset:0
ds_read_b64_tr_b16 a[66:67], v10 offset:512
ds_read_b64_tr_b16 a[72:73], v11 offset:0
ds_read_b64_tr_b16 a[74:75], v11 offset:512
ds_read_b64_tr_b16 a[80:81], v12 offset:0
ds_read_b64_tr_b16 a[82:83], v12 offset:512
ds_read_b64_tr_b16 a[88:89], v13 offset:0
ds_read_b64_tr_b16 a[90:91], v13 offset:512
v_xor_b32 v15, 64, v15
v_xor_b32 v16, 64, v16
v_xor_b32 v17, 64, v17
v_xor_b32 v18, 64, v18
v_mov_b32 v33, 0
global_load_dword v33, v33, s[96:97] offset:8 sc1
s_waitcnt lgkmcnt(0)
v_mfma_f32_16x16x32_bf16 v[56:59], a[64:67], a[0:3], 0
v_mfma_f32_16x16x32_bf16 v[60:63], a[64:67], a[4:7], 0
v_mfma_f32_16x16x32_bf16 v[64:67], a[64:67], a[8:11], 0
s_add_u32 m0, s50, 4096
v_mfma_f32_16x16x32_bf16 v[68:71], a[64:67], a[12:15], 0
v_mfma_f32_16x16x32_bf16 v[72:75], a[64:67], a[16:19], 0
buffer_load_dwordx4 v4, s[16:19], s37 offen lds
v_mfma_f32_16x16x32_bf16 v[76:79], a[64:67], a[20:23], 0
v_mfma_f32_16x16x32_bf16 v[80:83], a[64:67], a[24:27], 0
s_waitcnt vmcnt(5)
v_mfma_f32_16x16x32_bf16 v[84:87], a[64:67], a[28:31], 0
ds_read_b64_tr_b16 a[64:65], v10 offset:32768
buffer_load_dwordx4 v5, s[16:19], s37 offen offset:1024 lds
v_mfma_f32_16x16x32_bf16 v[120:123], a[72:75], a[0:3], 0
ds_read_b64_tr_b16 a[66:67], v10 offset:33280
s_lshl_b32 s44, s36, 8
v_mfma_f32_16x16x32_bf16 v[124:127], a[72:75], a[4:7], 0
buffer_load_dwordx4 v6, s[16:19], s37 offen offset:2048 lds
s_lshl_b32 s45, s35, 1
v_mfma_f32_16x16x32_bf16 v[128:131], a[72:75], a[8:11], 0
ds_read_b128 a[32:35], v15 offset:0
v_lshrrev_b32 v48, 4, v19
v_mfma_f32_16x16x32_bf16 v[132:135], a[72:75], a[12:15], 0
v_bfe_u32 v49, v19, 1, 3
v_mfma_f32_16x16x32_bf16 v[136:139], a[72:75], a[16:19], 0
buffer_load_dwordx4 v7, s[16:19], s37 offen offset:3072 lds
v_xor_b32 v49, v49, v48
v_mfma_f32_16x16x32_bf16 v[140:143], a[72:75], a[20:23], 0
v_xor_b32 v49, s45, v49
v_mfma_f32_16x16x32_bf16 v[144:147], a[72:75], a[24:27], 0
ds_read_b128 a[36:39], v15 offset:2048
s_mov_b32 s39, 128
v_mul_u32_u24 v48, 1152, v48
v_mfma_f32_16x16x32_bf16 v[148:151], a[72:75], a[28:31], 0
ds_read_b64_tr_b16 a[72:73], v11 offset:32768
v_and_b32 v50, 1, v19
v_mfma_f32_16x16x32_bf16 v[160:163], a[80:83], a[0:3], 0
ds_read_b64_tr_b16 a[74:75], v11 offset:33280
v_lshl_add_u32 v48, v50, 4, v48
v_mfma_f32_16x16x32_bf16 v[164:167], a[80:83], a[4:7], 0
s_xor_b32 m0, s43, 229376
v_add_u32 v48, s44, v48
v_mfma_f32_16x16x32_bf16 v[168:171], a[80:83], a[8:11], 0
s_waitcnt vmcnt(14)
s_barrier
v_lshl_add_u32 v24, v49, 5, v48
v_mfma_f32_16x16x32_bf16 v[172:175], a[80:83], a[12:15], 0
ds_read_b64_tr_b16 a[96:97], v14 offset:16384
s_mov_b32 s38, 589824
v_mfma_f32_16x16x32_bf16 v[176:179], a[80:83], a[16:19], 0
ds_read_b64_tr_b16 a[98:99], v14 offset:16640
v_xor_b32 v49, 4, v49
v_mfma_f32_16x16x32_bf16 v[180:183], a[80:83], a[20:23], 0
ds_read_b64_tr_b16 a[68:69], v10 offset:4096
v_lshl_add_u32 v25, v49, 5, v48
v_mfma_f32_16x16x32_bf16 v[184:187], a[80:83], a[24:27], 0
ds_read_b64_tr_b16 a[70:71], v10 offset:4608
buffer_load_dwordx4 v0, s[8:11], s39 offen lds
v_add_u32 v26, 7168, v24
v_mfma_f32_16x16x32_bf16 v[188:191], a[80:83], a[28:31], 0
ds_read_b64_tr_b16 a[76:77], v11 offset:4096
v_add_u32 v27, 10752, v25
v_mfma_f32_16x16x32_bf16 v[192:195], a[88:91], a[0:3], 0
ds_read_b64_tr_b16 a[78:79], v11 offset:4608
buffer_load_dwordx4 v1, s[8:11], s39 offen offset:1024 lds
v_add_u32 v25, 3584, v25
v_mfma_f32_16x16x32_bf16 v[196:199], a[88:91], a[4:7], 0
ds_read_b64_tr_b16 a[84:85], v12 offset:4096
v_lshrrev_b32 v48, 3, v19
v_mfma_f32_16x16x32_bf16 v[200:203], a[88:91], a[8:11], 0
ds_read_b64_tr_b16 a[86:87], v12 offset:4608
v_bfe_u32 v49, v19, 1, 2
v_mfma_f32_16x16x32_bf16 v[204:207], a[88:91], a[12:15], 0
ds_read_b64_tr_b16 a[92:93], v13 offset:4096
buffer_load_dwordx4 v2, s[8:11], s39 offen offset:2048 lds
v_bfe_u32 v51, v19, 4, 2
v_mfma_f32_16x16x32_bf16 v[208:211], a[88:91], a[16:19], 0
ds_read_b64_tr_b16 a[94:95], v13 offset:4608
v_xor_b32 v49, v49, v51
v_mfma_f32_16x16x32_bf16 v[212:215], a[88:91], a[20:23], 0
ds_read_b64_tr_b16 a[80:81], v12 offset:32768
buffer_load_dwordx4 v3, s[8:11], s39 offen offset:3072 lds
v_mul_u32_u24 v48, 1152, v48
v_mfma_f32_16x16x32_bf16 v[216:219], a[88:91], a[24:27], 0
ds_read_b64_tr_b16 a[82:83], v12 offset:33280
v_lshl_add_u32 v48, v50, 4, v48
v_mfma_f32_16x16x32_bf16 v[220:223], a[88:91], a[28:31], 0
s_waitcnt lgkmcnt(10)
v_mfma_f32_16x16x32_bf16 v[224:227], a[96:99], a[0:3], 0
ds_read_b64_tr_b16 a[88:89], v13 offset:32768
s_xor_b32 m0, s3, 229376
v_lshl_add_u32 v48, v49, 5, v48
v_mfma_f32_16x16x32_bf16 v[228:231], a[96:99], a[4:7], 0
ds_read_b64_tr_b16 a[90:91], v13 offset:33280
v_add_u32 v28, 1024, v48
v_mfma_f32_16x16x32_bf16 v[232:235], a[96:99], a[8:11], 0
v_xor_b32 v15, 229440, v15
buffer_load_dwordx4 v8, s[12:15], s38 offen lds
s_mov_b32 s75, 0x02030100
v_mfma_f32_16x16x32_bf16 v[236:239], a[96:99], a[12:15], 0
ds_read_b128 a[40:43], v16 offset:0
s_cmp_ge_u32 s36, 1
s_cselect_b32 s75, 0x03020001, s75
v_mfma_f32_16x16x32_bf16 v[240:243], a[96:99], a[16:19], 0
ds_read_b128 a[44:47], v16 offset:2048
s_cmp_ge_u32 s36, 2
s_cselect_b32 s75, 0x03010002, s75
s_cselect_b32 s65, 4, 0
v_mfma_f32_16x16x32_bf16 v[244:247], a[96:99], a[20:23], 0
v_xor_b32 v16, 229440, v16
s_add_u32 m0, m0, 4096
v_mfma_f32_16x16x32_bf16 v[248:251], a[96:99], a[24:27], 0
ds_read_b128 a[48:51], v17 offset:0
s_cmp_ge_u32 s36, 3
s_cselect_b32 s75, 0x02000103, s75
v_mfma_f32_16x16x32_bf16 v[252:255], a[96:99], a[28:31], 0
s_waitcnt vmcnt(18)
s_lshr_b32 s44, s33, 1
s_and_b32 s44, s44, 7
v_mfma_f32_16x16x32_bf16 a[212:215], a[0:3], a[100:103], 0
ds_read_b64_tr_b16 a[96:97], v14 offset:18432
buffer_load_dwordx4 v8, s[16:19], s38 offen lds
s_add_u32 s65, s65, s44
v_mfma_f32_16x16x32_bf16 a[216:219], a[4:7], a[100:103], 0
ds_read_b64_tr_b16 a[98:99], v14 offset:18688
s_cmp_ge_u32 s65, 9
s_cselect_b32 s44, 9, 0
v_mfma_f32_16x16x32_bf16 a[220:223], a[8:11], a[100:103], 0
ds_read_b128 a[52:55], v17 offset:2048
s_mov_b32 s37, 589824
v_mfma_f32_16x16x32_bf16 a[224:227], a[12:15], a[100:103], 0
s_sub_u32 s65, s65, s44
v_mfma_f32_16x16x32_bf16 a[228:231], a[16:19], a[100:103], 0
v_lshl_add_u32 v48, v19, 2, s32
v_mfma_f32_16x16x32_bf16 a[232:235], a[20:23], a[100:103], 0
v_xor_b32 v17, 229440, v17
s_mov_b32 m0, s49
v_mul_u32_u24 v49, 57, v48
v_mfma_f32_16x16x32_bf16 a[236:239], a[24:27], a[100:103], 0
v_lshrrev_b32 v49, 9, v49
v_mfma_f32_16x16x32_bf16 a[240:243], a[28:31], a[100:103], 0
s_waitcnt lgkmcnt(10)
buffer_load_dwordx4 v4, s[12:15], s37 offen lds
v_mul_u32_u24 v50, 9, v49
v_mfma_f32_16x16x32_bf16 v[88:91], a[68:71], a[0:3], 0
global_load_dwordx4 a[100:103], v[20:21], off offset:0
v_sub_u32 v48, v48, v50
v_mfma_f32_16x16x32_bf16 v[92:95], a[68:71], a[4:7], 0
ds_read_b128 a[56:59], v18 offset:0
v_cmp_eq_u32 vcc, 0, v49
v_mfma_f32_16x16x32_bf16 v[96:99], a[68:71], a[8:11], 0
buffer_load_dwordx4 v5, s[12:15], s37 offen offset:1024 lds
v_mov_b32 v50, s65
v_mfma_f32_16x16x32_bf16 v[100:103], a[68:71], a[12:15], 0
s_nop 0
v_mfma_f32_16x16x32_bf16 v[104:107], a[68:71], a[16:19], 0
buffer_load_dwordx4 v6, s[12:15], s37 offen offset:2048 lds
v_cndmask_b32_e64 v50, v50, 0, vcc
v_mfma_f32_16x16x32_bf16 v[108:111], a[68:71], a[20:23], 0
v_add_u32 v48, v48, v50
v_mfma_f32_16x16x32_bf16 v[112:115], a[68:71], a[24:27], 0
s_waitcnt vmcnt(10)
v_mfma_f32_16x16x32_bf16 v[116:119], a[68:71], a[28:31], 0
ds_read_b64_tr_b16 a[68:69], v10 offset:36864
buffer_load_dwordx4 v7, s[12:15], s37 offen offset:3072 lds
v_cmp_lt_u32 vcc, 8, v48
v_mfma_f32_16x16x32_bf16 v[152:155], a[76:79], a[0:3], 0
ds_read_b64_tr_b16 a[70:71], v10 offset:37376
v_subrev_u32 v50, 9, v48
v_mfma_f32_16x16x32_bf16 v[156:159], a[76:79], a[4:7], 0
ds_read_b128 a[60:63], v18 offset:2048
v_lshlrev_b32 v49, 3, v49
v_mfma_f32_16x16x32_bf16 a[188:191], a[76:79], a[8:11], 0
v_xor_b32 v18, 229440, v18
v_cndmask_b32 v48, v48, v50, vcc
v_mfma_f32_16x16x32_bf16 a[192:195], a[76:79], a[12:15], 0
s_waitcnt lgkmcnt(14)
s_add_u32 m0, m0, 4096
v_bfe_u32 v49, s75, v49, 8
v_mfma_f32_16x16x32_bf16 a[196:199], a[76:79], a[16:19], 0
buffer_load_dwordx4 v4, s[16:19], s37 offen lds
s_mul_i32 s45, s35, 36
v_mfma_f32_16x16x32_bf16 a[200:203], a[76:79], a[20:23], 0
v_mad_u32_u24 v48, v49, 9, v48
v_mfma_f32_16x16x32_bf16 a[204:207], a[76:79], a[24:27], 0
buffer_load_dwordx4 v5, s[16:19], s37 offen offset:1024 lds
v_add_u32 v48, s45, v48
v_mfma_f32_16x16x32_bf16 a[208:211], a[76:79], a[28:31], 0
ds_read_b64_tr_b16 a[76:77], v11 offset:36864
v_mul_u32_u24 v48, 36864, v48
v_mfma_f32_16x16x32_bf16 a[124:127], a[84:87], a[0:3], 0
ds_read_b64_tr_b16 a[78:79], v11 offset:37376
s_mul_i32 s51, s34, 331776
v_mfma_f32_16x16x32_bf16 a[128:131], a[84:87], a[4:7], 0
buffer_load_dwordx4 v6, s[16:19], s37 offen offset:2048 lds
v_readlane_b32 s66, v48, 0
v_mfma_f32_16x16x32_bf16 a[132:135], a[84:87], a[8:11], 0
v_mfma_f32_16x16x32_bf16 a[136:139], a[84:87], a[12:15], 0
buffer_load_dwordx4 v7, s[16:19], s37 offen offset:3072 lds
v_readlane_b32 s67, v48, 1
v_mfma_f32_16x16x32_bf16 a[140:143], a[84:87], a[16:19], 0
v_readlane_b32 s68, v48, 2
v_mfma_f32_16x16x32_bf16 a[144:147], a[84:87], a[20:23], 0
v_readlane_b32 s69, v48, 3
v_mfma_f32_16x16x32_bf16 a[148:151], a[84:87], a[24:27], 0
s_add_u32 s37, s37, 294912
v_readlane_b32 s70, v48, 4
v_mfma_f32_16x16x32_bf16 a[152:155], a[84:87], a[28:31], 0
ds_read_b64_tr_b16 a[84:85], v12 offset:36864
v_readlane_b32 s71, v48, 5
v_mfma_f32_16x16x32_bf16 a[156:159], a[92:95], a[0:3], 0
ds_read_b64_tr_b16 a[86:87], v12 offset:37376
s_mov_b32 s39, 256
v_mfma_f32_16x16x32_bf16 a[160:163], a[92:95], a[4:7], 0
v_mfma_f32_16x16x32_bf16 a[164:167], a[92:95], a[8:11], 0
v_mfma_f32_16x16x32_bf16 a[168:171], a[92:95], a[12:15], 0
s_mov_b32 s38, 1179648
v_mfma_f32_16x16x32_bf16 a[172:175], a[92:95], a[16:19], 0
v_mfma_f32_16x16x32_bf16 a[176:179], a[92:95], a[20:23], 0
v_mfma_f32_16x16x32_bf16 a[180:183], a[92:95], a[24:27], 0
v_mfma_f32_16x16x32_bf16 a[184:187], a[92:95], a[28:31], 0
s_waitcnt lgkmcnt(4)
v_mfma_f32_16x16x32_bf16 v[56:59], a[64:67], a[32:35], v[56:59]
ds_read_b64_tr_b16 a[92:93], v13 offset:36864
v_mfma_f32_16x16x32_bf16 v[60:63], a[64:67], a[36:39], v[60:63]
ds_read_b64_tr_b16 a[94:95], v13 offset:37376
v_mfma_f32_16x16x32_bf16 v[64:67], a[64:67], a[40:43], v[64:67]
s_mov_b32 m0, s50
v_mfma_f32_16x16x32_bf16 v[68:71], a[64:67], a[44:47], v[68:71]
v_mfma_f32_16x16x32_bf16 v[72:75], a[64:67], a[48:51], v[72:75]
buffer_load_dwordx4 v4, s[12:15], s37 offen lds
v_mfma_f32_16x16x32_bf16 v[76:79], a[64:67], a[52:55], v[76:79]
v_mfma_f32_16x16x32_bf16 v[80:83], a[64:67], a[56:59], v[80:83]
s_waitcnt vmcnt(5)
s_barrier
v_mfma_f32_16x16x32_bf16 v[84:87], a[64:67], a[60:63], v[84:87]
ds_read_b64_tr_b16 a[64:65], v10 offset:0
v_mfma_f32_16x16x32_bf16 v[120:123], a[72:75], a[32:35], v[120:123]
ds_read_b64_tr_b16 a[66:67], v10 offset:512
v_readlane_b32 s72, v48, 6
v_mfma_f32_16x16x32_bf16 v[124:127], a[72:75], a[36:39], v[124:127]
buffer_load_dwordx4 v5, s[12:15], s37 offen offset:1024 lds
v_readlane_b32 s73, v48, 7
v_mfma_f32_16x16x32_bf16 v[128:131], a[72:75], a[40:43], v[128:131]
ds_read_b128 a[0:3], v15 offset:0
v_readlane_b32 s100, v48, 8
v_mfma_f32_16x16x32_bf16 v[132:135], a[72:75], a[44:47], v[132:135]
buffer_load_dwordx4 v6, s[12:15], s37 offen offset:2048 lds
s_bfe_u32 s44, s2, 0x10002
v_mfma_f32_16x16x32_bf16 v[136:139], a[72:75], a[48:51], v[136:139]
s_mul_i32 s44, s44, 576
v_mfma_f32_16x16x32_bf16 v[140:143], a[72:75], a[52:55], v[140:143]
buffer_load_dwordx4 v7, s[12:15], s37 offen offset:3072 lds
s_mul_i32 s45, s35, 1152
v_mfma_f32_16x16x32_bf16 v[144:147], a[72:75], a[56:59], v[144:147]
ds_read_b128 a[4:7], v15 offset:2048
s_add_u32 s44, s44, s45
v_mfma_f32_16x16x32_bf16 v[148:151], a[72:75], a[60:63], v[148:151]
ds_read_b64_tr_b16 a[72:73], v11 offset:0
s_lshr_b32 s45, s2, 3
v_mfma_f32_16x16x32_bf16 v[160:163], a[80:83], a[32:35], v[160:163]
ds_read_b64_tr_b16 a[74:75], v11 offset:512
s_mul_i32 s45, s45, 18
v_mfma_f32_16x16x32_bf16 v[164:167], a[80:83], a[36:39], v[164:167]
s_waitcnt lgkmcnt(6)
s_add_u32 m0, m0, 4096
s_add_u32 s44, s44, s45
v_mfma_f32_16x16x32_bf16 v[168:171], a[80:83], a[40:43], v[168:171]
v_xor_b32 v15, 64, v15
s_mul_i32 s44, s44, 1152
v_mfma_f32_16x16x32_bf16 v[172:175], a[80:83], a[44:47], v[172:175]
buffer_load_dwordx4 v4, s[16:19], s37 offen lds
v_mfma_f32_16x16x32_bf16 v[176:179], a[80:83], a[48:51], v[176:179]
s_mul_i32 s45, s32, 5248
v_mfma_f32_16x16x32_bf16 v[180:183], a[80:83], a[52:55], v[180:183]
s_add_u32 s44, s44, s45
v_mfma_f32_16x16x32_bf16 v[184:187], a[80:83], a[56:59], v[184:187]
buffer_load_dwordx4 v5, s[16:19], s37 offen offset:1024 lds
v_lshl_add_u32 v31, v19, 7, s44
v_mfma_f32_16x16x32_bf16 v[188:191], a[80:83], a[60:63], v[188:191]
ds_read_b64_tr_b16 a[80:81], v12 offset:0
v_cmp_gt_u32 vcc, 41, v19
v_mfma_f32_16x16x32_bf16 v[192:195], a[88:91], a[32:35], v[192:195]
ds_read_b64_tr_b16 a[82:83], v12 offset:512
v_mov_b32 v49, 1073741824
v_mfma_f32_16x16x32_bf16 v[196:199], a[88:91], a[36:39], v[196:199]
ds_read_b128 a[8:11], v16 offset:0
s_lshl_b32 s44, s2, 3
v_mfma_f32_16x16x32_bf16 v[200:203], a[88:91], a[40:43], v[200:203]
buffer_load_dwordx4 v6, s[16:19], s37 offen offset:2048 lds
s_lshr_b32 s45, s32, 1
v_mfma_f32_16x16x32_bf16 v[204:207], a[88:91], a[44:47], v[204:207]
ds_read_b128 a[12:15], v16 offset:2048
v_cndmask_b32 v31, v49, v31, vcc
v_mfma_f32_16x16x32_bf16 v[208:211], a[88:91], a[48:51], v[208:211]
buffer_load_dwordx4 v7, s[16:19], s37 offen offset:3072 lds
s_bitcmp1_b32 s2, 2
s_mov_b32 s46, 663552
s_cselect_b32 s46, 4294303744, s46
v_mfma_f32_16x16x32_bf16 v[212:215], a[88:91], a[52:55], v[212:215]
v_add_u32 v29, s46, v31
v_mfma_f32_16x16x32_bf16 v[216:219], a[88:91], a[56:59], v[216:219]
s_lshl_b32 s45, s45, 2
v_mfma_f32_16x16x32_bf16 v[220:223], a[88:91], a[60:63], v[220:223]
ds_read_b64_tr_b16 a[88:89], v13 offset:0
v_mfma_f32_16x16x32_bf16 v[224:227], a[96:99], a[32:35], v[224:227]
ds_read_b64_tr_b16 a[90:91], v13 offset:512
s_add_u32 s44, s44, s45
v_mfma_f32_16x16x32_bf16 v[228:231], a[96:99], a[36:39], v[228:231]
v_xor_b32 v14, 229376, v14
v_add_u32 v48, s44, v19
v_mfma_f32_16x16x32_bf16 v[232:235], a[96:99], a[40:43], v[232:235]
v_xor_b32 v16, 64, v16
v_cmp_gt_u32 vcc, 4, v19
v_mfma_f32_16x16x32_bf16 v[236:239], a[96:99], a[44:47], v[236:239]
s_add_u32 s37, s37, 294912
v_lshlrev_b32 v48, 12, v48
v_mfma_f32_16x16x32_bf16 v[240:243], a[96:99], a[48:51], v[240:243]
ds_read_b128 a[16:19], v17 offset:0
s_nop 0
v_mfma_f32_16x16x32_bf16 v[244:247], a[96:99], a[52:55], v[244:247]
s_mov_b32 m0, s43
v_cndmask_b32 v32, v49, v48, vcc
v_mfma_f32_16x16x32_bf16 v[248:251], a[96:99], a[56:59], v[248:251]
buffer_load_dwordx4 v0, s[8:11], s39 offen lds
s_mul_i32 s44, s34, 2304
v_mfma_f32_16x16x32_bf16 v[252:255], a[96:99], a[60:63], v[252:255]
s_waitcnt vmcnt(36)
s_and_b32 s45, s34, 1
v_mfma_f32_16x16x32_bf16 a[212:215], a[32:35], a[104:107], a[212:215]
ds_read_b64_tr_b16 a[96:97], v14 offset:16384
s_lshl_b32 s46, s45, 8
v_mfma_f32_16x16x32_bf16 a[216:219], a[36:39], a[104:107], a[216:219]
ds_read_b64_tr_b16 a[98:99], v14 offset:16640
s_add_u32 s46, s46, s44
v_mfma_f32_16x16x32_bf16 a[220:223], a[40:43], a[104:107], a[220:223]
ds_read_b128 a[20:23], v17 offset:2048
v_mfma_f32_16x16x32_bf16 a[224:227], a[44:47], a[104:107], a[224:227]
buffer_load_dwordx4 v1, s[8:11], s39 offen offset:1024 lds
s_lshl_b32 s47, s32, 9
v_mfma_f32_16x16x32_bf16 a[228:231], a[48:51], a[104:107], a[228:231]
buffer_load_dwordx4 v2, s[8:11], s39 offen offset:2048 lds
s_add_u32 s46, s46, s47
v_mfma_f32_16x16x32_bf16 a[232:235], a[52:55], a[104:107], a[232:235]
v_xor_b32 v17, 64, v17
s_xor_b32 s45, s45, 1
v_mfma_f32_16x16x32_bf16 a[236:239], a[56:59], a[104:107], a[236:239]
buffer_load_dwordx4 v3, s[8:11], s39 offen offset:3072 lds
s_lshl_b32 s45, s45, 11
v_mfma_f32_16x16x32_bf16 a[240:243], a[60:63], a[104:107], a[240:243]
s_waitcnt lgkmcnt(15)
s_add_u32 s45, s45, s44
v_mfma_f32_16x16x32_bf16 v[88:91], a[68:71], a[32:35], v[88:91]
global_load_dwordx4 a[104:107], v[20:21], off offset:64
s_lshl_b32 s47, s32, 5
v_mfma_f32_16x16x32_bf16 v[92:95], a[68:71], a[36:39], v[92:95]
ds_read_b128 a[24:27], v18 offset:0
s_add_u32 s45, s45, s47
v_mfma_f32_16x16x32_bf16 v[96:99], a[68:71], a[40:43], v[96:99]
s_mov_b32 m0, s3
v_lshrrev_b32 v48, 4, v19
v_mfma_f32_16x16x32_bf16 v[100:103], a[68:71], a[44:47], v[100:103]
v_lshl_add_u64 v[20:21], 64, 1, v[20:21]
v_mul_u32_u24 v49, 73728, v48
v_mfma_f32_16x16x32_bf16 v[104:107], a[68:71], a[48:51], v[104:107]
buffer_load_dwordx4 v8, s[12:15], s38 offen lds
v_cmp_eq_u32 vcc, 3, v48
v_mfma_f32_16x16x32_bf16 v[108:111], a[68:71], a[52:55], v[108:111]
v_mov_b32 v50, 1073741824
v_mfma_f32_16x16x32_bf16 v[112:115], a[68:71], a[56:59], v[112:115]
s_waitcnt vmcnt(14)
v_mfma_f32_16x16x32_bf16 v[116:119], a[68:71], a[60:63], v[116:119]
ds_read_b64_tr_b16 a[68:69], v10 offset:4096
v_and_b32 v51, 15, v19
v_mfma_f32_16x16x32_bf16 v[152:155], a[76:79], a[32:35], v[152:155]
ds_read_b64_tr_b16 a[70:71], v10 offset:4608
v_cndmask_b32 v49, v49, v50, vcc
v_mfma_f32_16x16x32_bf16 v[156:159], a[76:79], a[36:39], v[156:159]
ds_read_b128 a[28:31], v18 offset:2048
v_lshl_add_u32 v52, v51, 3, v49
v_mfma_f32_16x16x32_bf16 a[188:191], a[76:79], a[40:43], a[188:191]
v_xor_b32 v18, 64, v18
v_add_u32 v34, s46, v52
v_mfma_f32_16x16x32_bf16 a[192:195], a[76:79], a[44:47], a[192:195]
s_add_u32 m0, m0, 4096
v_and_b32 v52, 3, v19
v_mfma_f32_16x16x32_bf16 a[196:199], a[76:79], a[48:51], a[196:199]
buffer_load_dwordx4 v8, s[16:19], s38 offen lds
v_lshlrev_b32 v37, 7, v52
v_mfma_f32_16x16x32_bf16 a[200:203], a[76:79], a[52:55], a[200:203]
s_add_u32 s38, s38, 589824
v_lshl_add_u32 v49, v52, 3, v49
v_mfma_f32_16x16x32_bf16 a[204:207], a[76:79], a[56:59], a[204:207]
v_bfe_u32 v52, v19, 2, 1
v_mfma_f32_16x16x32_bf16 a[208:211], a[76:79], a[60:63], a[208:211]
ds_read_b64_tr_b16 a[76:77], v11 offset:4096
v_lshl_add_u32 v49, v52, 7, v49
v_mfma_f32_16x16x32_bf16 a[124:127], a[84:87], a[32:35], a[124:127]
ds_read_b64_tr_b16 a[78:79], v11 offset:4608
v_bfe_u32 v52, v19, 3, 1
v_mfma_f32_16x16x32_bf16 a[128:131], a[84:87], a[36:39], a[128:131]
s_add_u32 s39, s39, 128
v_mul_u32_u24 v52, 36864, v52
v_mfma_f32_16x16x32_bf16 a[132:135], a[84:87], a[40:43], a[132:135]
v_mfma_f32_16x16x32_bf16 a[136:139], a[84:87], a[44:47], a[136:139]
s_cmp_eq_u32 s39, 1152
s_cselect_b32 s39, 1073741824, s39
v_add3_u32 v35, v49, v52, s45
v_mfma_f32_16x16x32_bf16 a[140:143], a[84:87], a[48:51], a[140:143]
v_lshlrev_b32 v48, 15, v48
v_mfma_f32_16x16x32_bf16 a[144:147], a[84:87], a[52:55], a[144:147]
s_lshl_b32 s44, s33, 2
v_mfma_f32_16x16x32_bf16 a[148:151], a[84:87], a[56:59], a[148:151]
s_xor_b32 s43, s43, 229376
s_add_u32 s44, s44, s32
v_mfma_f32_16x16x32_bf16 a[152:155], a[84:87], a[60:63], a[152:155]
ds_read_b64_tr_b16 a[84:85], v12 offset:4096
v_cndmask_b32 v48, v48, v50, vcc
v_mfma_f32_16x16x32_bf16 a[156:159], a[92:95], a[32:35], a[156:159]
ds_read_b64_tr_b16 a[86:87], v12 offset:4608
s_lshl_b32 s44, s44, 9
v_mfma_f32_16x16x32_bf16 a[160:163], a[92:95], a[36:39], a[160:163]
s_xor_b32 s3, s3, 229376
v_lshl_add_u32 v48, v51, 4, v48
v_mfma_f32_16x16x32_bf16 a[164:167], a[92:95], a[40:43], a[164:167]
v_add_u32 v36, s44, v48
v_mfma_f32_16x16x32_bf16 a[168:171], a[92:95], a[44:47], a[168:171]
v_mfma_f32_16x16x32_bf16 a[172:175], a[92:95], a[48:51], a[172:175]
v_mfma_f32_16x16x32_bf16 a[176:179], a[92:95], a[52:55], a[176:179]
v_mfma_f32_16x16x32_bf16 a[180:183], a[92:95], a[56:59], a[180:183]
v_mfma_f32_16x16x32_bf16 a[184:187], a[92:95], a[60:63], a[184:187]
s_waitcnt vmcnt(34)
v_readfirstlane_b32 s62, v33
s_nop 0
s_cmp_lg_u32 s62, 0
s_cbranch_scc0 L_nonce_h
L_nonce_h_r:
.p2align 6
L_g1_h:
s_waitcnt lgkmcnt(4)
v_mfma_f32_16x16x32_bf16 v[56:59], a[64:67], a[0:3], v[56:59]
ds_read_b64_tr_b16 a[92:93], v13 offset:4096
v_mfma_f32_16x16x32_bf16 v[60:63], a[64:67], a[4:7], v[60:63]
ds_read_b64_tr_b16 a[94:95], v13 offset:4608
v_mfma_f32_16x16x32_bf16 v[64:67], a[64:67], a[8:11], v[64:67]
s_mov_b32 m0, s49
v_mfma_f32_16x16x32_bf16 v[68:71], a[64:67], a[12:15], v[68:71]
v_mfma_f32_16x16x32_bf16 v[72:75], a[64:67], a[16:19], v[72:75]
v_mfma_f32_16x16x32_bf16 v[76:79], a[64:67], a[20:23], v[76:79]
v_mfma_f32_16x16x32_bf16 v[80:83], a[64:67], a[24:27], v[80:83]
s_waitcnt vmcnt(11)
v_mfma_f32_16x16x32_bf16 v[84:87], a[64:67], a[28:31], v[84:87]
ds_read_b64_tr_b16 a[64:65], v10 offset:32768
v_mfma_f32_16x16x32_bf16 v[120:123], a[72:75], a[0:3], v[120:123]
ds_read_b64_tr_b16 a[66:67], v10 offset:33280
v_mfma_f32_16x16x32_bf16 v[124:127], a[72:75], a[4:7], v[124:127]
buffer_load_dwordx4 v4, s[12:15], s37 offen lds
v_mfma_f32_16x16x32_bf16 v[128:131], a[72:75], a[8:11], v[128:131]
ds_read_b128 a[32:35], v15 offset:0
v_mfma_f32_16x16x32_bf16 v[132:135], a[72:75], a[12:15], v[132:135]
buffer_load_dwordx4 v5, s[12:15], s37 offen offset:1024 lds
v_mfma_f32_16x16x32_bf16 v[136:139], a[72:75], a[16:19], v[136:139]
v_mfma_f32_16x16x32_bf16 v[140:143], a[72:75], a[20:23], v[140:143]
v_mfma_f32_16x16x32_bf16 v[144:147], a[72:75], a[24:27], v[144:147]
ds_read_b128 a[36:39], v15 offset:2048
v_mfma_f32_16x16x32_bf16 v[148:151], a[72:75], a[28:31], v[148:151]
ds_read_b64_tr_b16 a[72:73], v11 offset:32768
v_mfma_f32_16x16x32_bf16 v[160:163], a[80:83], a[0:3], v[160:163]
ds_read_b64_tr_b16 a[74:75], v11 offset:33280
v_mfma_f32_16x16x32_bf16 v[164:167], a[80:83], a[4:7], v[164:167]
buffer_load_dwordx4 v6, s[12:15], s37 offen offset:2048 lds
v_mfma_f32_16x16x32_bf16 v[168:171], a[80:83], a[8:11], v[168:171]
v_xor_b32 v15, 229440, v15
v_mfma_f32_16x16x32_bf16 v[172:175], a[80:83], a[12:15], v[172:175]
buffer_load_dwordx4 v7, s[12:15], s37 offen offset:3072 lds
v_mfma_f32_16x16x32_bf16 v[176:179], a[80:83], a[16:19], v[176:179]
v_mfma_f32_16x16x32_bf16 v[180:183], a[80:83], a[20:23], v[180:183]
v_mfma_f32_16x16x32_bf16 v[184:187], a[80:83], a[24:27], v[184:187]
s_waitcnt lgkmcnt(6)
s_add_u32 m0, m0, 4096
v_mfma_f32_16x16x32_bf16 v[188:191], a[80:83], a[28:31], v[188:191]
ds_read_b64_tr_b16 a[80:81], v12 offset:32768
v_mfma_f32_16x16x32_bf16 v[192:195], a[88:91], a[0:3], v[192:195]
ds_read_b64_tr_b16 a[82:83], v12 offset:33280
v_mfma_f32_16x16x32_bf16 v[196:199], a[88:91], a[4:7], v[196:199]
ds_read_b128 a[40:43], v16 offset:0
v_mfma_f32_16x16x32_bf16 v[200:203], a[88:91], a[8:11], v[200:203]
buffer_load_dwordx4 v4, s[16:19], s37 offen lds
v_mfma_f32_16x16x32_bf16 v[204:207], a[88:91], a[12:15], v[204:207]
ds_read_b128 a[44:47], v16 offset:2048
v_mfma_f32_16x16x32_bf16 v[208:211], a[88:91], a[16:19], v[208:211]
v_mfma_f32_16x16x32_bf16 v[212:215], a[88:91], a[20:23], v[212:215]
v_mfma_f32_16x16x32_bf16 v[216:219], a[88:91], a[24:27], v[216:219]
buffer_load_dwordx4 v5, s[16:19], s37 offen offset:1024 lds
v_mfma_f32_16x16x32_bf16 v[220:223], a[88:91], a[28:31], v[220:223]
ds_read_b64_tr_b16 a[88:89], v13 offset:32768
v_mfma_f32_16x16x32_bf16 v[224:227], a[96:99], a[0:3], v[224:227]
ds_read_b64_tr_b16 a[90:91], v13 offset:33280
v_mfma_f32_16x16x32_bf16 v[228:231], a[96:99], a[4:7], v[228:231]
v_xor_b32 v16, 229440, v16
v_mfma_f32_16x16x32_bf16 v[232:235], a[96:99], a[8:11], v[232:235]
buffer_load_dwordx4 v6, s[16:19], s37 offen offset:2048 lds
v_mfma_f32_16x16x32_bf16 v[236:239], a[96:99], a[12:15], v[236:239]
v_mfma_f32_16x16x32_bf16 v[240:243], a[96:99], a[16:19], v[240:243]
ds_read_b128 a[48:51], v17 offset:0
v_mfma_f32_16x16x32_bf16 v[244:247], a[96:99], a[20:23], v[244:247]
v_mfma_f32_16x16x32_bf16 v[248:251], a[96:99], a[24:27], v[248:251]
buffer_load_dwordx4 v7, s[16:19], s37 offen offset:3072 lds
v_mfma_f32_16x16x32_bf16 v[252:255], a[96:99], a[28:31], v[252:255]
s_waitcnt vmcnt(23)
v_mfma_f32_16x16x32_bf16 a[212:215], a[0:3], a[100:103], a[212:215]
ds_read_b64_tr_b16 a[96:97], v14 offset:18432
v_mfma_f32_16x16x32_bf16 a[216:219], a[4:7], a[100:103], a[216:219]
ds_read_b64_tr_b16 a[98:99], v14 offset:18688
v_mfma_f32_16x16x32_bf16 a[220:223], a[8:11], a[100:103], a[220:223]
ds_read_b128 a[52:55], v17 offset:2048
v_mfma_f32_16x16x32_bf16 a[224:227], a[12:15], a[100:103], a[224:227]
s_add_u32 s37, s37, 294912
v_mfma_f32_16x16x32_bf16 a[228:231], a[16:19], a[100:103], a[228:231]
v_mfma_f32_16x16x32_bf16 a[232:235], a[20:23], a[100:103], a[232:235]
v_xor_b32 v17, 229440, v17
v_mfma_f32_16x16x32_bf16 a[236:239], a[24:27], a[100:103], a[236:239]
v_mfma_f32_16x16x32_bf16 a[240:243], a[28:31], a[100:103], a[240:243]
s_waitcnt lgkmcnt(15)
v_mfma_f32_16x16x32_bf16 v[88:91], a[68:71], a[0:3], v[88:91]
global_load_dwordx4 a[100:103], v[20:21], off offset:0
v_mfma_f32_16x16x32_bf16 v[92:95], a[68:71], a[4:7], v[92:95]
ds_read_b128 a[56:59], v18 offset:0
v_mfma_f32_16x16x32_bf16 v[96:99], a[68:71], a[8:11], v[96:99]
v_mfma_f32_16x16x32_bf16 v[100:103], a[68:71], a[12:15], v[100:103]
v_mfma_f32_16x16x32_bf16 v[104:107], a[68:71], a[16:19], v[104:107]
v_mfma_f32_16x16x32_bf16 v[108:111], a[68:71], a[20:23], v[108:111]
v_mfma_f32_16x16x32_bf16 v[112:115], a[68:71], a[24:27], v[112:115]
s_waitcnt vmcnt(16)
v_mfma_f32_16x16x32_bf16 v[116:119], a[68:71], a[28:31], v[116:119]
ds_read_b64_tr_b16 a[68:69], v10 offset:36864
v_mfma_f32_16x16x32_bf16 v[152:155], a[76:79], a[0:3], v[152:155]
ds_read_b64_tr_b16 a[70:71], v10 offset:37376
v_mfma_f32_16x16x32_bf16 v[156:159], a[76:79], a[4:7], v[156:159]
ds_read_b128 a[60:63], v18 offset:2048
v_mfma_f32_16x16x32_bf16 a[188:191], a[76:79], a[8:11], a[188:191]
v_xor_b32 v18, 229440, v18
v_mfma_f32_16x16x32_bf16 a[192:195], a[76:79], a[12:15], a[192:195]
v_mfma_f32_16x16x32_bf16 a[196:199], a[76:79], a[16:19], a[196:199]
v_mfma_f32_16x16x32_bf16 a[200:203], a[76:79], a[20:23], a[200:203]
v_mfma_f32_16x16x32_bf16 a[204:207], a[76:79], a[24:27], a[204:207]
v_mfma_f32_16x16x32_bf16 a[208:211], a[76:79], a[28:31], a[208:211]
ds_read_b64_tr_b16 a[76:77], v11 offset:36864
v_mfma_f32_16x16x32_bf16 a[124:127], a[84:87], a[0:3], a[124:127]
ds_read_b64_tr_b16 a[78:79], v11 offset:37376
v_mfma_f32_16x16x32_bf16 a[128:131], a[84:87], a[4:7], a[128:131]
v_mfma_f32_16x16x32_bf16 a[132:135], a[84:87], a[8:11], a[132:135]
v_mfma_f32_16x16x32_bf16 a[136:139], a[84:87], a[12:15], a[136:139]
v_mfma_f32_16x16x32_bf16 a[140:143], a[84:87], a[16:19], a[140:143]
v_mfma_f32_16x16x32_bf16 a[144:147], a[84:87], a[20:23], a[144:147]
v_mfma_f32_16x16x32_bf16 a[148:151], a[84:87], a[24:27], a[148:151]
v_mfma_f32_16x16x32_bf16 a[152:155], a[84:87], a[28:31], a[152:155]
ds_read_b64_tr_b16 a[84:85], v12 offset:36864
v_mfma_f32_16x16x32_bf16 a[156:159], a[92:95], a[0:3], a[156:159]
ds_read_b64_tr_b16 a[86:87], v12 offset:37376
v_mfma_f32_16x16x32_bf16 a[160:163], a[92:95], a[4:7], a[160:163]
v_mfma_f32_16x16x32_bf16 a[164:167], a[92:95], a[8:11], a[164:167]
v_mfma_f32_16x16x32_bf16 a[168:171], a[92:95], a[12:15], a[168:171]
v_mfma_f32_16x16x32_bf16 a[172:175], a[92:95], a[16:19], a[172:175]
v_mfma_f32_16x16x32_bf16 a[176:179], a[92:95], a[20:23], a[176:179]
v_mfma_f32_16x16x32_bf16 a[180:183], a[92:95], a[24:27], a[180:183]
v_mfma_f32_16x16x32_bf16 a[184:187], a[92:95], a[28:31], a[184:187]
s_waitcnt lgkmcnt(4)
v_mfma_f32_16x16x32_bf16 v[56:59], a[64:67], a[32:35], v[56:59]
ds_read_b64_tr_b16 a[92:93], v13 offset:36864
v_mfma_f32_16x16x32_bf16 v[60:63], a[64:67], a[36:39], v[60:63]
ds_read_b64_tr_b16 a[94:95], v13 offset:37376
v_mfma_f32_16x16x32_bf16 v[64:67], a[64:67], a[40:43], v[64:67]
s_mov_b32 m0, s50
v_mfma_f32_16x16x32_bf16 v[68:71], a[64:67], a[44:47], v[68:71]
v_mfma_f32_16x16x32_bf16 v[72:75], a[64:67], a[48:51], v[72:75]
buffer_load_dwordx4 v4, s[12:15], s37 offen lds
v_mfma_f32_16x16x32_bf16 v[76:79], a[64:67], a[52:55], v[76:79]
v_mfma_f32_16x16x32_bf16 v[80:83], a[64:67], a[56:59], v[80:83]
s_waitcnt vmcnt(6)
s_barrier
v_mfma_f32_16x16x32_bf16 v[84:87], a[64:67], a[60:63], v[84:87]
ds_read_b64_tr_b16 a[64:65], v10 offset:0
v_mfma_f32_16x16x32_bf16 v[120:123], a[72:75], a[32:35], v[120:123]
ds_read_b64_tr_b16 a[66:67], v10 offset:512
v_mfma_f32_16x16x32_bf16 v[124:127], a[72:75], a[36:39], v[124:127]
buffer_load_dwordx4 v5, s[12:15], s37 offen offset:1024 lds
v_mfma_f32_16x16x32_bf16 v[128:131], a[72:75], a[40:43], v[128:131]
ds_read_b128 a[0:3], v15 offset:0
v_mfma_f32_16x16x32_bf16 v[132:135], a[72:75], a[44:47], v[132:135]
buffer_load_dwordx4 v6, s[12:15], s37 offen offset:2048 lds
v_mfma_f32_16x16x32_bf16 v[136:139], a[72:75], a[48:51], v[136:139]
v_mfma_f32_16x16x32_bf16 v[140:143], a[72:75], a[52:55], v[140:143]
buffer_load_dwordx4 v7, s[12:15], s37 offen offset:3072 lds
v_mfma_f32_16x16x32_bf16 v[144:147], a[72:75], a[56:59], v[144:147]
ds_read_b128 a[4:7], v15 offset:2048
v_mfma_f32_16x16x32_bf16 v[148:151], a[72:75], a[60:63], v[148:151]
ds_read_b64_tr_b16 a[72:73], v11 offset:0
v_mfma_f32_16x16x32_bf16 v[160:163], a[80:83], a[32:35], v[160:163]
ds_read_b64_tr_b16 a[74:75], v11 offset:512
v_mfma_f32_16x16x32_bf16 v[164:167], a[80:83], a[36:39], v[164:167]
s_waitcnt lgkmcnt(6)
s_add_u32 m0, m0, 4096
v_mfma_f32_16x16x32_bf16 v[168:171], a[80:83], a[40:43], v[168:171]
v_xor_b32 v15, 64, v15
v_mfma_f32_16x16x32_bf16 v[172:175], a[80:83], a[44:47], v[172:175]
buffer_load_dwordx4 v4, s[16:19], s37 offen lds
v_mfma_f32_16x16x32_bf16 v[176:179], a[80:83], a[48:51], v[176:179]
v_mfma_f32_16x16x32_bf16 v[180:183], a[80:83], a[52:55], v[180:183]
v_mfma_f32_16x16x32_bf16 v[184:187], a[80:83], a[56:59], v[184:187]
buffer_load_dwordx4 v5, s[16:19], s37 offen offset:1024 lds
v_mfma_f32_16x16x32_bf16 v[188:191], a[80:83], a[60:63], v[188:191]
ds_read_b64_tr_b16 a[80:81], v12 offset:0
v_mfma_f32_16x16x32_bf16 v[192:195], a[88:91], a[32:35], v[192:195]
ds_read_b64_tr_b16 a[82:83], v12 offset:512
v_mfma_f32_16x16x32_bf16 v[196:199], a[88:91], a[36:39], v[196:199]
ds_read_b128 a[8:11], v16 offset:0
v_mfma_f32_16x16x32_bf16 v[200:203], a[88:91], a[40:43], v[200:203]
buffer_load_dwordx4 v6, s[16:19], s37 offen offset:2048 lds
v_mfma_f32_16x16x32_bf16 v[204:207], a[88:91], a[44:47], v[204:207]
ds_read_b128 a[12:15], v16 offset:2048
v_mfma_f32_16x16x32_bf16 v[208:211], a[88:91], a[48:51], v[208:211]
buffer_load_dwordx4 v7, s[16:19], s37 offen offset:3072 lds
v_mfma_f32_16x16x32_bf16 v[212:215], a[88:91], a[52:55], v[212:215]
v_mfma_f32_16x16x32_bf16 v[216:219], a[88:91], a[56:59], v[216:219]
v_mfma_f32_16x16x32_bf16 v[220:223], a[88:91], a[60:63], v[220:223]
ds_read_b64_tr_b16 a[88:89], v13 offset:0
v_mfma_f32_16x16x32_bf16 v[224:227], a[96:99], a[32:35], v[224:227]
ds_read_b64_tr_b16 a[90:91], v13 offset:512
v_mfma_f32_16x16x32_bf16 v[228:231], a[96:99], a[36:39], v[228:231]
v_xor_b32 v14, 229376, v14
v_mfma_f32_16x16x32_bf16 v[232:235], a[96:99], a[40:43], v[232:235]
v_xor_b32 v16, 64, v16
v_mfma_f32_16x16x32_bf16 v[236:239], a[96:99], a[44:47], v[236:239]
s_add_u32 s37, s37, 294912
v_mfma_f32_16x16x32_bf16 v[240:243], a[96:99], a[48:51], v[240:243]
ds_read_b128 a[16:19], v17 offset:0
v_mfma_f32_16x16x32_bf16 v[244:247], a[96:99], a[52:55], v[244:247]
s_mov_b32 m0, s43
v_mfma_f32_16x16x32_bf16 v[248:251], a[96:99], a[56:59], v[248:251]
buffer_load_dwordx4 v0, s[8:11], s39 offen lds
v_mfma_f32_16x16x32_bf16 v[252:255], a[96:99], a[60:63], v[252:255]
s_waitcnt vmcnt(20)
v_mfma_f32_16x16x32_bf16 a[212:215], a[32:35], a[104:107], a[212:215]
ds_read_b64_tr_b16 a[96:97], v14 offset:16384
v_mfma_f32_16x16x32_bf16 a[216:219], a[36:39], a[104:107], a[216:219]
ds_read_b64_tr_b16 a[98:99], v14 offset:16640
v_mfma_f32_16x16x32_bf16 a[220:223], a[40:43], a[104:107], a[220:223]
ds_read_b128 a[20:23], v17 offset:2048
v_mfma_f32_16x16x32_bf16 a[224:227], a[44:47], a[104:107], a[224:227]
buffer_load_dwordx4 v1, s[8:11], s39 offen offset:1024 lds
v_mfma_f32_16x16x32_bf16 a[228:231], a[48:51], a[104:107], a[228:231]
buffer_load_dwordx4 v2, s[8:11], s39 offen offset:2048 lds
v_mfma_f32_16x16x32_bf16 a[232:235], a[52:55], a[104:107], a[232:235]
v_xor_b32 v17, 64, v17
v_mfma_f32_16x16x32_bf16 a[236:239], a[56:59], a[104:107], a[236:239]
buffer_load_dwordx4 v3, s[8:11], s39 offen offset:3072 lds
v_mfma_f32_16x16x32_bf16 a[240:243], a[60:63], a[104:107], a[240:243]
s_waitcnt lgkmcnt(15)
v_mfma_f32_16x16x32_bf16 v[88:91], a[68:71], a[32:35], v[88:91]
global_load_dwordx4 a[104:107], v[20:21], off offset:64
v_mfma_f32_16x16x32_bf16 v[92:95], a[68:71], a[36:39], v[92:95]
ds_read_b128 a[24:27], v18 offset:0
v_mfma_f32_16x16x32_bf16 v[96:99], a[68:71], a[40:43], v[96:99]
s_mov_b32 m0, s3
v_mfma_f32_16x16x32_bf16 v[100:103], a[68:71], a[44:47], v[100:103]
v_lshl_add_u64 v[20:21], 64, 1, v[20:21]
v_mfma_f32_16x16x32_bf16 v[104:107], a[68:71], a[48:51], v[104:107]
buffer_load_dwordx4 v8, s[12:15], s38 offen lds
v_mfma_f32_16x16x32_bf16 v[108:111], a[68:71], a[52:55], v[108:111]
v_mfma_f32_16x16x32_bf16 v[112:115], a[68:71], a[56:59], v[112:115]
s_waitcnt vmcnt(15)
v_mfma_f32_16x16x32_bf16 v[116:119], a[68:71], a[60:63], v[116:119]
ds_read_b64_tr_b16 a[68:69], v10 offset:4096
v_mfma_f32_16x16x32_bf16 v[152:155], a[76:79], a[32:35], v[152:155]
ds_read_b64_tr_b16 a[70:71], v10 offset:4608
v_mfma_f32_16x16x32_bf16 v[156:159], a[76:79], a[36:39], v[156:159]
ds_read_b128 a[28:31], v18 offset:2048
v_mfma_f32_16x16x32_bf16 a[188:191], a[76:79], a[40:43], a[188:191]
v_xor_b32 v18, 64, v18
v_mfma_f32_16x16x32_bf16 a[192:195], a[76:79], a[44:47], a[192:195]
s_add_u32 m0, m0, 4096
v_mfma_f32_16x16x32_bf16 a[196:199], a[76:79], a[48:51], a[196:199]
buffer_load_dwordx4 v8, s[16:19], s38 offen lds
v_mfma_f32_16x16x32_bf16 a[200:203], a[76:79], a[52:55], a[200:203]
s_add_u32 s38, s38, 589824
v_mfma_f32_16x16x32_bf16 a[204:207], a[76:79], a[56:59], a[204:207]
v_mfma_f32_16x16x32_bf16 a[208:211], a[76:79], a[60:63], a[208:211]
ds_read_b64_tr_b16 a[76:77], v11 offset:4096
v_mfma_f32_16x16x32_bf16 a[124:127], a[84:87], a[32:35], a[124:127]
ds_read_b64_tr_b16 a[78:79], v11 offset:4608
v_mfma_f32_16x16x32_bf16 a[128:131], a[84:87], a[36:39], a[128:131]
s_add_u32 s39, s39, 128
v_mfma_f32_16x16x32_bf16 a[132:135], a[84:87], a[40:43], a[132:135]
v_mfma_f32_16x16x32_bf16 a[136:139], a[84:87], a[44:47], a[136:139]
s_cmp_eq_u32 s39, 1152
s_cselect_b32 s39, 1073741824, s39
v_mfma_f32_16x16x32_bf16 a[140:143], a[84:87], a[48:51], a[140:143]
v_mfma_f32_16x16x32_bf16 a[144:147], a[84:87], a[52:55], a[144:147]
v_mfma_f32_16x16x32_bf16 a[148:151], a[84:87], a[56:59], a[148:151]
s_xor_b32 s43, s43, 229376
v_mfma_f32_16x16x32_bf16 a[152:155], a[84:87], a[60:63], a[152:155]
ds_read_b64_tr_b16 a[84:85], v12 offset:4096
v_mfma_f32_16x16x32_bf16 a[156:159], a[92:95], a[32:35], a[156:159]
ds_read_b64_tr_b16 a[86:87], v12 offset:4608
v_mfma_f32_16x16x32_bf16 a[160:163], a[92:95], a[36:39], a[160:163]
s_xor_b32 s3, s3, 229376
v_mfma_f32_16x16x32_bf16 a[164:167], a[92:95], a[40:43], a[164:167]
v_mfma_f32_16x16x32_bf16 a[168:171], a[92:95], a[44:47], a[168:171]
v_mfma_f32_16x16x32_bf16 a[172:175], a[92:95], a[48:51], a[172:175]
v_mfma_f32_16x16x32_bf16 a[176:179], a[92:95], a[52:55], a[176:179]
v_mfma_f32_16x16x32_bf16 a[180:183], a[92:95], a[56:59], a[180:183]
v_mfma_f32_16x16x32_bf16 a[184:187], a[92:95], a[60:63], a[184:187]
s_cmp_eq_u32 s42, s41
s_cbranch_scc1 L_midh
L_mid_rh:
s_sub_u32 s42, s42, 1
s_cbranch_scc0 L_g1_h
s_mov_b32 s37, 21233664
s_mov_b32 s38, 21270528
s_mov_b32 s39, 21463040
s_mov_b32 s42, 21577728
s_waitcnt lgkmcnt(4)
v_mfma_f32_16x16x32_bf16 v[56:59], a[64:67], a[0:3], v[56:59]
ds_read_b64_tr_b16 a[92:93], v13 offset:4096
v_mfma_f32_16x16x32_bf16 v[60:63], a[64:67], a[4:7], v[60:63]
ds_read_b64_tr_b16 a[94:95], v13 offset:4608
buffer_load_dwordx3 v[0:2], v36, s[20:23], s39 offen offset:0 sc1
v_mfma_f32_16x16x32_bf16 v[64:67], a[64:67], a[8:11], v[64:67]
buffer_load_dwordx3 v[4:6], v36, s[20:23], s39 offen offset:256 sc1
v_mfma_f32_16x16x32_bf16 v[68:71], a[64:67], a[12:15], v[68:71]
buffer_load_dwordx2 v[38:39], v34, s[20:23], s37 offen offset:0 sc1
v_mfma_f32_16x16x32_bf16 v[72:75], a[64:67], a[16:19], v[72:75]
buffer_load_dwordx2 v[40:41], v34, s[20:23], s38 offen offset:0 sc1
v_mfma_f32_16x16x32_bf16 v[76:79], a[64:67], a[20:23], v[76:79]
buffer_load_dwordx2 v[42:43], v34, s[20:23], s37 offen offset:128 sc1
v_mfma_f32_16x16x32_bf16 v[80:83], a[64:67], a[24:27], v[80:83]
s_waitcnt vmcnt(16)
buffer_load_dwordx2 v[44:45], v34, s[20:23], s38 offen offset:128 sc1
v_mfma_f32_16x16x32_bf16 v[84:87], a[64:67], a[28:31], v[84:87]
ds_read_b64_tr_b16 a[64:65], v10 offset:32768
buffer_load_dwordx2 v[46:47], v34, s[20:23], s37 offen offset:256 sc1
v_mfma_f32_16x16x32_bf16 v[120:123], a[72:75], a[0:3], v[120:123]
ds_read_b64_tr_b16 a[66:67], v10 offset:33280
buffer_load_dwordx2 v[48:49], v34, s[20:23], s38 offen offset:256 sc1
v_mfma_f32_16x16x32_bf16 v[124:127], a[72:75], a[4:7], v[124:127]
buffer_load_dwordx2 v[50:51], v34, s[20:23], s37 offen offset:384 sc1
v_mfma_f32_16x16x32_bf16 v[128:131], a[72:75], a[8:11], v[128:131]
ds_read_b128 a[32:35], v15 offset:0
buffer_load_dwordx2 v[8:9], v34, s[20:23], s38 offen offset:384 sc1
v_mfma_f32_16x16x32_bf16 v[132:135], a[72:75], a[12:15], v[132:135]
buffer_load_dwordx2 v[32:33], v35, s[20:23], s37 offen sc1
v_mfma_f32_16x16x32_bf16 v[136:139], a[72:75], a[16:19], v[136:139]
buffer_load_dword v23, v37, s[20:23], s42 offen sc1
v_mfma_f32_16x16x32_bf16 v[140:143], a[72:75], a[20:23], v[140:143]
v_mfma_f32_16x16x32_bf16 v[144:147], a[72:75], a[24:27], v[144:147]
ds_read_b128 a[36:39], v15 offset:2048
v_mfma_f32_16x16x32_bf16 v[148:151], a[72:75], a[28:31], v[148:151]
ds_read_b64_tr_b16 a[72:73], v11 offset:32768
v_mfma_f32_16x16x32_bf16 v[160:163], a[80:83], a[0:3], v[160:163]
ds_read_b64_tr_b16 a[74:75], v11 offset:33280
v_mfma_f32_16x16x32_bf16 v[164:167], a[80:83], a[4:7], v[164:167]
s_lshl_b32 s43, s32, 11
s_add_u32 m0, s43, 122880
v_mfma_f32_16x16x32_bf16 v[168:171], a[80:83], a[8:11], v[168:171]
v_xor_b32 v15, 229440, v15
s_mov_b32 s3, 4193280
v_mfma_f32_16x16x32_bf16 v[172:175], a[80:83], a[12:15], v[172:175]
v_mfma_f32_16x16x32_bf16 v[176:179], a[80:83], a[16:19], v[176:179]
v_mov_b32 v20, 0
v_mfma_f32_16x16x32_bf16 v[180:183], a[80:83], a[20:23], v[180:183]
buffer_load_dwordx4 v30, s[24:27], 0 offen lds
v_or_b32 v21, s32, v19
v_mfma_f32_16x16x32_bf16 v[184:187], a[80:83], a[24:27], v[184:187]
v_cmp_eq_u32 vcc, 0, v21
v_mfma_f32_16x16x32_bf16 v[188:191], a[80:83], a[28:31], v[188:191]
ds_read_b64_tr_b16 a[80:81], v12 offset:32768
v_mov_b32 v21, 1073741824
v_mfma_f32_16x16x32_bf16 v[192:195], a[88:91], a[0:3], v[192:195]
ds_read_b64_tr_b16 a[82:83], v12 offset:33280
buffer_load_dwordx4 v30, s[24:27], s3 offen offset:1024 lds
v_mfma_f32_16x16x32_bf16 v[196:199], a[88:91], a[4:7], v[196:199]
ds_read_b128 a[40:43], v16 offset:0
v_mov_b32 v53, 1.0
v_mfma_f32_16x16x32_bf16 v[200:203], a[88:91], a[8:11], v[200:203]
v_cndmask_b32 v21, v21, v20, vcc
v_mfma_f32_16x16x32_bf16 v[204:207], a[88:91], a[12:15], v[204:207]
ds_read_b128 a[44:47], v16 offset:2048
v_mfma_f32_16x16x32_bf16 v[208:211], a[88:91], a[16:19], v[208:211]
s_add_u32 m0, s43, 155648
v_mfma_f32_16x16x32_bf16 v[212:215], a[88:91], a[20:23], v[212:215]
v_mfma_f32_16x16x32_bf16 v[216:219], a[88:91], a[24:27], v[216:219]
v_mfma_f32_16x16x32_bf16 v[220:223], a[88:91], a[28:31], v[220:223]
ds_read_b64_tr_b16 a[88:89], v13 offset:32768
v_mfma_f32_16x16x32_bf16 v[224:227], a[96:99], a[0:3], v[224:227]
ds_read_b64_tr_b16 a[90:91], v13 offset:33280
buffer_load_dwordx4 v30, s[28:31], 0 offen lds
v_mfma_f32_16x16x32_bf16 v[228:231], a[96:99], a[4:7], v[228:231]
v_xor_b32 v16, 229440, v16
v_mfma_f32_16x16x32_bf16 v[232:235], a[96:99], a[8:11], v[232:235]
v_mfma_f32_16x16x32_bf16 v[236:239], a[96:99], a[12:15], v[236:239]
buffer_load_dwordx4 v30, s[28:31], s3 offen offset:1024 lds
v_mfma_f32_16x16x32_bf16 v[240:243], a[96:99], a[16:19], v[240:243]
ds_read_b128 a[48:51], v17 offset:0
v_mfma_f32_16x16x32_bf16 v[244:247], a[96:99], a[20:23], v[244:247]
v_mfma_f32_16x16x32_bf16 v[248:251], a[96:99], a[24:27], v[248:251]
v_mfma_f32_16x16x32_bf16 v[252:255], a[96:99], a[28:31], v[252:255]
s_waitcnt vmcnt(31)
s_add_u32 m0, s49, 65536
v_mfma_f32_16x16x32_bf16 a[212:215], a[0:3], a[100:103], a[212:215]
ds_read_b64_tr_b16 a[96:97], v14 offset:18432
v_mfma_f32_16x16x32_bf16 a[216:219], a[4:7], a[100:103], a[216:219]
ds_read_b64_tr_b16 a[98:99], v14 offset:18688
v_mfma_f32_16x16x32_bf16 a[220:223], a[8:11], a[100:103], a[220:223]
ds_read_b128 a[52:55], v17 offset:2048
v_mfma_f32_16x16x32_bf16 a[224:227], a[12:15], a[100:103], a[224:227]
buffer_load_dwordx4 v24, s[4:7], s66 offen lds
v_mfma_f32_16x16x32_bf16 a[228:231], a[16:19], a[100:103], a[228:231]
v_mfma_f32_16x16x32_bf16 a[232:235], a[20:23], a[100:103], a[232:235]
v_xor_b32 v17, 229440, v17
v_mfma_f32_16x16x32_bf16 a[236:239], a[24:27], a[100:103], a[236:239]
buffer_load_dwordx4 v25, s[4:7], s66 offen offset:1024 lds
v_mfma_f32_16x16x32_bf16 a[240:243], a[28:31], a[100:103], a[240:243]
s_waitcnt lgkmcnt(15)
v_mfma_f32_16x16x32_bf16 v[88:91], a[68:71], a[0:3], v[88:91]
v_mfma_f32_16x16x32_bf16 v[92:95], a[68:71], a[4:7], v[92:95]
ds_read_b128 a[56:59], v18 offset:0
v_mfma_f32_16x16x32_bf16 v[96:99], a[68:71], a[8:11], v[96:99]
buffer_load_dwordx4 v26, s[4:7], s66 offen offset:2048 lds
v_mfma_f32_16x16x32_bf16 v[100:103], a[68:71], a[12:15], v[100:103]
v_mfma_f32_16x16x32_bf16 v[104:107], a[68:71], a[16:19], v[104:107]
v_mfma_f32_16x16x32_bf16 v[108:111], a[68:71], a[20:23], v[108:111]
v_mfma_f32_16x16x32_bf16 v[112:115], a[68:71], a[24:27], v[112:115]
s_waitcnt vmcnt(26)
buffer_load_dwordx4 v27, s[4:7], s66 offen offset:3072 lds
v_mfma_f32_16x16x32_bf16 v[116:119], a[68:71], a[28:31], v[116:119]
ds_read_b64_tr_b16 a[68:69], v10 offset:36864
v_mfma_f32_16x16x32_bf16 v[152:155], a[76:79], a[0:3], v[152:155]
ds_read_b64_tr_b16 a[70:71], v10 offset:37376
v_mfma_f32_16x16x32_bf16 v[156:159], a[76:79], a[4:7], v[156:159]
ds_read_b128 a[60:63], v18 offset:2048
v_mfma_f32_16x16x32_bf16 a[188:191], a[76:79], a[8:11], a[188:191]
v_xor_b32 v18, 229440, v18
v_mfma_f32_16x16x32_bf16 a[192:195], a[76:79], a[12:15], a[192:195]
s_add_u32 m0, m0, 4096
s_add_u32 s66, s66, 18432
v_mfma_f32_16x16x32_bf16 a[196:199], a[76:79], a[16:19], a[196:199]
v_mfma_f32_16x16x32_bf16 a[200:203], a[76:79], a[20:23], a[200:203]
buffer_load_dwordx4 v24, s[4:7], s66 offen lds
v_mfma_f32_16x16x32_bf16 a[204:207], a[76:79], a[24:27], a[204:207]
v_mfma_f32_16x16x32_bf16 a[208:211], a[76:79], a[28:31], a[208:211]
ds_read_b64_tr_b16 a[76:77], v11 offset:36864
v_mfma_f32_16x16x32_bf16 a[124:127], a[84:87], a[0:3], a[124:127]
ds_read_b64_tr_b16 a[78:79], v11 offset:37376
v_mfma_f32_16x16x32_bf16 a[128:131], a[84:87], a[4:7], a[128:131]
buffer_load_dwordx4 v25, s[4:7], s66 offen offset:1024 lds
v_mfma_f32_16x16x32_bf16 a[132:135], a[84:87], a[8:11], a[132:135]
s_waitcnt vmcnt(10)
v_mfma_f32_16x16x32_bf16 a[136:139], a[84:87], a[12:15], a[136:139]
v_bfe_i32 v52, v34, 30, 1
v_xor_b32 v23, s62, v23
v_mfma_f32_16x16x32_bf16 a[140:143], a[84:87], a[16:19], a[140:143]
buffer_load_dwordx4 v26, s[4:7], s66 offen offset:2048 lds
v_bitop3_b32 v23, v23, v2, s62 bitop3:0xf6
v_mfma_f32_16x16x32_bf16 a[144:147], a[84:87], a[20:23], a[144:147]
v_bitop3_b32 v23, v23, v6, s62 bitop3:0xf6
v_bitop3_b32 v23, v23, v39, s62 bitop3:0xf6
v_mfma_f32_16x16x32_bf16 a[148:151], a[84:87], a[24:27], a[148:151]
v_bitop3_b32 v23, v23, v41, s62 bitop3:0xf6
v_mfma_f32_16x16x32_bf16 a[152:155], a[84:87], a[28:31], a[152:155]
ds_read_b64_tr_b16 a[84:85], v12 offset:36864
v_bitop3_b32 v23, v23, v43, s62 bitop3:0xf6
v_bitop3_b32 v23, v23, v45, s62 bitop3:0xf6
v_mfma_f32_16x16x32_bf16 a[156:159], a[92:95], a[0:3], a[156:159]
ds_read_b64_tr_b16 a[86:87], v12 offset:37376
buffer_load_dwordx4 v27, s[4:7], s66 offen offset:3072 lds
v_bitop3_b32 v23, v23, v47, s62 bitop3:0xf6
v_mfma_f32_16x16x32_bf16 a[160:163], a[92:95], a[4:7], a[160:163]
v_bitop3_b32 v23, v23, v49, s62 bitop3:0xf6
v_mfma_f32_16x16x32_bf16 a[164:167], a[92:95], a[8:11], a[164:167]
v_bitop3_b32 v23, v23, v51, s62 bitop3:0xf6
v_bitop3_b32 v23, v23, v9, s62 bitop3:0xf6
v_mfma_f32_16x16x32_bf16 a[168:171], a[92:95], a[12:15], a[168:171]
v_bitop3_b32 v23, v23, v33, s62 bitop3:0xf6
v_mfma_f32_16x16x32_bf16 a[172:175], a[92:95], a[16:19], a[172:175]
v_bfi_b32 v23, v52, 0, v23
v_cmp_ne_u32 vcc, 0, v23
v_mfma_f32_16x16x32_bf16 a[176:179], a[92:95], a[20:23], a[176:179]
v_mfma_f32_16x16x32_bf16 a[180:183], a[92:95], a[24:27], a[180:183]
v_mfma_f32_16x16x32_bf16 a[184:187], a[92:95], a[28:31], a[184:187]
s_cbranch_vccnz L_side_h
L_side_h_r:
v_mfma_f32_16x16x4_f32 a[108:111], v53, v0, 0
v_mfma_f32_16x16x4_f32 a[112:115], v53, v1, 0
v_mfma_f32_16x16x4_f32 a[116:119], v53, v4, 0
v_mfma_f32_16x16x4_f32 a[120:123], v53, v5, 0
s_waitcnt lgkmcnt(4)
v_mfma_f32_16x16x32_bf16 v[56:59], a[64:67], a[32:35], v[56:59]
ds_read_b64_tr_b16 a[92:93], v13 offset:36864
v_mfma_f32_16x16x32_bf16 v[60:63], a[64:67], a[36:39], v[60:63]
ds_read_b64_tr_b16 a[94:95], v13 offset:37376
v_mfma_f32_16x16x32_bf16 v[64:67], a[64:67], a[40:43], v[64:67]
s_mov_b32 s37, 0x3ae38e39
s_mov_b32 s38, 0x3727c5ac
v_mfma_f32_16x16x32_bf16 v[68:71], a[64:67], a[44:47], v[68:71]
v_and_b32 v15, 15, v19
s_lshl_b32 s39, s32, 9
v_mfma_f32_16x16x32_bf16 v[72:75], a[64:67], a[48:51], v[72:75]
s_add_u32 s39, s39, 151552
v_lshl_add_u32 v16, v15, 4, s39
v_mfma_f32_16x16x32_bf16 v[76:79], a[64:67], a[52:55], v[76:79]
s_lshl_b32 s39, s32, 7
s_add_u32 s39, s39, 153600
v_mfma_f32_16x16x32_bf16 v[80:83], a[64:67], a[56:59], v[80:83]
v_lshl_add_u32 v17, v15, 2, s39
v_accvgpr_read_b32 v0, a108
v_mfma_f32_16x16x32_bf16 v[84:87], a[64:67], a[60:63], v[84:87]
v_accvgpr_read_b32 v1, a112
v_mfma_f32_16x16x32_bf16 v[120:123], a[72:75], a[32:35], v[120:123]
v_accvgpr_read_b32 v4, a116
v_accvgpr_read_b32 v5, a120
v_mfma_f32_16x16x32_bf16 v[124:127], a[72:75], a[36:39], v[124:127]
s_waitcnt vmcnt(24) lgkmcnt(0)
s_barrier
v_mfma_f32_16x16x32_bf16 v[128:131], a[72:75], a[40:43], v[128:131]
v_mul_f32 v0, s37, v0
v_mul_f32 v4, s37, v4
s_mov_b32 s50, 77824
v_mfma_f32_16x16x32_bf16 v[132:135], a[72:75], a[44:47], v[132:135]
v_mul_f32 v1, s37, v1
v_mul_f32 v5, s37, v5
v_mfma_f32_16x16x32_bf16 v[136:139], a[72:75], a[48:51], v[136:139]
v_fma_f32 v1, -v0, v0, v1
v_fma_f32 v5, -v4, v4, v5
v_mfma_f32_16x16x32_bf16 v[140:143], a[72:75], a[52:55], v[140:143]
v_max_f32 v1, 0, v1
v_max_f32 v5, 0, v5
v_mfma_f32_16x16x32_bf16 v[144:147], a[72:75], a[56:59], v[144:147]
v_cvt_pk_bf16_f32 v1, v1, v1
v_cvt_pk_bf16_f32 v5, v5, v5
v_mfma_f32_16x16x32_bf16 v[148:151], a[72:75], a[60:63], v[148:151]
v_cvt_pk_bf16_f32 v0, -v0, -v0
v_cvt_pk_bf16_f32 v4, -v4, -v4
s_mul_i32 s46, s32, 10
s_lshl_b32 s47, s32, 3
v_mfma_f32_16x16x32_bf16 v[160:163], a[80:83], a[32:35], v[160:163]
v_lshlrev_b32 v1, 16, v1
v_lshlrev_b32 v5, 16, v5
v_mfma_f32_16x16x32_bf16 v[164:167], a[80:83], a[36:39], v[164:167]
v_add_f32 v1, s38, v1
v_add_f32 v5, s38, v5
v_mfma_f32_16x16x32_bf16 v[168:171], a[80:83], a[40:43], v[168:171]
v_cvt_pk_bf16_f32 v1, v1, v1
v_cvt_pk_bf16_f32 v5, v5, v5
v_mfma_f32_16x16x32_bf16 v[172:175], a[80:83], a[44:47], v[172:175]
v_lshlrev_b32 v1, 16, v1
v_lshlrev_b32 v5, 16, v5
s_add_u32 s47, s47, 4
s_min_u32 s46, s46, s47
v_mfma_f32_16x16x32_bf16 v[176:179], a[80:83], a[48:51], v[176:179]
v_sqrt_f32 v1, v1
v_sqrt_f32 v5, v5
v_mfma_f32_16x16x32_bf16 v[180:183], a[80:83], a[52:55], v[180:183]
v_cvt_pk_bf16_f32 v1, v1, v1
v_cvt_pk_bf16_f32 v5, v5, v5
v_mfma_f32_16x16x32_bf16 v[184:187], a[80:83], a[56:59], v[184:187]
v_lshlrev_b32 v1, 16, v1
v_lshlrev_b32 v5, 16, v5
v_mfma_f32_16x16x32_bf16 v[188:191], a[80:83], a[60:63], v[188:191]
v_rcp_f32 v1, v1
s_lshl_b32 s47, s46, 10
s_mul_i32 s46, s46, 9216
v_mfma_f32_16x16x32_bf16 v[192:195], a[88:91], a[32:35], v[192:195]
v_rcp_f32 v5, v5
ds_write2_b32 v16, v0, v20 offset0:0 offset1:1
v_mfma_f32_16x16x32_bf16 v[196:199], a[88:91], a[36:39], v[196:199]
ds_write2_b32 v16, v20, v0 offset0:2 offset1:3
ds_write2_b32 v16, v4, v20 offset0:64 offset1:65
v_mfma_f32_16x16x32_bf16 v[200:203], a[88:91], a[40:43], v[200:203]
ds_write2_b32 v16, v20, v4 offset0:66 offset1:67
ds_write2_b32 v17, v1, v5 offset0:0 offset1:16
v_mfma_f32_16x16x32_bf16 v[204:207], a[88:91], a[44:47], v[204:207]
v_mul_f32 v33, v1, v1
v_mul_f32 v22, v5, v5
s_cmp_lt_u32 s32, 2
s_cselect_b32 s45, 131072, s50
s_cselect_b32 s50, 0, 1073741824
v_mfma_f32_16x16x32_bf16 v[208:211], a[88:91], a[48:51], v[208:211]
s_add_u32 m0, s47, s45
s_add_u32 s46, s46, s51
v_mfma_f32_16x16x32_bf16 v[212:215], a[88:91], a[52:55], v[212:215]
buffer_load_dwordx4 v28, s[4:7], s46 offen lds
v_cvt_pk_bf16_f32 v52, v38, v38
v_mfma_f32_16x16x32_bf16 v[216:219], a[88:91], a[56:59], v[216:219]
s_add_u32 s46, s46, 8192
v_lshlrev_b32 v52, 16, v52
v_mfma_f32_16x16x32_bf16 v[220:223], a[88:91], a[60:63], v[220:223]
s_waitcnt vmcnt(9)
s_waitcnt lgkmcnt(0)
s_barrier
v_mfma_f32_16x16x32_bf16 v[224:227], a[96:99], a[32:35], v[224:227]
v_xor_b32 v18, 0, v16
ds_read_b128 a[0:3], v18 offset:0
buffer_load_dwordx4 v28, s[4:7], s46 offen offset:1024 lds
v_mfma_f32_16x16x32_bf16 v[228:231], a[96:99], a[36:39], v[228:231]
ds_read_b128 a[4:7], v18 offset:256
s_add_u32 s46, s46, 8192
v_mfma_f32_16x16x32_bf16 v[232:235], a[96:99], a[40:43], v[232:235]
v_xor_b32 v18, 512, v16
ds_read_b128 a[8:11], v18 offset:0
buffer_load_dwordx4 v28, s[4:7], s46 offen offset:2048 lds
v_mfma_f32_16x16x32_bf16 v[236:239], a[96:99], a[44:47], v[236:239]
ds_read_b128 a[12:15], v18 offset:256
s_add_u32 s46, s46, 8192
v_mfma_f32_16x16x32_bf16 v[240:243], a[96:99], a[48:51], v[240:243]
v_xor_b32 v18, 1024, v16
ds_read_b128 a[16:19], v18 offset:0
buffer_load_dwordx4 v28, s[4:7], s46 offen offset:3072 lds
v_mfma_f32_16x16x32_bf16 v[244:247], a[96:99], a[52:55], v[244:247]
ds_read_b128 a[20:23], v18 offset:256
v_sub_f32 v52, v38, v52
v_mfma_f32_16x16x32_bf16 v[248:251], a[96:99], a[56:59], v[248:251]
v_xor_b32 v18, 1536, v16
s_add_u32 m0, m0, 4096
s_add_u32 s46, s46, 12288
v_mfma_f32_16x16x32_bf16 v[252:255], a[96:99], a[60:63], v[252:255]
s_waitcnt vmcnt(30)
ds_read_b128 a[24:27], v18 offset:0
v_mfma_f32_16x16x32_bf16 a[212:215], a[32:35], a[104:107], a[212:215]
ds_read_b128 a[28:31], v18 offset:256
buffer_load_dwordx4 v28, s[4:7], s46 offen lds
v_mfma_f32_16x16x32_bf16 a[216:219], a[36:39], a[104:107], a[216:219]
v_cvt_pk_bf16_f32 v38, v38, v52
v_cvt_pk_bf16_f32 v52, v40, v40
v_mfma_f32_16x16x32_bf16 a[220:223], a[40:43], a[104:107], a[220:223]
v_lshlrev_b32 v52, 16, v52
v_sub_f32 v52, v40, v52
v_mfma_f32_16x16x32_bf16 a[224:227], a[44:47], a[104:107], a[224:227]
s_add_u32 s46, s46, 8192
v_cvt_pk_bf16_f32 v39, v40, v52
v_mfma_f32_16x16x32_bf16 a[228:231], a[48:51], a[104:107], a[228:231]
v_cvt_pk_bf16_f32 v52, v42, v42
v_lshlrev_b32 v52, 16, v52
v_mfma_f32_16x16x32_bf16 a[232:235], a[52:55], a[104:107], a[232:235]
buffer_load_dwordx4 v28, s[4:7], s46 offen offset:1024 lds
v_sub_f32 v52, v42, v52
v_mfma_f32_16x16x32_bf16 a[236:239], a[56:59], a[104:107], a[236:239]
v_cvt_pk_bf16_f32 v40, v42, v52
v_cvt_pk_bf16_f32 v52, v44, v44
v_mfma_f32_16x16x32_bf16 a[240:243], a[60:63], a[104:107], a[240:243]
s_add_u32 s46, s46, 8192
v_lshlrev_b32 v52, 16, v52
v_mfma_f32_16x16x32_bf16 v[88:91], a[68:71], a[32:35], v[88:91]
v_sub_f32 v52, v44, v52
v_cvt_pk_bf16_f32 v41, v44, v52
v_mfma_f32_16x16x32_bf16 v[92:95], a[68:71], a[36:39], v[92:95]
buffer_load_dwordx4 v28, s[4:7], s46 offen offset:2048 lds
v_cvt_pk_bf16_f32 v52, v46, v46
v_mfma_f32_16x16x32_bf16 v[96:99], a[68:71], a[40:43], v[96:99]
v_lshlrev_b32 v52, 16, v52
v_sub_f32 v52, v46, v52
v_mfma_f32_16x16x32_bf16 v[100:103], a[68:71], a[44:47], v[100:103]
s_add_u32 s46, s46, 8192
v_cvt_pk_bf16_f32 v42, v46, v52
v_mfma_f32_16x16x32_bf16 v[104:107], a[68:71], a[48:51], v[104:107]
v_cvt_pk_bf16_f32 v52, v48, v48
v_lshlrev_b32 v52, 16, v52
v_mfma_f32_16x16x32_bf16 v[108:111], a[68:71], a[52:55], v[108:111]
v_sub_f32 v52, v48, v52
v_cvt_pk_bf16_f32 v43, v48, v52
v_mfma_f32_16x16x32_bf16 v[112:115], a[68:71], a[56:59], v[112:115]
buffer_load_dwordx4 v28, s[4:7], s46 offen offset:3072 lds
v_cvt_pk_bf16_f32 v52, v50, v50
v_mfma_f32_16x16x32_bf16 v[116:119], a[68:71], a[60:63], v[116:119]
v_lshlrev_b32 v52, 16, v52
v_sub_f32 v52, v50, v52
v_mfma_f32_16x16x32_bf16 v[152:155], a[76:79], a[32:35], v[152:155]
s_add_u32 s46, s46, 12288
s_add_u32 m0, m0, 4096
v_mfma_f32_16x16x32_bf16 v[156:159], a[76:79], a[36:39], v[156:159]
v_cvt_pk_bf16_f32 v44, v50, v52
v_cvt_pk_bf16_f32 v52, v8, v8
v_mfma_f32_16x16x32_bf16 a[188:191], a[76:79], a[40:43], a[188:191]
s_lshr_b32 s47, s50, 13
s_or_b32 m0, m0, s47
v_mfma_f32_16x16x32_bf16 a[192:195], a[76:79], a[44:47], a[192:195]
v_lshlrev_b32 v52, 16, v52
v_sub_f32 v52, v8, v52
v_mfma_f32_16x16x32_bf16 a[196:199], a[76:79], a[48:51], a[196:199]
s_or_b32 s46, s46, s50
v_cvt_pk_bf16_f32 v45, v8, v52
v_mfma_f32_16x16x32_bf16 a[200:203], a[76:79], a[52:55], a[200:203]
v_cvt_pk_bf16_f32 v52, v32, v32
v_lshlrev_b32 v52, 16, v52
v_mfma_f32_16x16x32_bf16 a[204:207], a[76:79], a[56:59], a[204:207]
buffer_load_dwordx4 v28, s[4:7], s46 offen lds
v_sub_f32 v52, v32, v52
v_mfma_f32_16x16x32_bf16 a[208:211], a[76:79], a[60:63], a[208:211]
v_cvt_pk_bf16_f32 v46, v32, v52
v_mov_b32 v47, 0
v_mfma_f32_16x16x32_bf16 a[124:127], a[84:87], a[32:35], a[124:127]
s_mul_i32 s3, s33, 144
s_mul_i32 s42, s34, 9
s_add_u32 s3, s3, s42
v_mfma_f32_16x16x32_bf16 a[128:131], a[84:87], a[36:39], a[128:131]
s_add_u32 s46, s46, 8192
s_lshl_b32 s3, s3, 13
s_and_b32 s42, s34, 1
v_mfma_f32_16x16x32_bf16 a[132:135], a[84:87], a[40:43], a[132:135]
s_lshl_b32 s40, s42, 13
s_lshl_b32 s41, s32, 14
s_add_u32 s40, s40, s41
v_mfma_f32_16x16x32_bf16 a[136:139], a[84:87], a[44:47], a[136:139]
buffer_load_dwordx4 v28, s[4:7], s46 offen offset:1024 lds
s_add_u32 s41, s40, 8192
s_add_u32 s37, s3, s40
v_mfma_f32_16x16x32_bf16 a[140:143], a[84:87], a[48:51], a[140:143]
s_add_u32 s38, s3, s41
s_xor_b32 s42, s42, 1
s_mul_i32 s43, s42, 114688
v_mfma_f32_16x16x32_bf16 a[144:147], a[84:87], a[52:55], a[144:147]
s_lshl_b32 s42, s42, 16
s_add_u32 s39, s3, s42
v_mfma_f32_16x16x32_bf16 a[148:151], a[84:87], a[56:59], a[148:151]
s_cmp_eq_u32 s41, 0x10000
s_cselect_b32 s41, 114688, s41
s_lshl_b32 s3, s32, 11
v_mfma_f32_16x16x32_bf16 a[152:155], a[84:87], a[60:63], a[152:155]
v_lshl_add_u32 v4, v19, 4, s3
v_xor_b32 v5, 0x800, v4
v_xor_b32 v6, 0x1000, v4
v_mfma_f32_16x16x32_bf16 a[156:159], a[92:95], a[32:35], a[156:159]
v_xor_b32 v7, 0x1800, v4
v_mov_b32 v11, v4
v_lshrrev_b32 v53, 5, v19
v_mfma_f32_16x16x32_bf16 a[160:163], a[92:95], a[36:39], a[160:163]
v_and_b32 v52, 15, v19
v_lshlrev_b32 v52, 4, v52
v_mfma_f32_16x16x32_bf16 a[164:167], a[92:95], a[40:43], a[164:167]
v_lshl_add_u32 v52, v53, 10, v52
v_bfe_u32 v53, v19, 4, 1
v_xor_b32 v53, s32, v53
v_mfma_f32_16x16x32_bf16 a[168:171], a[92:95], a[44:47], a[168:171]
v_lshl_add_u32 v52, v53, 11, v52
s_lshl_b32 s42, s32, 8
v_mfma_f32_16x16x32_bf16 a[172:175], a[92:95], a[48:51], a[172:175]
v_add_u32 v15, s42, v52
v_xor_b32 v16, 0x1000, v15
s_lshl_b32 s3, s33, 2
v_mfma_f32_16x16x32_bf16 a[176:179], a[92:95], a[52:55], a[176:179]
s_add_u32 s3, s3, s32
s_mul_i32 s3, s3, 1152
v_mfma_f32_16x16x32_bf16 a[180:183], a[92:95], a[56:59], a[180:183]
s_lshl_b32 s42, s36, 8
s_add_u32 s42, s42, s3
v_and_b32 v52, 15, v19
v_mfma_f32_16x16x32_bf16 a[184:187], a[92:95], a[60:63], a[184:187]
v_mul_u32_u24 v52, 73728, v52
v_lshrrev_b32 v53, 4, v19
v_lshl_add_u32 v34, v53, 3, v52
v_add_u32 v34, s42, v34
s_lshl_b32 s42, s35, 6
v_add_u32 v34, s42, v34
s_lshl_b32 s42, s34, 3
s_add_u32 s3, s3, s42
s_add_u32 s3, s3, 1024
v_and_b32 v53, 1, v53
v_lshl_add_u32 v52, v53, 2, v52
v_lshrrev_b32 v53, 5, v19
v_mul_u32_u24 v53, 1179648, v53
v_add3_u32 v35, v52, v53, s3
s_mov_b32 s51, 1179648
buffer_load_dwordx2 a[96:97], v34, s[8:11], 0 offen offset:0
buffer_load_dwordx2 a[98:99], v34, s[8:11], s51 offen offset:0
buffer_load_dwordx2 a[252:253], v34, s[8:11], 0 offen offset:32
buffer_load_dwordx2 a[254:255], v34, s[8:11], s51 offen offset:32
buffer_load_dword v2, v35, s[8:11], 0 offen
s_waitcnt lgkmcnt(0)
v_mfma_f32_16x16x16_bf16 v[56:59], v[38:39], a[0:1], v[56:59]
v_mfma_f32_16x16x16_bf16 v[88:91], v[38:39], a[2:3], v[88:91]
v_mfma_f32_16x16x16_bf16 v[120:123], v[40:41], a[0:1], v[120:123]
v_mfma_f32_16x16x16_bf16 v[152:155], v[40:41], a[2:3], v[152:155]
v_mfma_f32_16x16x16_bf16 v[60:63], v[38:39], a[4:5], v[60:63]
v_mfma_f32_16x16x16_bf16 v[92:95], v[38:39], a[6:7], v[92:95]
v_mfma_f32_16x16x16_bf16 v[124:127], v[40:41], a[4:5], v[124:127]
v_mfma_f32_16x16x16_bf16 v[156:159], v[40:41], a[6:7], v[156:159]
s_nop 4
v_max_f32 v56, 0, v56
v_add_u32 v52, s40, v4
v_max_f32 v57, 0, v57
v_max_f32 v58, 0, v58
v_mfma_f32_16x16x16_bf16 v[64:67], v[38:39], a[8:9], v[64:67]
v_max_f32 v59, 0, v59
v_mul_f32 v56, v56, v88
v_mul_f32 v57, v57, v89
v_mul_f32 v58, v58, v90
v_mfma_f32_16x16x16_bf16 v[96:99], v[38:39], a[10:11], v[96:99]
v_mul_f32 v59, v59, v91
v_cvt_pk_bf16_f32 v56, v56, v57
v_cvt_pk_bf16_f32 v57, v58, v59
v_max_f32 v120, 0, v120
v_mfma_f32_16x16x16_bf16 v[128:131], v[40:41], a[8:9], v[128:131]
v_max_f32 v121, 0, v121
v_max_f32 v122, 0, v122
v_max_f32 v123, 0, v123
v_mul_f32 v120, v120, v152
v_mfma_f32_16x16x16_bf16 a[188:191], v[40:41], a[10:11], a[188:191]
v_mul_f32 v121, v121, v153
v_mul_f32 v122, v122, v154
v_mul_f32 v123, v123, v155
v_cvt_pk_bf16_f32 v58, v120, v121
v_cvt_pk_bf16_f32 v59, v122, v123
buffer_store_dwordx4 v[56:59], v4, s[20:23], s37 offen sc1
ds_write_b128 v52, v[56:59] offset:0
v_max_f32 v60, 0, v60
v_max_f32 v61, 0, v61
v_max_f32 v62, 0, v62
v_max_f32 v63, 0, v63
v_mfma_f32_16x16x16_bf16 v[68:71], v[38:39], a[12:13], v[68:71]
v_mul_f32 v60, v60, v92
v_mul_f32 v61, v61, v93
v_mul_f32 v62, v62, v94
v_mul_f32 v63, v63, v95
v_mfma_f32_16x16x16_bf16 v[100:103], v[38:39], a[14:15], v[100:103]
v_cvt_pk_bf16_f32 v60, v60, v61
v_cvt_pk_bf16_f32 v61, v62, v63
v_max_f32 v124, 0, v124
v_max_f32 v125, 0, v125
v_mfma_f32_16x16x16_bf16 v[132:135], v[40:41], a[12:13], v[132:135]
v_max_f32 v126, 0, v126
v_max_f32 v127, 0, v127
v_mul_f32 v124, v124, v156
v_mul_f32 v125, v125, v157
v_mfma_f32_16x16x16_bf16 a[192:195], v[40:41], a[14:15], a[192:195]
v_mul_f32 v126, v126, v158
v_mul_f32 v127, v127, v159
v_cvt_pk_bf16_f32 v62, v124, v125
v_cvt_pk_bf16_f32 v63, v126, v127
buffer_store_dwordx4 v[60:63], v4, s[20:23], s37 offen offset:1024 sc1
ds_write_b128 v52, v[60:63] offset:1024
v_max_f32 v64, 0, v64
v_add_u32 v52, s40, v5
v_max_f32 v65, 0, v65
v_max_f32 v66, 0, v66
v_max_f32 v67, 0, v67
v_mfma_f32_16x16x16_bf16 v[72:75], v[38:39], a[16:17], v[72:75]
v_mul_f32 v64, v64, v96
v_mul_f32 v65, v65, v97
v_mul_f32 v66, v66, v98
v_mul_f32 v67, v67, v99
v_cvt_pk_bf16_f32 v64, v64, v65
v_mfma_f32_16x16x16_bf16 v[104:107], v[38:39], a[18:19], v[104:107]
v_cvt_pk_bf16_f32 v65, v66, v67
v_max_f32 v128, 0, v128
v_max_f32 v129, 0, v129
v_max_f32 v130, 0, v130
v_max_f32 v131, 0, v131
v_mfma_f32_16x16x16_bf16 v[136:139], v[40:41], a[16:17], v[136:139]
v_accvgpr_read_b32 v48, a188
v_accvgpr_read_b32 v49, a189
v_accvgpr_read_b32 v50, a190
v_accvgpr_read_b32 v51, a191
v_mul_f32 v128, v128, v48
v_mfma_f32_16x16x16_bf16 a[196:199], v[40:41], a[18:19], a[196:199]
v_mul_f32 v129, v129, v49
v_mul_f32 v130, v130, v50
v_mul_f32 v131, v131, v51
v_cvt_pk_bf16_f32 v66, v128, v129
v_cvt_pk_bf16_f32 v67, v130, v131
buffer_store_dwordx4 v[64:67], v5, s[20:23], s37 offen sc1
ds_write_b128 v52, v[64:67] offset:0
v_max_f32 v68, 0, v68
v_max_f32 v69, 0, v69
v_max_f32 v70, 0, v70
v_max_f32 v71, 0, v71
v_mul_f32 v68, v68, v100
v_mfma_f32_16x16x16_bf16 v[76:79], v[38:39], a[20:21], v[76:79]
v_mul_f32 v69, v69, v101
v_mul_f32 v70, v70, v102
v_mul_f32 v71, v71, v103
v_cvt_pk_bf16_f32 v68, v68, v69
v_cvt_pk_bf16_f32 v69, v70, v71
v_mfma_f32_16x16x16_bf16 v[108:111], v[38:39], a[22:23], v[108:111]
v_max_f32 v132, 0, v132
v_max_f32 v133, 0, v133
v_max_f32 v134, 0, v134
v_max_f32 v135, 0, v135
v_accvgpr_read_b32 v48, a192
v_mfma_f32_16x16x16_bf16 v[140:143], v[40:41], a[20:21], v[140:143]
v_accvgpr_read_b32 v49, a193
v_accvgpr_read_b32 v50, a194
v_accvgpr_read_b32 v51, a195
v_mul_f32 v132, v132, v48
v_mul_f32 v133, v133, v49
v_mfma_f32_16x16x16_bf16 a[200:203], v[40:41], a[22:23], a[200:203]
v_mul_f32 v134, v134, v50
v_mul_f32 v135, v135, v51
v_cvt_pk_bf16_f32 v70, v132, v133
v_cvt_pk_bf16_f32 v71, v134, v135
buffer_store_dwordx4 v[68:71], v5, s[20:23], s37 offen offset:1024 sc1
ds_write_b128 v52, v[68:71] offset:1024
s_mul_i32 s44, s33, 144
s_mul_i32 s45, s35, 36
s_add_u32 s44, s44, s45
s_and_b32 s46, s2, 0xe7
s_lshl_b32 s46, s46, 7
s_add_u32 s46, s46, 21594112
s_bfe_u32 s45, s75, 131072
s_lshl_b32 s47, s45, 10
s_add_u32 s90, s47, s46
s_bfe_u32 s45, s75, 131080
s_lshl_b32 s47, s45, 10
s_add_u32 s91, s47, s46
s_mul_i32 s45, s45, 9
s_add_u32 s45, s45, s44
s_lshl_b32 s61, s45, 13
s_bfe_u32 s45, s75, 131088
s_lshl_b32 s47, s45, 10
s_add_u32 s92, s47, s46
s_mul_i32 s45, s45, 9
s_add_u32 s45, s45, s44
s_lshl_b32 s63, s45, 13
s_bfe_u32 s45, s75, 131096
s_lshl_b32 s47, s45, 10
s_add_u32 s93, s47, s46
s_mul_i32 s45, s45, 9
s_add_u32 s45, s45, s44
s_lshl_b32 s101, s45, 13
s_lshl_b32 s82, s65, 13
s_add_u32 s83, s82, 8192
v_max_f32 v72, 0, v72
v_add_u32 v52, s40, v6
v_max_f32 v73, 0, v73
v_max_f32 v74, 0, v74
v_max_f32 v75, 0, v75
v_mfma_f32_16x16x16_bf16 v[80:83], v[38:39], a[24:25], v[80:83]
v_mul_f32 v72, v72, v104
v_mul_f32 v73, v73, v105
v_mul_f32 v74, v74, v106
v_mul_f32 v75, v75, v107
v_cvt_pk_bf16_f32 v72, v72, v73
v_mfma_f32_16x16x16_bf16 v[112:115], v[38:39], a[26:27], v[112:115]
v_cvt_pk_bf16_f32 v73, v74, v75
v_max_f32 v136, 0, v136
v_max_f32 v137, 0, v137
v_max_f32 v138, 0, v138
v_max_f32 v139, 0, v139
v_mfma_f32_16x16x16_bf16 v[144:147], v[40:41], a[24:25], v[144:147]
v_accvgpr_read_b32 v48, a196
v_accvgpr_read_b32 v49, a197
v_accvgpr_read_b32 v50, a198
v_accvgpr_read_b32 v51, a199
v_mul_f32 v136, v136, v48
v_mfma_f32_16x16x16_bf16 a[204:207], v[40:41], a[26:27], a[204:207]
v_mul_f32 v137, v137, v49
v_mul_f32 v138, v138, v50
v_mul_f32 v139, v139, v51
v_cvt_pk_bf16_f32 v74, v136, v137
v_cvt_pk_bf16_f32 v75, v138, v139
buffer_store_dwordx4 v[72:75], v6, s[20:23], s37 offen sc1
ds_write_b128 v52, v[72:75] offset:0
s_cmp_eq_u32 s83, 73728
s_cselect_b32 s83, 0, s83
s_add_u32 s84, s83, 8192
s_cmp_eq_u32 s84, 73728
s_cselect_b32 s84, 0, s84
s_add_u32 s86, s84, 8192
s_cmp_eq_u32 s86, 73728
s_cselect_b32 s86, 0, s86
s_add_u32 s87, s86, 8192
s_cmp_eq_u32 s87, 73728
s_cselect_b32 s87, 0, s87
s_add_u32 s88, s87, 8192
s_cmp_eq_u32 s88, 73728
s_cselect_b32 s88, 0, s88
s_add_u32 s89, s88, 8192
s_cmp_eq_u32 s89, 73728
s_cselect_b32 s89, 0, s89
s_add_u32 s64, s89, 8192
s_cmp_eq_u32 s64, 73728
s_cselect_b32 s64, 0, s64
s_add_u32 s50, s64, 8192
s_cmp_eq_u32 s50, 73728
s_cselect_b32 s50, 0, s50
v_lshrrev_b32 v120, 4, v19
v_and_b32 v121, 15, v19
s_lshl_b32 s44, s33, 2
s_add_u32 s44, s44, s32
s_and_b32 s45, s44, 31
s_lshr_b32 s46, s33, 3
s_lshl_b32 s42, s36, 7
v_max_f32 v76, 0, v76
v_max_f32 v77, 0, v77
v_max_f32 v78, 0, v78
v_max_f32 v79, 0, v79
v_mul_f32 v76, v76, v108
v_mfma_f32_16x16x16_bf16 v[84:87], v[38:39], a[28:29], v[84:87]
v_mul_f32 v77, v77, v109
v_mul_f32 v78, v78, v110
v_mul_f32 v79, v79, v111
v_cvt_pk_bf16_f32 v76, v76, v77
v_cvt_pk_bf16_f32 v77, v78, v79
v_mfma_f32_16x16x16_bf16 v[116:119], v[38:39], a[30:31], v[116:119]
v_max_f32 v140, 0, v140
v_max_f32 v141, 0, v141
v_max_f32 v142, 0, v142
v_max_f32 v143, 0, v143
v_accvgpr_read_b32 v48, a200
v_mfma_f32_16x16x16_bf16 v[148:151], v[40:41], a[28:29], v[148:151]
v_accvgpr_read_b32 v49, a201
v_accvgpr_read_b32 v50, a202
v_accvgpr_read_b32 v51, a203
v_mul_f32 v140, v140, v48
v_mul_f32 v141, v141, v49
v_mfma_f32_16x16x16_bf16 a[208:211], v[40:41], a[30:31], a[208:211]
v_mul_f32 v142, v142, v50
v_mul_f32 v143, v143, v51
v_cvt_pk_bf16_f32 v78, v140, v141
v_cvt_pk_bf16_f32 v79, v142, v143
buffer_store_dwordx4 v[76:79], v6, s[20:23], s37 offen offset:1024 sc1
ds_write_b128 v52, v[76:79] offset:1024
s_lshl_b32 s47, s35, 5
s_add_u32 s42, s42, s47
s_cmp_ge_u32 s42, 288
s_cselect_b64 vcc, -1, 0
s_cmp_lg_u32 s45, 0
s_cselect_b32 s47, 63, 64
v_lshl_add_u32 v122, v121, 1, s46
v_lshlrev_b32 v125, 4, v120
v_add_u32 v125, 147456, v125
v_sub_u32 v123, s47, v122
v_and_b32 v123, 63, v123
v_lshrrev_b32 v31, 1, v123
v_lshl_add_u32 v31, v31, 6, v125
v_and_b32 v124, 1, v123
v_lshl_add_u32 v31, v124, 13, v31
v_cndmask_b32 v123, v122, v123, vcc
v_lshrrev_b32 v29, 1, v123
v_lshl_add_u32 v29, v29, 6, v125
v_and_b32 v124, 1, v123
v_lshl_add_u32 v29, v124, 13, v29
v_add_u32 v122, 32, v122
v_sub_u32 v123, s47, v122
v_and_b32 v123, 63, v123
v_lshrrev_b32 v32, 1, v123
v_lshl_add_u32 v32, v32, 6, v125
v_and_b32 v124, 1, v123
v_lshl_add_u32 v32, v124, 13, v32
v_cndmask_b32 v123, v122, v123, vcc
v_lshrrev_b32 v30, 1, v123
v_max_f32 v80, 0, v80
v_add_u32 v52, s40, v7
v_max_f32 v81, 0, v81
v_max_f32 v82, 0, v82
v_max_f32 v83, 0, v83
v_mfma_f32_16x16x16_bf16 v[160:163], v[42:43], a[0:1], v[160:163]
v_mul_f32 v80, v80, v112
v_mul_f32 v81, v81, v113
v_mul_f32 v82, v82, v114
v_mul_f32 v83, v83, v115
v_cvt_pk_bf16_f32 v80, v80, v81
v_mfma_f32_16x16x16_bf16 a[124:127], v[42:43], a[2:3], a[124:127]
v_cvt_pk_bf16_f32 v81, v82, v83
v_max_f32 v144, 0, v144
v_max_f32 v145, 0, v145
v_max_f32 v146, 0, v146
v_max_f32 v147, 0, v147
v_mfma_f32_16x16x16_bf16 v[192:195], v[44:45], a[0:1], v[192:195]
v_accvgpr_read_b32 v48, a204
v_accvgpr_read_b32 v49, a205
v_accvgpr_read_b32 v50, a206
v_accvgpr_read_b32 v51, a207
v_mul_f32 v144, v144, v48
v_mfma_f32_16x16x16_bf16 a[156:159], v[44:45], a[2:3], a[156:159]
v_mul_f32 v145, v145, v49
v_mul_f32 v146, v146, v50
v_mul_f32 v147, v147, v51
v_cvt_pk_bf16_f32 v82, v144, v145
v_cvt_pk_bf16_f32 v83, v146, v147
buffer_store_dwordx4 v[80:83], v7, s[20:23], s37 offen sc1
ds_write_b128 v52, v[80:83] offset:0
v_lshl_add_u32 v30, v30, 6, v125
v_and_b32 v124, 1, v123
v_lshl_add_u32 v30, v124, 13, v30
s_sub_u32 s46, 32, s45
s_and_b32 s46, s46, 31
s_mul_i32 s77, s46, 4608
s_add_u32 s77, s77, 18874368
s_cmp_ge_u32 s42, 288
s_cselect_b32 s46, s46, s45
s_movk_i32 s45, 256
s_cselect_b32 s45, -256, s45
s_mul_i32 s46, s46, 4608
s_add_u32 s76, s46, 18874368
v_add_u32 v122, s42, v121
v_subrev_u32 v123, 1, v122
v_sub_u32 v124, 575, v122
v_cndmask_b32 v123, v123, v124, vcc
v_mul_u32_u24 v124, 147456, v120
v_lshl_add_u32 v36, v123, 4, v124
v_add_u32 v37, s45, v36
s_lshl_b32 s46, s34, 2
s_sub_u32 s47, 63, s46
v_and_b32 v123, 3, v19
v_sub_u32 v123, s47, v123
v_lshl_add_u32 v8, v123, 4, v124
v_cmp_eq_u32 vcc, 0, v122
v_mov_b32 v124, 1073741824
s_nop 0
v_cndmask_b32 v36, v36, v124, vcc
v_cmp_eq_u32 vcc, 0, v19
v_max_f32 v84, 0, v84
v_max_f32 v85, 0, v85
v_max_f32 v86, 0, v86
v_max_f32 v87, 0, v87
v_mul_f32 v84, v84, v116
v_mfma_f32_16x16x16_bf16 v[164:167], v[42:43], a[4:5], v[164:167]
v_mul_f32 v85, v85, v117
v_mul_f32 v86, v86, v118
v_mul_f32 v87, v87, v119
v_cvt_pk_bf16_f32 v84, v84, v85
v_cvt_pk_bf16_f32 v85, v86, v87
v_mfma_f32_16x16x16_bf16 a[128:131], v[42:43], a[6:7], a[128:131]
v_max_f32 v148, 0, v148
v_max_f32 v149, 0, v149
v_max_f32 v150, 0, v150
v_max_f32 v151, 0, v151
v_accvgpr_read_b32 v48, a208
v_mfma_f32_16x16x16_bf16 v[196:199], v[44:45], a[4:5], v[196:199]
v_accvgpr_read_b32 v49, a209
v_accvgpr_read_b32 v50, a210
v_accvgpr_read_b32 v51, a211
v_mul_f32 v148, v148, v48
v_mul_f32 v149, v149, v49
v_mfma_f32_16x16x16_bf16 a[160:163], v[44:45], a[6:7], a[160:163]
v_mul_f32 v150, v150, v50
v_mul_f32 v151, v151, v51
v_cvt_pk_bf16_f32 v86, v148, v149
v_cvt_pk_bf16_f32 v87, v150, v151
buffer_store_dwordx4 v[84:87], v7, s[20:23], s37 offen offset:1024 sc1
ds_write_b128 v52, v[84:87] offset:1024
s_sub_u32 s44, s42, 1
s_max_i32 s44, s44, 0
v_cndmask_b32 v3, v124, v20, vcc
s_sub_u32 s45, 544, s42
s_cmp_ge_u32 s42, 288
s_cselect_b32 s44, s45, s44
s_lshr_b32 s45, s44, 5
s_add_u32 s44, s44, 31
s_lshr_b32 s44, s44, 5
s_min_u32 s44, s44, 8
s_lshr_b32 s47, s47, 5
v_mov_b32 v123, s47
v_mov_b32 v125, s45
v_cmp_eq_u32 vcc, 0, v120
v_mov_b32 v121, s44
s_nop 0
v_cndmask_b32 v123, v123, v125, vcc
v_cmp_eq_u32 vcc, 1, v120
v_and_b32 v125, 7, v19
v_lshlrev_b32 v125, 5, v125
v_cndmask_b32 v123, v123, v121, vcc
v_bfe_u32 v120, v19, 3, 1
v_lshl_add_u32 v125, v120, 2, v125
v_and_b32 v120, 1, v123
v_lshl_add_u32 v125, v120, 3, v125
v_bfe_u32 v120, v123, 1, 2
v_add_u32 v125, v120, v125
v_lshrrev_b32 v120, 3, v123
v_lshl_add_u32 v125, v120, 4, v125
v_lshlrev_b32 v9, 7, v125
v_max_f32 v160, 0, v160
v_add_u32 v52, s41, v4
v_max_f32 v161, 0, v161
v_max_f32 v162, 0, v162
v_max_f32 v163, 0, v163
v_accvgpr_read_b32 v48, a124
v_mfma_f32_16x16x16_bf16 v[168:171], v[42:43], a[8:9], v[168:171]
v_accvgpr_read_b32 v49, a125
v_accvgpr_read_b32 v50, a126
v_accvgpr_read_b32 v51, a127
v_mul_f32 v160, v160, v48
v_mul_f32 v161, v161, v49
v_mul_f32 v162, v162, v50
v_mfma_f32_16x16x16_bf16 a[132:135], v[42:43], a[10:11], a[132:135]
v_mul_f32 v163, v163, v51
v_cvt_pk_bf16_f32 v160, v160, v161
v_cvt_pk_bf16_f32 v161, v162, v163
v_max_f32 v192, 0, v192
v_max_f32 v193, 0, v193
v_max_f32 v194, 0, v194
v_mfma_f32_16x16x16_bf16 v[200:203], v[44:45], a[8:9], v[200:203]
v_max_f32 v195, 0, v195
v_accvgpr_read_b32 v48, a156
v_accvgpr_read_b32 v49, a157
v_accvgpr_read_b32 v50, a158
v_accvgpr_read_b32 v51, a159
v_mul_f32 v192, v192, v48
v_mfma_f32_16x16x16_bf16 a[164:167], v[44:45], a[10:11], a[164:167]
v_mul_f32 v193, v193, v49
v_mul_f32 v194, v194, v50
v_mul_f32 v195, v195, v51
v_cvt_pk_bf16_f32 v162, v192, v193
v_cvt_pk_bf16_f32 v163, v194, v195
buffer_store_dwordx4 v[160:163], v4, s[20:23], s38 offen sc1
ds_write_b128 v52, v[160:163] offset:0
v_lshrrev_b32 v126, 4, v19
s_lshl_b32 s44, s32, 7
s_add_u32 s44, s44, 153600
v_lshl_add_u32 v128, v126, 4, s44
v_xor_b32 v129, 0, v128
ds_read_b128 v[56:59], v129 offset:0
ds_read_b128 v[60:63], v129 offset:64
v_xor_b32 v129, 128, v128
ds_read_b128 v[64:67], v129 offset:0
ds_read_b128 v[68:71], v129 offset:64
v_xor_b32 v129, 256, v128
ds_read_b128 v[72:75], v129 offset:0
ds_read_b128 v[76:79], v129 offset:64
v_xor_b32 v129, 384, v128
ds_read_b128 v[80:83], v129 offset:0
ds_read_b128 v[84:87], v129 offset:64
v_bfe_u32 v128, v19, 2, 2
v_lshl_add_u32 v128, v126, 2, v128
v_lshlrev_b32 v128, 6, v128
v_and_b32 v129, 1, v126
v_lshl_add_u32 v128, v129, 5, v128
v_and_b32 v129, 3, v19
v_lshl_add_u32 v128, v129, 3, v128
s_lshl_b32 s44, s32, 11
s_add_u32 s44, s44, 122880
v_add_u32 v128, s44, v128
v_xor_b32 v129, 0, v128
ds_read_b64_tr_b16 a[32:33], v129 offset:0
ds_read_b64_tr_b16 a[34:35], v129 offset:1024
ds_read_b64_tr_b16 a[36:37], v129 offset:32768
v_max_f32 v164, 0, v164
v_max_f32 v165, 0, v165
v_max_f32 v166, 0, v166
v_max_f32 v167, 0, v167
v_accvgpr_read_b32 v48, a128
v_accvgpr_read_b32 v49, a129
v_mfma_f32_16x16x16_bf16 v[172:175], v[42:43], a[12:13], v[172:175]
v_accvgpr_read_b32 v50, a130
v_accvgpr_read_b32 v51, a131
v_mul_f32 v164, v164, v48
v_mul_f32 v165, v165, v49
v_mul_f32 v166, v166, v50
v_mul_f32 v167, v167, v51
v_mfma_f32_16x16x16_bf16 a[136:139], v[42:43], a[14:15], a[136:139]
v_cvt_pk_bf16_f32 v164, v164, v165
v_cvt_pk_bf16_f32 v165, v166, v167
v_max_f32 v196, 0, v196
v_max_f32 v197, 0, v197
v_max_f32 v198, 0, v198
v_max_f32 v199, 0, v199
v_mfma_f32_16x16x16_bf16 v[204:207], v[44:45], a[12:13], v[204:207]
v_accvgpr_read_b32 v48, a160
v_accvgpr_read_b32 v49, a161
v_accvgpr_read_b32 v50, a162
v_accvgpr_read_b32 v51, a163
v_mul_f32 v196, v196, v48
v_mul_f32 v197, v197, v49
v_mfma_f32_16x16x16_bf16 a[168:171], v[44:45], a[14:15], a[168:171]
v_mul_f32 v198, v198, v50
v_mul_f32 v199, v199, v51
v_cvt_pk_bf16_f32 v166, v196, v197
v_cvt_pk_bf16_f32 v167, v198, v199
buffer_store_dwordx4 v[164:167], v4, s[20:23], s38 offen offset:1024 sc1
ds_write_b128 v52, v[164:167] offset:1024
ds_read_b64_tr_b16 a[38:39], v129 offset:33792
v_xor_b32 v129, 32, v128
ds_read_b64_tr_b16 a[40:41], v129 offset:0
ds_read_b64_tr_b16 a[42:43], v129 offset:1024
ds_read_b64_tr_b16 a[44:45], v129 offset:32768
ds_read_b64_tr_b16 a[46:47], v129 offset:33792
v_and_b32 v127, 8, v19
v_cmp_eq_u32 vcc, 0, v127
v_mov_b32 v127, 1.0
s_waitcnt lgkmcnt(9)
v_cndmask_b32_e64 v127, v127, -1.0, vcc
v_accvgpr_read_b32 v104, a212
v_accvgpr_read_b32 v105, a213
v_accvgpr_read_b32 v106, a214
v_accvgpr_read_b32 v107, a215
v_mul_f32 v104, v104, v56
v_mul_f32 v105, v105, v57
v_mul_f32 v106, v106, v58
v_mul_f32 v107, v107, v59
v_cvt_pk_bf16_f32 v88, v104, v105
v_cvt_pk_bf16_f32 v89, v106, v107
v_accvgpr_read_b32 v104, a216
v_accvgpr_read_b32 v105, a217
v_accvgpr_read_b32 v106, a218
v_accvgpr_read_b32 v107, a219
v_mul_f32 v104, v104, v60
v_mul_f32 v105, v105, v61
v_mul_f32 v106, v106, v62
v_mul_f32 v107, v107, v63
v_cvt_pk_bf16_f32 v90, v104, v105
v_max_f32 v168, 0, v168
v_add_u32 v52, s41, v5
v_max_f32 v169, 0, v169
v_max_f32 v170, 0, v170
v_max_f32 v171, 0, v171
v_accvgpr_read_b32 v48, a132
v_mfma_f32_16x16x16_bf16 v[176:179], v[42:43], a[16:17], v[176:179]
v_accvgpr_read_b32 v49, a133
v_accvgpr_read_b32 v50, a134
v_accvgpr_read_b32 v51, a135
v_mul_f32 v168, v168, v48
v_mul_f32 v169, v169, v49
v_mul_f32 v170, v170, v50
v_mfma_f32_16x16x16_bf16 a[140:143], v[42:43], a[18:19], a[140:143]
v_mul_f32 v171, v171, v51
v_cvt_pk_bf16_f32 v168, v168, v169
v_cvt_pk_bf16_f32 v169, v170, v171
v_max_f32 v200, 0, v200
v_max_f32 v201, 0, v201
v_max_f32 v202, 0, v202
v_mfma_f32_16x16x16_bf16 v[208:211], v[44:45], a[16:17], v[208:211]
v_max_f32 v203, 0, v203
v_accvgpr_read_b32 v48, a164
v_accvgpr_read_b32 v49, a165
v_accvgpr_read_b32 v50, a166
v_accvgpr_read_b32 v51, a167
v_mul_f32 v200, v200, v48
v_mfma_f32_16x16x16_bf16 a[172:175], v[44:45], a[18:19], a[172:175]
v_mul_f32 v201, v201, v49
v_mul_f32 v202, v202, v50
v_mul_f32 v203, v203, v51
v_cvt_pk_bf16_f32 v170, v200, v201
v_cvt_pk_bf16_f32 v171, v202, v203
buffer_store_dwordx4 v[168:171], v5, s[20:23], s38 offen sc1
ds_write_b128 v52, v[168:171] offset:0
v_cvt_pk_bf16_f32 v91, v106, v107
v_xor_b32 v129, 2048, v128
ds_read_b64_tr_b16 a[48:49], v129 offset:0
ds_read_b64_tr_b16 a[50:51], v129 offset:1024
ds_read_b64_tr_b16 a[52:53], v129 offset:32768
ds_read_b64_tr_b16 a[54:55], v129 offset:33792
v_xor_b32 v129, 2080, v128
ds_read_b64_tr_b16 a[56:57], v129 offset:0
ds_read_b64_tr_b16 a[58:59], v129 offset:1024
ds_read_b64_tr_b16 a[60:61], v129 offset:32768
ds_read_b64_tr_b16 a[62:63], v129 offset:33792
v_accvgpr_read_b32 v104, a220
v_accvgpr_read_b32 v105, a221
v_accvgpr_read_b32 v106, a222
v_accvgpr_read_b32 v107, a223
v_mul_f32 v104, v104, v64
v_mul_f32 v105, v105, v65
v_mul_f32 v106, v106, v66
v_mul_f32 v107, v107, v67
v_cvt_pk_bf16_f32 v92, v104, v105
v_cvt_pk_bf16_f32 v93, v106, v107
v_accvgpr_read_b32 v104, a224
v_accvgpr_read_b32 v105, a225
v_accvgpr_read_b32 v106, a226
v_accvgpr_read_b32 v107, a227
v_mul_f32 v104, v104, v68
v_mul_f32 v105, v105, v69
v_mul_f32 v106, v106, v70
v_mul_f32 v107, v107, v71
v_cvt_pk_bf16_f32 v94, v104, v105
v_max_f32 v172, 0, v172
v_max_f32 v173, 0, v173
v_max_f32 v174, 0, v174
v_max_f32 v175, 0, v175
v_accvgpr_read_b32 v48, a136
v_accvgpr_read_b32 v49, a137
v_mfma_f32_16x16x16_bf16 v[180:183], v[42:43], a[20:21], v[180:183]
v_accvgpr_read_b32 v50, a138
v_accvgpr_read_b32 v51, a139
v_mul_f32 v172, v172, v48
v_mul_f32 v173, v173, v49
v_mul_f32 v174, v174, v50
v_mul_f32 v175, v175, v51
v_mfma_f32_16x16x16_bf16 a[144:147], v[42:43], a[22:23], a[144:147]
v_cvt_pk_bf16_f32 v172, v172, v173
v_cvt_pk_bf16_f32 v173, v174, v175
v_max_f32 v204, 0, v204
v_max_f32 v205, 0, v205
v_max_f32 v206, 0, v206
v_max_f32 v207, 0, v207
v_mfma_f32_16x16x16_bf16 v[212:215], v[44:45], a[20:21], v[212:215]
v_accvgpr_read_b32 v48, a168
v_accvgpr_read_b32 v49, a169
v_accvgpr_read_b32 v50, a170
v_accvgpr_read_b32 v51, a171
v_mul_f32 v204, v204, v48
v_mul_f32 v205, v205, v49
v_mfma_f32_16x16x16_bf16 a[176:179], v[44:45], a[22:23], a[176:179]
v_mul_f32 v206, v206, v50
v_mul_f32 v207, v207, v51
v_cvt_pk_bf16_f32 v174, v204, v205
v_cvt_pk_bf16_f32 v175, v206, v207
buffer_store_dwordx4 v[172:175], v5, s[20:23], s38 offen offset:1024 sc1
ds_write_b128 v52, v[172:175] offset:1024
v_cvt_pk_bf16_f32 v95, v106, v107
v_xor_b32 v129, 4096, v128
ds_read_b64_tr_b16 a[64:65], v129 offset:0
ds_read_b64_tr_b16 a[66:67], v129 offset:1024
ds_read_b64_tr_b16 a[68:69], v129 offset:32768
ds_read_b64_tr_b16 a[70:71], v129 offset:33792
v_xor_b32 v129, 4128, v128
ds_read_b64_tr_b16 a[72:73], v129 offset:0
ds_read_b64_tr_b16 a[74:75], v129 offset:1024
ds_read_b64_tr_b16 a[76:77], v129 offset:32768
ds_read_b64_tr_b16 a[78:79], v129 offset:33792
v_accvgpr_read_b32 v104, a228
v_accvgpr_read_b32 v105, a229
v_accvgpr_read_b32 v106, a230
v_accvgpr_read_b32 v107, a231
v_mul_f32 v104, v104, v72
v_mul_f32 v105, v105, v73
v_mul_f32 v106, v106, v74
v_mul_f32 v107, v107, v75
v_cvt_pk_bf16_f32 v96, v104, v105
v_cvt_pk_bf16_f32 v97, v106, v107
v_accvgpr_read_b32 v104, a232
v_accvgpr_read_b32 v105, a233
v_accvgpr_read_b32 v106, a234
v_accvgpr_read_b32 v107, a235
v_mul_f32 v104, v104, v76
v_mul_f32 v105, v105, v77
v_mul_f32 v106, v106, v78
v_mul_f32 v107, v107, v79
v_cvt_pk_bf16_f32 v98, v104, v105
v_max_f32 v176, 0, v176
v_add_u32 v52, s41, v6
v_max_f32 v177, 0, v177
v_max_f32 v178, 0, v178
v_max_f32 v179, 0, v179
v_accvgpr_read_b32 v48, a140
v_mfma_f32_16x16x16_bf16 v[184:187], v[42:43], a[24:25], v[184:187]
v_accvgpr_read_b32 v49, a141
v_accvgpr_read_b32 v50, a142
v_accvgpr_read_b32 v51, a143
v_mul_f32 v176, v176, v48
v_mul_f32 v177, v177, v49
v_mul_f32 v178, v178, v50
v_mfma_f32_16x16x16_bf16 a[148:151], v[42:43], a[26:27], a[148:151]
v_mul_f32 v179, v179, v51
v_cvt_pk_bf16_f32 v176, v176, v177
v_cvt_pk_bf16_f32 v177, v178, v179
v_max_f32 v208, 0, v208
v_max_f32 v209, 0, v209
v_max_f32 v210, 0, v210
v_mfma_f32_16x16x16_bf16 v[216:219], v[44:45], a[24:25], v[216:219]
v_max_f32 v211, 0, v211
v_accvgpr_read_b32 v48, a172
v_accvgpr_read_b32 v49, a173
v_accvgpr_read_b32 v50, a174
v_accvgpr_read_b32 v51, a175
v_mul_f32 v208, v208, v48
v_mfma_f32_16x16x16_bf16 a[180:183], v[44:45], a[26:27], a[180:183]
v_mul_f32 v209, v209, v49
v_mul_f32 v210, v210, v50
v_mul_f32 v211, v211, v51
v_cvt_pk_bf16_f32 v178, v208, v209
v_cvt_pk_bf16_f32 v179, v210, v211
buffer_store_dwordx4 v[176:179], v6, s[20:23], s38 offen sc1
ds_write_b128 v52, v[176:179] offset:0
v_cvt_pk_bf16_f32 v99, v106, v107
v_xor_b32 v129, 6144, v128
ds_read_b64_tr_b16 a[80:81], v129 offset:0
ds_read_b64_tr_b16 a[82:83], v129 offset:1024
ds_read_b64_tr_b16 a[84:85], v129 offset:32768
ds_read_b64_tr_b16 a[86:87], v129 offset:33792
v_xor_b32 v129, 6176, v128
ds_read_b64_tr_b16 a[88:89], v129 offset:0
ds_read_b64_tr_b16 a[90:91], v129 offset:1024
ds_read_b64_tr_b16 a[92:93], v129 offset:32768
ds_read_b64_tr_b16 a[94:95], v129 offset:33792
v_accvgpr_read_b32 v104, a236
v_accvgpr_read_b32 v105, a237
v_accvgpr_read_b32 v106, a238
v_accvgpr_read_b32 v107, a239
v_mul_f32 v104, v104, v80
v_mul_f32 v105, v105, v81
v_mul_f32 v106, v106, v82
v_mul_f32 v107, v107, v83
v_cvt_pk_bf16_f32 v100, v104, v105
v_cvt_pk_bf16_f32 v101, v106, v107
v_accvgpr_read_b32 v104, a240
v_accvgpr_read_b32 v105, a241
v_accvgpr_read_b32 v106, a242
v_accvgpr_read_b32 v107, a243
v_mul_f32 v104, v104, v84
v_mul_f32 v105, v105, v85
v_mul_f32 v106, v106, v86
v_mul_f32 v107, v107, v87
v_cvt_pk_bf16_f32 v102, v104, v105
v_cvt_pk_bf16_f32 v103, v106, v107
v_max_f32 v180, 0, v180
v_max_f32 v181, 0, v181
v_max_f32 v182, 0, v182
v_max_f32 v183, 0, v183
v_accvgpr_read_b32 v48, a144
v_accvgpr_read_b32 v49, a145
v_mfma_f32_16x16x16_bf16 v[188:191], v[42:43], a[28:29], v[188:191]
v_accvgpr_read_b32 v50, a146
v_accvgpr_read_b32 v51, a147
v_mul_f32 v180, v180, v48
v_mul_f32 v181, v181, v49
v_mul_f32 v182, v182, v50
v_mul_f32 v183, v183, v51
v_mfma_f32_16x16x16_bf16 a[152:155], v[42:43], a[30:31], a[152:155]
v_cvt_pk_bf16_f32 v180, v180, v181
v_cvt_pk_bf16_f32 v181, v182, v183
v_max_f32 v212, 0, v212
v_max_f32 v213, 0, v213
v_max_f32 v214, 0, v214
v_max_f32 v215, 0, v215
v_mfma_f32_16x16x16_bf16 v[220:223], v[44:45], a[28:29], v[220:223]
v_accvgpr_read_b32 v48, a176
v_accvgpr_read_b32 v49, a177
v_accvgpr_read_b32 v50, a178
v_accvgpr_read_b32 v51, a179
v_mul_f32 v212, v212, v48
v_mul_f32 v213, v213, v49
v_mfma_f32_16x16x16_bf16 a[184:187], v[44:45], a[30:31], a[184:187]
v_mul_f32 v214, v214, v50
v_mul_f32 v215, v215, v51
v_cvt_pk_bf16_f32 v182, v212, v213
v_cvt_pk_bf16_f32 v183, v214, v215
buffer_store_dwordx4 v[180:183], v6, s[20:23], s38 offen offset:1024 sc1
ds_write_b128 v52, v[180:183] offset:1024
s_waitcnt lgkmcnt(1)
v_mfma_f32_16x16x32_bf16 v[56:59], a[32:35], v[88:91], 0
v_mfma_f32_16x16x32_bf16 v[104:107], a[36:39], v[88:91], 0
v_mfma_f32_16x16x32_bf16 v[60:63], a[40:43], v[88:91], 0
v_mfma_f32_16x16x32_bf16 v[108:111], a[44:47], v[88:91], 0
s_and_b32 s44, s32, 1
s_cmp_eq_u32 s44, 1
s_mov_b32 s44, 0x03020100
s_cselect_b32 s44, 0x01000302, s44
s_add_u32 s45, s44, 0x04040404
s_bitcmp1_b32 s32, 1
s_cselect_b32 s46, s45, s44
s_cselect_b32 s47, s44, s45
v_mfma_f32_16x16x32_bf16 v[64:67], a[48:51], v[92:95], 0
v_mfma_f32_16x16x32_bf16 v[112:115], a[52:55], v[92:95], 0
v_mfma_f32_16x16x32_bf16 v[68:71], a[56:59], v[92:95], 0
v_mfma_f32_16x16x32_bf16 v[116:119], a[60:63], v[92:95], 0
s_nop 3
v_fmac_f32_dpp v56, v104, v127 row_ror:8 row_mask:0xf bank_mask:0xf
v_fmac_f32_dpp v57, v105, v127 row_ror:8 row_mask:0xf bank_mask:0xf
v_fmac_f32_dpp v58, v106, v127 row_ror:8 row_mask:0xf bank_mask:0xf
v_fmac_f32_dpp v59, v107, v127 row_ror:8 row_mask:0xf bank_mask:0xf
v_fmac_f32_dpp v60, v108, v127 row_ror:8 row_mask:0xf bank_mask:0xf
v_max_f32 v184, 0, v184
v_add_u32 v52, s41, v7
v_max_f32 v185, 0, v185
v_max_f32 v186, 0, v186
v_max_f32 v187, 0, v187
v_accvgpr_read_b32 v48, a148
v_accvgpr_read_b32 v49, a149
v_accvgpr_read_b32 v50, a150
v_accvgpr_read_b32 v51, a151
v_mul_f32 v184, v184, v48
v_mfma_f32_16x16x16_bf16 v[224:227], v[46:47], a[0:1], v[224:227]
v_mul_f32 v185, v185, v49
v_mul_f32 v186, v186, v50
v_mul_f32 v187, v187, v51
v_cvt_pk_bf16_f32 v184, v184, v185
v_cvt_pk_bf16_f32 v185, v186, v187
v_max_f32 v216, 0, v216
v_max_f32 v217, 0, v217
v_max_f32 v218, 0, v218
v_max_f32 v219, 0, v219
v_accvgpr_read_b32 v48, a180
v_mfma_f32_16x16x16_bf16 v[228:231], v[46:47], a[4:5], v[228:231]
v_accvgpr_read_b32 v49, a181
v_accvgpr_read_b32 v50, a182
v_accvgpr_read_b32 v51, a183
v_mul_f32 v216, v216, v48
v_mul_f32 v217, v217, v49
v_mul_f32 v218, v218, v50
v_mul_f32 v219, v219, v51
v_cvt_pk_bf16_f32 v186, v216, v217
v_cvt_pk_bf16_f32 v187, v218, v219
buffer_store_dwordx4 v[184:187], v7, s[20:23], s38 offen sc1
ds_write_b128 v52, v[184:187] offset:0
v_fmac_f32_dpp v61, v109, v127 row_ror:8 row_mask:0xf bank_mask:0xf
v_fmac_f32_dpp v62, v110, v127 row_ror:8 row_mask:0xf bank_mask:0xf
v_fmac_f32_dpp v63, v111, v127 row_ror:8 row_mask:0xf bank_mask:0xf
v_mfma_f32_16x16x32_bf16 v[72:75], a[64:67], v[96:99], 0
v_mfma_f32_16x16x32_bf16 v[104:107], a[68:71], v[96:99], 0
v_mfma_f32_16x16x32_bf16 v[76:79], a[72:75], v[96:99], 0
v_mfma_f32_16x16x32_bf16 v[108:111], a[76:79], v[96:99], 0
s_nop 3
v_fmac_f32_dpp v64, v112, v127 row_ror:8 row_mask:0xf bank_mask:0xf
v_fmac_f32_dpp v65, v113, v127 row_ror:8 row_mask:0xf bank_mask:0xf
v_fmac_f32_dpp v66, v114, v127 row_ror:8 row_mask:0xf bank_mask:0xf
v_fmac_f32_dpp v67, v115, v127 row_ror:8 row_mask:0xf bank_mask:0xf
v_fmac_f32_dpp v68, v116, v127 row_ror:8 row_mask:0xf bank_mask:0xf
v_fmac_f32_dpp v69, v117, v127 row_ror:8 row_mask:0xf bank_mask:0xf
v_fmac_f32_dpp v70, v118, v127 row_ror:8 row_mask:0xf bank_mask:0xf
v_fmac_f32_dpp v71, v119, v127 row_ror:8 row_mask:0xf bank_mask:0xf
v_mfma_f32_16x16x32_bf16 v[80:83], a[80:83], v[100:103], 0
v_mfma_f32_16x16x32_bf16 v[112:115], a[84:87], v[100:103], 0
v_mfma_f32_16x16x32_bf16 v[84:87], a[88:91], v[100:103], 0
v_mfma_f32_16x16x32_bf16 v[116:119], a[92:95], v[100:103], 0
s_nop 3
v_fmac_f32_dpp v72, v104, v127 row_ror:8 row_mask:0xf bank_mask:0xf
v_fmac_f32_dpp v73, v105, v127 row_ror:8 row_mask:0xf bank_mask:0xf
v_fmac_f32_dpp v74, v106, v127 row_ror:8 row_mask:0xf bank_mask:0xf
v_max_f32 v188, 0, v188
v_max_f32 v189, 0, v189
v_max_f32 v190, 0, v190
v_max_f32 v191, 0, v191
v_accvgpr_read_b32 v48, a152
v_accvgpr_read_b32 v49, a153
v_accvgpr_read_b32 v50, a154
v_accvgpr_read_b32 v51, a155
v_mul_f32 v188, v188, v48
v_mul_f32 v189, v189, v49
v_mfma_f32_16x16x16_bf16 v[232:235], v[46:47], a[8:9], v[232:235]
v_mul_f32 v190, v190, v50
v_mul_f32 v191, v191, v51
v_cvt_pk_bf16_f32 v188, v188, v189
v_cvt_pk_bf16_f32 v189, v190, v191
v_max_f32 v220, 0, v220
v_max_f32 v221, 0, v221
v_max_f32 v222, 0, v222
v_max_f32 v223, 0, v223
v_accvgpr_read_b32 v48, a184
v_accvgpr_read_b32 v49, a185
v_mfma_f32_16x16x16_bf16 v[236:239], v[46:47], a[12:13], v[236:239]
v_accvgpr_read_b32 v50, a186
v_accvgpr_read_b32 v51, a187
v_mul_f32 v220, v220, v48
v_mul_f32 v221, v221, v49
v_mul_f32 v222, v222, v50
v_mul_f32 v223, v223, v51
v_cvt_pk_bf16_f32 v190, v220, v221
v_cvt_pk_bf16_f32 v191, v222, v223
buffer_store_dwordx4 v[188:191], v7, s[20:23], s38 offen offset:1024 sc1
ds_write_b128 v52, v[188:191] offset:1024
v_fmac_f32_dpp v75, v107, v127 row_ror:8 row_mask:0xf bank_mask:0xf
v_fmac_f32_dpp v76, v108, v127 row_ror:8 row_mask:0xf bank_mask:0xf
v_fmac_f32_dpp v77, v109, v127 row_ror:8 row_mask:0xf bank_mask:0xf
v_fmac_f32_dpp v78, v110, v127 row_ror:8 row_mask:0xf bank_mask:0xf
v_fmac_f32_dpp v79, v111, v127 row_ror:8 row_mask:0xf bank_mask:0xf
v_mul_u32_u24 v128, 18432, v126
v_and_b32 v129, 7, v19
v_lshl_add_u32 v128, v129, 4, v128
v_and_b32 v129, 8, v19
v_add_u32 v128, v129, v128
s_mul_i32 s44, s33, 147456
s_lshl_b32 s45, s48, 2
s_add_u32 s45, s45, s32
s_lshl_b32 s45, s45, 7
s_add_u32 s44, s44, s45
s_add_u32 s44, s44, 18874368
v_fmac_f32_dpp v80, v112, v127 row_ror:8 row_mask:0xf bank_mask:0xf
v_fmac_f32_dpp v81, v113, v127 row_ror:8 row_mask:0xf bank_mask:0xf
v_fmac_f32_dpp v82, v114, v127 row_ror:8 row_mask:0xf bank_mask:0xf
v_fmac_f32_dpp v83, v115, v127 row_ror:8 row_mask:0xf bank_mask:0xf
v_fmac_f32_dpp v84, v116, v127 row_ror:8 row_mask:0xf bank_mask:0xf
v_fmac_f32_dpp v85, v117, v127 row_ror:8 row_mask:0xf bank_mask:0xf
v_fmac_f32_dpp v86, v118, v127 row_ror:8 row_mask:0xf bank_mask:0xf
v_fmac_f32_dpp v87, v119, v127 row_ror:8 row_mask:0xf bank_mask:0xf
v_permlane32_swap_b32 v224, v228
v_permlane32_swap_b32 v225, v229
v_permlane32_swap_b32 v226, v230
v_permlane32_swap_b32 v227, v231
v_mfma_f32_16x16x16_bf16 v[240:243], v[46:47], a[16:17], v[240:243]
v_max_f32 v224, 0, v224
v_max_f32 v225, 0, v225
v_max_f32 v226, 0, v226
v_max_f32 v227, 0, v227
v_mfma_f32_16x16x16_bf16 v[244:247], v[46:47], a[20:21], v[244:247]
v_mul_f32 v224, v224, v228
v_mul_f32 v225, v225, v229
v_mul_f32 v226, v226, v230
v_mul_f32 v227, v227, v231
v_cvt_pk_bf16_f32 v224, v224, v225
v_cvt_pk_bf16_f32 v225, v226, v227
v_cvt_pk_bf16_f32 v172, v56, v64
v_cvt_pk_bf16_f32 v173, v72, v80
s_add_u32 s45, s44, 0
v_perm_b32 v174, v173, v172, s46
v_perm_b32 v175, v173, v172, s47
buffer_store_dwordx2 v[174:175], v128, s[20:23], s45 offen sc1
v_cvt_pk_bf16_f32 v176, v57, v65
v_cvt_pk_bf16_f32 v177, v73, v81
s_add_u32 s45, s44, 4608
v_perm_b32 v178, v177, v176, s46
v_perm_b32 v179, v177, v176, s47
buffer_store_dwordx2 v[178:179], v128, s[20:23], s45 offen sc1
v_cvt_pk_bf16_f32 v180, v58, v66
v_cvt_pk_bf16_f32 v181, v74, v82
s_add_u32 s45, s44, 9216
v_perm_b32 v182, v181, v180, s46
v_perm_b32 v183, v181, v180, s47
buffer_store_dwordx2 v[182:183], v128, s[20:23], s45 offen sc1
v_cvt_pk_bf16_f32 v184, v59, v67
v_permlane32_swap_b32 v232, v236
v_permlane32_swap_b32 v233, v237
v_permlane32_swap_b32 v234, v238
v_permlane32_swap_b32 v235, v239
v_max_f32 v232, 0, v232
v_max_f32 v233, 0, v233
v_mfma_f32_16x16x16_bf16 v[248:251], v[46:47], a[24:25], v[248:251]
v_max_f32 v234, 0, v234
v_max_f32 v235, 0, v235
v_mul_f32 v232, v232, v236
v_mul_f32 v233, v233, v237
v_mul_f32 v234, v234, v238
v_mul_f32 v235, v235, v239
v_mfma_f32_16x16x16_bf16 v[252:255], v[46:47], a[28:29], v[252:255]
v_cvt_pk_bf16_f32 v226, v232, v233
v_cvt_pk_bf16_f32 v227, v234, v235
s_nop 1
v_permlane16_swap_b32 v224, v226
v_permlane16_swap_b32 v225, v227
buffer_store_dwordx4 v[224:227], v15, s[20:23], s39 offen sc1
v_add_u32 v52, s43, v15
ds_write_b128 v52, v[224:227]
v_cvt_pk_bf16_f32 v185, v75, v83
s_add_u32 s45, s44, 13824
v_perm_b32 v186, v185, v184, s46
v_perm_b32 v187, v185, v184, s47
buffer_store_dwordx2 v[186:187], v128, s[20:23], s45 offen sc1
v_cvt_pk_bf16_f32 v188, v60, v68
v_cvt_pk_bf16_f32 v189, v76, v84
s_add_u32 s45, s44, 73728
v_perm_b32 v190, v189, v188, s46
v_perm_b32 v191, v189, v188, s47
buffer_store_dwordx2 v[190:191], v128, s[20:23], s45 offen sc1
v_cvt_pk_bf16_f32 v192, v61, v69
v_cvt_pk_bf16_f32 v193, v77, v85
s_add_u32 s45, s44, 78336
v_perm_b32 v194, v193, v192, s46
v_perm_b32 v195, v193, v192, s47
buffer_store_dwordx2 v[194:195], v128, s[20:23], s45 offen sc1
v_cvt_pk_bf16_f32 v196, v62, v70
v_cvt_pk_bf16_f32 v197, v78, v86
v_permlane32_swap_b32 v240, v244
v_permlane32_swap_b32 v241, v245
v_permlane32_swap_b32 v242, v246
v_permlane32_swap_b32 v243, v247
v_max_f32 v240, 0, v240
v_max_f32 v241, 0, v241
v_max_f32 v242, 0, v242
v_max_f32 v243, 0, v243
v_mul_f32 v240, v240, v244
v_mul_f32 v241, v241, v245
v_mul_f32 v242, v242, v246
v_mul_f32 v243, v243, v247
v_cvt_pk_bf16_f32 v240, v240, v241
v_cvt_pk_bf16_f32 v241, v242, v243
s_add_u32 s45, s44, 82944
v_perm_b32 v198, v197, v196, s46
v_perm_b32 v199, v197, v196, s47
buffer_store_dwordx2 v[198:199], v128, s[20:23], s45 offen sc1
v_cvt_pk_bf16_f32 v200, v63, v71
v_cvt_pk_bf16_f32 v201, v79, v87
s_add_u32 s45, s44, 87552
v_perm_b32 v202, v201, v200, s46
v_perm_b32 v203, v201, v200, s47
buffer_store_dwordx2 v[202:203], v128, s[20:23], s45 offen sc1
v_lshrrev_b32 v120, 2, v19
v_and_b32 v121, 3, v19
v_lshlrev_b32 v121, 3, v121
v_and_b32 v122, 7, v120
v_lshl_add_u32 v122, v122, 5, v121
v_lshl_add_u32 v152, v120, 8, v122
v_bfe_u32 v122, v120, 1, 2
v_lshl_add_u32 v122, v122, 5, v121
v_lshl_add_u32 v122, v120, 7, v122
v_permlane32_swap_b32 v248, v252
v_permlane32_swap_b32 v249, v253
v_permlane32_swap_b32 v250, v254
v_permlane32_swap_b32 v251, v255
v_max_f32 v248, 0, v248
v_max_f32 v249, 0, v249
v_max_f32 v250, 0, v250
v_max_f32 v251, 0, v251
v_mul_f32 v248, v248, v252
v_mul_f32 v249, v249, v253
v_mul_f32 v250, v250, v254
v_mul_f32 v251, v251, v255
v_cvt_pk_bf16_f32 v242, v248, v249
v_cvt_pk_bf16_f32 v243, v250, v251
s_nop 1
v_permlane16_swap_b32 v240, v242
v_permlane16_swap_b32 v241, v243
buffer_store_dwordx4 v[240:243], v16, s[20:23], s39 offen sc1
v_add_u32 v52, s43, v16
ds_write_b128 v52, v[240:243]
v_add_u32 v168, 0x18000, v122
v_add_u32 v160, 0x10000, v152
v_xor_b32 v153, 32, v152
v_xor_b32 v161, 32, v160
v_xor_b32 v154, 64, v152
v_xor_b32 v162, 64, v160
v_xor_b32 v155, 96, v152
v_xor_b32 v163, 96, v160
v_xor_b32 v156, 128, v152
v_xor_b32 v164, 128, v160
v_xor_b32 v157, 160, v152
v_xor_b32 v165, 160, v160
v_xor_b32 v158, 192, v152
v_xor_b32 v166, 192, v160
v_xor_b32 v159, 224, v152
v_xor_b32 v167, 224, v160
v_xor_b32 v169, 32, v168
v_xor_b32 v170, 64, v168
v_xor_b32 v171, 96, v168
v_add_u32 v52, 114688, v11
s_waitcnt vmcnt(31)
s_waitcnt lgkmcnt(0)
s_barrier
ds_read_b128 a[100:103], v11 offset:0
ds_read_b128 a[104:107], v11 offset:1024
ds_read_b128 a[108:111], v11 offset:8192
ds_read_b128 a[112:115], v11 offset:9216
ds_read_b128 a[116:119], v11 offset:16384
ds_read_b128 a[120:123], v11 offset:17408
ds_read_b128 a[124:127], v11 offset:24576
ds_read_b128 a[128:131], v11 offset:25600
ds_read_b128 a[132:135], v11 offset:32768
ds_read_b128 a[136:139], v11 offset:33792
ds_read_b128 a[140:143], v11 offset:40960
ds_read_b128 a[144:147], v11 offset:41984
ds_read_b128 a[148:151], v11 offset:49152
ds_read_b128 a[152:155], v11 offset:50176
ds_read_b128 a[156:159], v11 offset:57344
ds_read_b128 a[160:163], v11 offset:58368
ds_read_b128 a[164:167], v52 offset:0
ds_read_b128 a[168:171], v52 offset:1024
ds_read_b64_tr_b16 a[64:65], v160 offset:0
ds_read_b64_tr_b16 a[66:67], v160 offset:4096
ds_read_b64_tr_b16 a[68:69], v161 offset:0
ds_read_b64_tr_b16 a[70:71], v161 offset:4096
ds_read_b64_tr_b16 a[72:73], v162 offset:0
ds_read_b64_tr_b16 a[74:75], v162 offset:4096
ds_read_b64_tr_b16 a[76:77], v163 offset:0
ds_read_b64_tr_b16 a[78:79], v163 offset:4096
ds_read_b64_tr_b16 a[80:81], v164 offset:0
ds_read_b64_tr_b16 a[82:83], v164 offset:4096
ds_read_b64_tr_b16 a[84:85], v165 offset:0
ds_read_b64_tr_b16 a[86:87], v165 offset:4096
ds_read_b64_tr_b16 a[88:89], v166 offset:0
ds_read_b64_tr_b16 a[90:91], v166 offset:4096
ds_read_b64_tr_b16 a[92:93], v167 offset:0
ds_read_b64_tr_b16 a[94:95], v167 offset:4096
ds_read_b64_tr_b16 a[196:197], v168 offset:32768
ds_read_b64_tr_b16 a[198:199], v168 offset:34816
ds_read_b64_tr_b16 a[200:201], v169 offset:32768
ds_read_b64_tr_b16 a[202:203], v169 offset:34816
ds_read_b64_tr_b16 a[204:205], v170 offset:32768
ds_read_b64_tr_b16 a[206:207], v170 offset:34816
ds_read_b64_tr_b16 a[208:209], v171 offset:32768
ds_read_b64_tr_b16 a[210:211], v171 offset:34816
v_mov_b32 v54, s62
v_add_u32 v244, 0xc000, v160
v_add_u32 v245, 0xc000, v161
v_add_u32 v246, 0xc000, v162
v_add_u32 v247, 0xc000, v163
v_add_u32 v248, 0xc000, v164
v_add_u32 v249, 0xc000, v165
v_add_u32 v250, 0xc000, v166
v_add_u32 v251, 0xc000, v167
s_lshl_b32 s46, s2, 2
s_add_u32 s46, s46, s32
s_lshl_b32 s47, s46, 7
s_add_u32 s85, s47, 21626880
s_add_u32 s94, s47, 21757952
s_lshl_b32 s47, s46, 12
s_add_u32 s95, s47, 31457280
s_lshl_b32 s46, s46, 13
s_add_u32 s37, s46, 22020096
s_add_u32 s38, s37, 4096
v_lshlrev_b32 v52, 4, v19
v_and_b32 v50, 3, v19
v_max_u32 v50, 1, v50
v_xor_b32 v50, s2, v50
s_lshl_b32 s47, s32, 7
v_lshl_add_u32 v50, v50, 9, s47
v_and_b32 v51, 3, v19
v_bfe_u32 v49, v19, 2, 2
v_lshl_or_b32 v51, v49, 3, v51
v_max_u32 v51, 1, v51
v_xor_b32 v51, s2, v51
v_lshl_add_u32 v51, v51, 9, s47
s_and_b32 s46, s2, 0xe4
s_lshl_b32 s46, s46, 14
s_lshl_b32 s47, s32, 12
s_add_u32 s46, s46, s47
s_lshl_b32 s47, s34, 8
s_add_u32 s46, s46, s47
s_add_u32 s39, s46, 31457280
v_and_b32 v48, 1, v19
v_lshlrev_b32 v48, 4, v48
v_mov_b32 v53, 0x3f80
v_lshlrev_b32 v48, v48, v53
v_cmp_eq_u32 vcc, 0, v49
s_nop 1
v_cndmask_b32 v252, 0, v48, vcc
v_cmp_eq_u32 vcc, 1, v49
s_nop 1
v_cndmask_b32 v253, 0, v48, vcc
v_cmp_eq_u32 vcc, 2, v49
s_nop 1
v_cndmask_b32 v254, 0, v48, vcc
v_cmp_eq_u32 vcc, 3, v49
s_nop 1
v_cndmask_b32 v255, 0, v48, vcc
v_lshrrev_b32 v53, 4, v19
v_cmp_eq_u32 vcc, v53, v49
v_bfe_u32 v49, v19, 1, 1
v_lshlrev_b32 v53, 14, v53
v_cndmask_b32 v48, 0, v48, vcc
v_cmp_eq_u32 vcc, 1, v49
v_and_b32 v49, 15, v19
v_lshl_add_u32 v53, v49, 4, v53
v_cndmask_b32 v13, 0, v48, vcc
v_cndmask_b32 v12, v48, v20, vcc
s_waitcnt vmcnt(0) lgkmcnt(15)
s_barrier
buffer_store_dword v54, v21, s[20:23], s90 offen sc1
s_add_u32 m0, s49, 0
s_nop 0
buffer_load_dwordx4 v24, s[4:7], s67 offen lds
buffer_load_dwordx4 v25, s[4:7], s67 offen offset:1024 lds
buffer_load_dwordx4 v26, s[4:7], s67 offen offset:2048 lds
buffer_load_dwordx4 v27, s[4:7], s67 offen offset:3072 lds
s_add_u32 m0, m0, 4096
s_add_u32 s67, s67, 18432
s_nop 0
buffer_load_dwordx4 v24, s[4:7], s67 offen lds
buffer_load_dwordx4 v25, s[4:7], s67 offen offset:1024 lds
buffer_load_dwordx4 v26, s[4:7], s67 offen offset:2048 lds
buffer_load_dwordx4 v27, s[4:7], s67 offen offset:3072 lds
L_g2:
s_waitcnt lgkmcnt(15)
v_mfma_f32_16x16x32_bf16 v[56:59], a[64:67], a[100:103], 0
v_mfma_f32_16x16x32_bf16 v[60:63], a[64:67], a[104:107], 0
ds_read_b64_tr_b16 a[64:65], v160 offset:8192
v_mfma_f32_16x16x32_bf16 v[64:67], a[68:71], a[100:103], 0
ds_read_b64_tr_b16 a[66:67], v160 offset:12288
s_add_u32 m0, s49, 32768
v_mfma_f32_16x16x32_bf16 v[68:71], a[68:71], a[104:107], 0
ds_read_b64_tr_b16 a[68:69], v161 offset:8192
v_mfma_f32_16x16x32_bf16 v[72:75], a[72:75], a[100:103], 0
ds_read_b64_tr_b16 a[70:71], v161 offset:12288
v_mfma_f32_16x16x32_bf16 v[76:79], a[72:75], a[104:107], 0
ds_read_b64_tr_b16 a[72:73], v162 offset:8192
v_mfma_f32_16x16x32_bf16 v[80:83], a[76:79], a[100:103], 0
ds_read_b64_tr_b16 a[74:75], v162 offset:12288
v_mfma_f32_16x16x32_bf16 v[84:87], a[76:79], a[104:107], 0
s_waitcnt lgkmcnt(14)
ds_read_b64_tr_b16 a[76:77], v163 offset:8192
v_mfma_f32_16x16x32_bf16 v[88:91], a[80:83], a[100:103], 0
ds_read_b64_tr_b16 a[78:79], v163 offset:12288
buffer_load_dwordx4 v24, s[4:7], s68 offen lds
v_mfma_f32_16x16x32_bf16 v[92:95], a[80:83], a[104:107], 0
ds_read_b64_tr_b16 a[80:81], v164 offset:8192
v_mfma_f32_16x16x32_bf16 v[96:99], a[84:87], a[100:103], 0
ds_read_b64_tr_b16 a[82:83], v164 offset:12288
v_mfma_f32_16x16x32_bf16 v[100:103], a[84:87], a[104:107], 0
ds_read_b64_tr_b16 a[84:85], v165 offset:8192
v_mfma_f32_16x16x32_bf16 v[104:107], a[88:91], a[100:103], 0
ds_read_b64_tr_b16 a[86:87], v165 offset:12288
v_mfma_f32_16x16x32_bf16 v[108:111], a[88:91], a[104:107], 0
ds_read_b64_tr_b16 a[88:89], v166 offset:8192
v_mfma_f32_16x16x32_bf16 v[112:115], a[92:95], a[100:103], 0
ds_read_b64_tr_b16 a[90:91], v166 offset:12288
buffer_load_dwordx4 v25, s[4:7], s68 offen offset:1024 lds
v_mfma_f32_16x16x32_bf16 v[116:119], a[92:95], a[104:107], 0
s_waitcnt lgkmcnt(14)
ds_read_b64_tr_b16 a[92:93], v167 offset:8192
v_mfma_f32_16x16x32_bf16 v[120:123], a[196:199], a[100:103], 0
ds_read_b64_tr_b16 a[94:95], v167 offset:12288
v_mfma_f32_16x16x32_bf16 v[124:127], a[196:199], a[104:107], 0
ds_read_b64_tr_b16 a[196:197], v168 offset:36864
v_mfma_f32_16x16x32_bf16 v[128:131], a[200:203], a[100:103], 0
ds_read_b64_tr_b16 a[198:199], v168 offset:38912
v_mfma_f32_16x16x32_bf16 v[132:135], a[200:203], a[104:107], 0
ds_read_b64_tr_b16 a[200:201], v169 offset:36864
v_mfma_f32_16x16x32_bf16 v[136:139], a[204:207], a[100:103], 0
ds_read_b64_tr_b16 a[202:203], v169 offset:38912
buffer_load_dwordx4 v26, s[4:7], s68 offen offset:2048 lds
v_mfma_f32_16x16x32_bf16 v[140:143], a[204:207], a[104:107], 0
ds_read_b64_tr_b16 a[204:205], v170 offset:36864
v_mfma_f32_16x16x32_bf16 v[144:147], a[208:211], a[100:103], 0
ds_read_b64_tr_b16 a[206:207], v170 offset:38912
v_mfma_f32_16x16x32_bf16 v[148:151], a[208:211], a[104:107], 0
ds_read_b64_tr_b16 a[208:209], v171 offset:36864
s_waitcnt lgkmcnt(15)
v_mfma_f32_16x16x32_bf16 v[56:59], a[64:67], a[108:111], v[56:59]
ds_read_b64_tr_b16 a[210:211], v171 offset:38912
v_mfma_f32_16x16x32_bf16 v[60:63], a[64:67], a[112:115], v[60:63]
ds_read_b64_tr_b16 a[64:65], v160 offset:16384
v_mfma_f32_16x16x32_bf16 v[64:67], a[68:71], a[108:111], v[64:67]
ds_read_b64_tr_b16 a[66:67], v160 offset:20480
buffer_load_dwordx4 v27, s[4:7], s68 offen offset:3072 lds
v_mfma_f32_16x16x32_bf16 v[68:71], a[68:71], a[112:115], v[68:71]
ds_read_b64_tr_b16 a[68:69], v161 offset:16384
v_mfma_f32_16x16x32_bf16 v[72:75], a[72:75], a[108:111], v[72:75]
ds_read_b64_tr_b16 a[70:71], v161 offset:20480
v_mfma_f32_16x16x32_bf16 v[76:79], a[72:75], a[112:115], v[76:79]
ds_read_b64_tr_b16 a[72:73], v162 offset:16384
v_mfma_f32_16x16x32_bf16 v[80:83], a[76:79], a[108:111], v[80:83]
ds_read_b64_tr_b16 a[74:75], v162 offset:20480
v_mfma_f32_16x16x32_bf16 v[84:87], a[76:79], a[112:115], v[84:87]
s_waitcnt lgkmcnt(14)
ds_read_b64_tr_b16 a[76:77], v163 offset:16384
v_mfma_f32_16x16x32_bf16 v[88:91], a[80:83], a[108:111], v[88:91]
ds_read_b64_tr_b16 a[78:79], v163 offset:20480
v_mfma_f32_16x16x32_bf16 v[92:95], a[80:83], a[112:115], v[92:95]
ds_read_b64_tr_b16 a[80:81], v164 offset:16384
v_mfma_f32_16x16x32_bf16 v[96:99], a[84:87], a[108:111], v[96:99]
ds_read_b64_tr_b16 a[82:83], v164 offset:20480
v_mfma_f32_16x16x32_bf16 v[100:103], a[84:87], a[112:115], v[100:103]
ds_read_b64_tr_b16 a[84:85], v165 offset:16384
s_add_u32 m0, m0, 4096
s_add_u32 s68, s68, 18432
v_mfma_f32_16x16x32_bf16 v[104:107], a[88:91], a[108:111], v[104:107]
ds_read_b64_tr_b16 a[86:87], v165 offset:20480
v_mfma_f32_16x16x32_bf16 v[108:111], a[88:91], a[112:115], v[108:111]
ds_read_b64_tr_b16 a[88:89], v166 offset:16384
v_mfma_f32_16x16x32_bf16 v[112:115], a[92:95], a[108:111], v[112:115]
ds_read_b64_tr_b16 a[90:91], v166 offset:20480
buffer_load_dwordx4 v24, s[4:7], s68 offen lds
v_mfma_f32_16x16x32_bf16 v[116:119], a[92:95], a[112:115], v[116:119]
s_waitcnt lgkmcnt(14)
ds_read_b64_tr_b16 a[92:93], v167 offset:16384
v_mfma_f32_16x16x32_bf16 v[120:123], a[196:199], a[108:111], v[120:123]
ds_read_b64_tr_b16 a[94:95], v167 offset:20480
v_mfma_f32_16x16x32_bf16 v[124:127], a[196:199], a[112:115], v[124:127]
ds_read_b64_tr_b16 a[196:197], v168 offset:40960
v_mfma_f32_16x16x32_bf16 v[128:131], a[200:203], a[108:111], v[128:131]
ds_read_b64_tr_b16 a[198:199], v168 offset:43008
v_mfma_f32_16x16x32_bf16 v[132:135], a[200:203], a[112:115], v[132:135]
ds_read_b64_tr_b16 a[200:201], v169 offset:40960
v_mfma_f32_16x16x32_bf16 v[136:139], a[204:207], a[108:111], v[136:139]
ds_read_b64_tr_b16 a[202:203], v169 offset:43008
buffer_load_dwordx4 v25, s[4:7], s68 offen offset:1024 lds
v_mfma_f32_16x16x32_bf16 v[140:143], a[204:207], a[112:115], v[140:143]
ds_read_b64_tr_b16 a[204:205], v170 offset:40960
v_mfma_f32_16x16x32_bf16 v[144:147], a[208:211], a[108:111], v[144:147]
ds_read_b64_tr_b16 a[206:207], v170 offset:43008
v_mfma_f32_16x16x32_bf16 v[148:151], a[208:211], a[112:115], v[148:151]
ds_read_b64_tr_b16 a[208:209], v171 offset:40960
s_waitcnt lgkmcnt(15)
v_mfma_f32_16x16x32_bf16 v[56:59], a[64:67], a[116:119], v[56:59]
ds_read_b64_tr_b16 a[210:211], v171 offset:43008
v_mfma_f32_16x16x32_bf16 v[60:63], a[64:67], a[120:123], v[60:63]
ds_read_b64_tr_b16 a[64:65], v160 offset:24576
v_mfma_f32_16x16x32_bf16 v[64:67], a[68:71], a[116:119], v[64:67]
ds_read_b64_tr_b16 a[66:67], v160 offset:28672
buffer_load_dwordx4 v26, s[4:7], s68 offen offset:2048 lds
v_mfma_f32_16x16x32_bf16 v[68:71], a[68:71], a[120:123], v[68:71]
ds_read_b64_tr_b16 a[68:69], v161 offset:24576
v_mfma_f32_16x16x32_bf16 v[72:75], a[72:75], a[116:119], v[72:75]
ds_read_b64_tr_b16 a[70:71], v161 offset:28672
v_mfma_f32_16x16x32_bf16 v[76:79], a[72:75], a[120:123], v[76:79]
ds_read_b64_tr_b16 a[72:73], v162 offset:24576
v_mfma_f32_16x16x32_bf16 v[80:83], a[76:79], a[116:119], v[80:83]
ds_read_b64_tr_b16 a[74:75], v162 offset:28672
v_mfma_f32_16x16x32_bf16 v[84:87], a[76:79], a[120:123], v[84:87]
s_waitcnt lgkmcnt(14)
ds_read_b64_tr_b16 a[76:77], v163 offset:24576
v_mfma_f32_16x16x32_bf16 v[88:91], a[80:83], a[116:119], v[88:91]
ds_read_b64_tr_b16 a[78:79], v163 offset:28672
buffer_load_dwordx4 v27, s[4:7], s68 offen offset:3072 lds
v_mfma_f32_16x16x32_bf16 v[92:95], a[80:83], a[120:123], v[92:95]
ds_read_b64_tr_b16 a[80:81], v164 offset:24576
v_mfma_f32_16x16x32_bf16 v[96:99], a[84:87], a[116:119], v[96:99]
ds_read_b64_tr_b16 a[82:83], v164 offset:28672
v_mfma_f32_16x16x32_bf16 v[100:103], a[84:87], a[120:123], v[100:103]
ds_read_b64_tr_b16 a[84:85], v165 offset:24576
v_mfma_f32_16x16x32_bf16 v[104:107], a[88:91], a[116:119], v[104:107]
ds_read_b64_tr_b16 a[86:87], v165 offset:28672
v_mfma_f32_16x16x32_bf16 v[108:111], a[88:91], a[120:123], v[108:111]
ds_read_b64_tr_b16 a[88:89], v166 offset:24576
v_mfma_f32_16x16x32_bf16 v[112:115], a[92:95], a[116:119], v[112:115]
ds_read_b64_tr_b16 a[90:91], v166 offset:28672
v_mfma_f32_16x16x32_bf16 v[116:119], a[92:95], a[120:123], v[116:119]
s_waitcnt lgkmcnt(14)
ds_read_b64_tr_b16 a[92:93], v167 offset:24576
v_mfma_f32_16x16x32_bf16 v[120:123], a[196:199], a[116:119], v[120:123]
ds_read_b64_tr_b16 a[94:95], v167 offset:28672
v_mfma_f32_16x16x32_bf16 v[124:127], a[196:199], a[120:123], v[124:127]
ds_read_b64_tr_b16 a[196:197], v168 offset:45056
v_mfma_f32_16x16x32_bf16 v[128:131], a[200:203], a[116:119], v[128:131]
ds_read_b64_tr_b16 a[198:199], v168 offset:47104
v_mfma_f32_16x16x32_bf16 v[132:135], a[200:203], a[120:123], v[132:135]
ds_read_b64_tr_b16 a[200:201], v169 offset:45056
v_mfma_f32_16x16x32_bf16 v[136:139], a[204:207], a[116:119], v[136:139]
ds_read_b64_tr_b16 a[202:203], v169 offset:47104
v_mfma_f32_16x16x32_bf16 v[140:143], a[204:207], a[120:123], v[140:143]
ds_read_b64_tr_b16 a[204:205], v170 offset:45056
v_mfma_f32_16x16x32_bf16 v[144:147], a[208:211], a[116:119], v[144:147]
ds_read_b64_tr_b16 a[206:207], v170 offset:47104
v_mfma_f32_16x16x32_bf16 v[148:151], a[208:211], a[120:123], v[148:151]
ds_read_b64_tr_b16 a[208:209], v171 offset:45056
s_waitcnt lgkmcnt(15)
v_mfma_f32_16x16x32_bf16 v[56:59], a[64:67], a[124:127], v[56:59]
ds_read_b64_tr_b16 a[210:211], v171 offset:47104
v_mfma_f32_16x16x32_bf16 v[60:63], a[64:67], a[128:131], v[60:63]
v_mfma_f32_16x16x32_bf16 v[64:67], a[68:71], a[124:127], v[64:67]
v_mfma_f32_16x16x32_bf16 v[68:71], a[68:71], a[128:131], v[68:71]
v_mfma_f32_16x16x32_bf16 v[72:75], a[72:75], a[124:127], v[72:75]
v_mfma_f32_16x16x32_bf16 v[76:79], a[72:75], a[128:131], v[76:79]
s_waitcnt vmcnt(8) lgkmcnt(0)
s_barrier
v_mfma_f32_16x16x32_bf16 v[80:83], a[76:79], a[124:127], v[80:83]
ds_read_b64_tr_b16 a[64:65], v152 offset:0
ds_read_b64_tr_b16 a[66:67], v152 offset:4096
v_mfma_f32_16x16x32_bf16 v[84:87], a[76:79], a[128:131], v[84:87]
ds_read_b64_tr_b16 a[68:69], v153 offset:0
s_add_u32 m0, s49, 65536
v_mfma_f32_16x16x32_bf16 v[88:91], a[80:83], a[124:127], v[88:91]
ds_read_b64_tr_b16 a[70:71], v153 offset:4096
ds_read_b64_tr_b16 a[72:73], v154 offset:0
v_mfma_f32_16x16x32_bf16 v[92:95], a[80:83], a[128:131], v[92:95]
ds_read_b64_tr_b16 a[74:75], v154 offset:4096
v_mfma_f32_16x16x32_bf16 v[96:99], a[84:87], a[124:127], v[96:99]
ds_read_b64_tr_b16 a[76:77], v155 offset:0
ds_read_b64_tr_b16 a[78:79], v155 offset:4096
v_mfma_f32_16x16x32_bf16 v[100:103], a[84:87], a[128:131], v[100:103]
ds_read_b64_tr_b16 a[80:81], v156 offset:0
v_mfma_f32_16x16x32_bf16 v[104:107], a[88:91], a[124:127], v[104:107]
ds_read_b64_tr_b16 a[82:83], v156 offset:4096
ds_read_b64_tr_b16 a[84:85], v157 offset:0
v_mfma_f32_16x16x32_bf16 v[108:111], a[88:91], a[128:131], v[108:111]
ds_read_b64_tr_b16 a[86:87], v157 offset:4096
buffer_load_dwordx4 v24, s[4:7], s69 offen lds
v_mfma_f32_16x16x32_bf16 v[112:115], a[92:95], a[124:127], v[112:115]
ds_read_b64_tr_b16 a[88:89], v158 offset:0
ds_read_b64_tr_b16 a[90:91], v158 offset:4096
v_mfma_f32_16x16x32_bf16 v[116:119], a[92:95], a[128:131], v[116:119]
ds_read_b64_tr_b16 a[92:93], v159 offset:0
v_mfma_f32_16x16x32_bf16 v[120:123], a[196:199], a[124:127], v[120:123]
ds_read_b64_tr_b16 a[94:95], v159 offset:4096
v_mfma_f32_16x16x32_bf16 v[124:127], a[196:199], a[128:131], v[124:127]
ds_read_b64_tr_b16 a[196:197], v168 offset:49152
v_mfma_f32_16x16x32_bf16 v[128:131], a[200:203], a[124:127], v[128:131]
ds_read_b64_tr_b16 a[198:199], v168 offset:51200
v_mfma_f32_16x16x32_bf16 v[132:135], a[200:203], a[128:131], v[132:135]
ds_read_b64_tr_b16 a[200:201], v169 offset:49152
buffer_load_dwordx4 v25, s[4:7], s69 offen offset:1024 lds
v_mfma_f32_16x16x32_bf16 v[136:139], a[204:207], a[124:127], v[136:139]
ds_read_b64_tr_b16 a[202:203], v169 offset:51200
v_mfma_f32_16x16x32_bf16 v[140:143], a[204:207], a[128:131], v[140:143]
ds_read_b64_tr_b16 a[204:205], v170 offset:49152
v_mfma_f32_16x16x32_bf16 v[144:147], a[208:211], a[124:127], v[144:147]
ds_read_b64_tr_b16 a[206:207], v170 offset:51200
v_mfma_f32_16x16x32_bf16 v[148:151], a[208:211], a[128:131], v[148:151]
ds_read_b64_tr_b16 a[208:209], v171 offset:49152
s_waitcnt lgkmcnt(15)
v_mfma_f32_16x16x32_bf16 v[56:59], a[64:67], a[132:135], v[56:59]
ds_read_b64_tr_b16 a[210:211], v171 offset:51200
v_mfma_f32_16x16x32_bf16 v[60:63], a[64:67], a[136:139], v[60:63]
ds_read_b64_tr_b16 a[64:65], v152 offset:8192
buffer_load_dwordx4 v26, s[4:7], s69 offen offset:2048 lds
v_mfma_f32_16x16x32_bf16 v[64:67], a[68:71], a[132:135], v[64:67]
ds_read_b64_tr_b16 a[66:67], v152 offset:12288
v_mfma_f32_16x16x32_bf16 v[68:71], a[68:71], a[136:139], v[68:71]
ds_read_b64_tr_b16 a[68:69], v153 offset:8192
v_mfma_f32_16x16x32_bf16 v[72:75], a[72:75], a[132:135], v[72:75]
ds_read_b64_tr_b16 a[70:71], v153 offset:12288
v_mfma_f32_16x16x32_bf16 v[76:79], a[72:75], a[136:139], v[76:79]
ds_read_b64_tr_b16 a[72:73], v154 offset:8192
v_mfma_f32_16x16x32_bf16 v[80:83], a[76:79], a[132:135], v[80:83]
ds_read_b64_tr_b16 a[74:75], v154 offset:12288
v_mfma_f32_16x16x32_bf16 v[84:87], a[76:79], a[136:139], v[84:87]
s_waitcnt lgkmcnt(14)
ds_read_b64_tr_b16 a[76:77], v155 offset:8192
v_mfma_f32_16x16x32_bf16 v[88:91], a[80:83], a[132:135], v[88:91]
ds_read_b64_tr_b16 a[78:79], v155 offset:12288
buffer_load_dwordx4 v27, s[4:7], s69 offen offset:3072 lds
v_mfma_f32_16x16x32_bf16 v[92:95], a[80:83], a[136:139], v[92:95]
ds_read_b64_tr_b16 a[80:81], v156 offset:8192
v_mfma_f32_16x16x32_bf16 v[96:99], a[84:87], a[132:135], v[96:99]
ds_read_b64_tr_b16 a[82:83], v156 offset:12288
v_mfma_f32_16x16x32_bf16 v[100:103], a[84:87], a[136:139], v[100:103]
ds_read_b64_tr_b16 a[84:85], v157 offset:8192
v_mfma_f32_16x16x32_bf16 v[104:107], a[88:91], a[132:135], v[104:107]
ds_read_b64_tr_b16 a[86:87], v157 offset:12288
buffer_load_dword v23, off, s[20:23], s91 sc1
v_mfma_f32_16x16x32_bf16 v[108:111], a[88:91], a[136:139], v[108:111]
ds_read_b64_tr_b16 a[88:89], v158 offset:8192
v_mfma_f32_16x16x32_bf16 v[112:115], a[92:95], a[132:135], v[112:115]
ds_read_b64_tr_b16 a[90:91], v158 offset:12288
v_mfma_f32_16x16x32_bf16 v[116:119], a[92:95], a[136:139], v[116:119]
s_waitcnt lgkmcnt(14)
ds_read_b64_tr_b16 a[92:93], v159 offset:8192
v_mfma_f32_16x16x32_bf16 v[120:123], a[196:199], a[132:135], v[120:123]
ds_read_b64_tr_b16 a[94:95], v159 offset:12288
s_add_u32 m0, m0, 4096
s_add_u32 s69, s69, 18432
v_mfma_f32_16x16x32_bf16 v[124:127], a[196:199], a[136:139], v[124:127]
ds_read_b64_tr_b16 a[196:197], v168 offset:0
v_mfma_f32_16x16x32_bf16 v[128:131], a[200:203], a[132:135], v[128:131]
ds_read_b64_tr_b16 a[198:199], v168 offset:2048
v_mfma_f32_16x16x32_bf16 v[132:135], a[200:203], a[136:139], v[132:135]
ds_read_b64_tr_b16 a[200:201], v169 offset:0
buffer_load_dwordx4 v24, s[4:7], s69 offen lds
v_mfma_f32_16x16x32_bf16 v[136:139], a[204:207], a[132:135], v[136:139]
ds_read_b64_tr_b16 a[202:203], v169 offset:2048
v_mfma_f32_16x16x32_bf16 v[140:143], a[204:207], a[136:139], v[140:143]
ds_read_b64_tr_b16 a[204:205], v170 offset:0
v_mfma_f32_16x16x32_bf16 v[144:147], a[208:211], a[132:135], v[144:147]
ds_read_b64_tr_b16 a[206:207], v170 offset:2048
v_mfma_f32_16x16x32_bf16 v[148:151], a[208:211], a[136:139], v[148:151]
ds_read_b64_tr_b16 a[208:209], v171 offset:0
s_waitcnt lgkmcnt(15)
v_mfma_f32_16x16x32_bf16 v[56:59], a[64:67], a[140:143], v[56:59]
ds_read_b64_tr_b16 a[210:211], v171 offset:2048
v_mfma_f32_16x16x32_bf16 v[60:63], a[64:67], a[144:147], v[60:63]
ds_read_b64_tr_b16 a[64:65], v152 offset:16384
buffer_load_dwordx4 v25, s[4:7], s69 offen offset:1024 lds
v_mfma_f32_16x16x32_bf16 v[64:67], a[68:71], a[140:143], v[64:67]
ds_read_b64_tr_b16 a[66:67], v152 offset:20480
v_mfma_f32_16x16x32_bf16 v[68:71], a[68:71], a[144:147], v[68:71]
ds_read_b64_tr_b16 a[68:69], v153 offset:16384
v_mfma_f32_16x16x32_bf16 v[72:75], a[72:75], a[140:143], v[72:75]
ds_read_b64_tr_b16 a[70:71], v153 offset:20480
v_mfma_f32_16x16x32_bf16 v[76:79], a[72:75], a[144:147], v[76:79]
ds_read_b64_tr_b16 a[72:73], v154 offset:16384
v_mfma_f32_16x16x32_bf16 v[80:83], a[76:79], a[140:143], v[80:83]
ds_read_b64_tr_b16 a[74:75], v154 offset:20480
v_mfma_f32_16x16x32_bf16 v[84:87], a[76:79], a[144:147], v[84:87]
s_waitcnt lgkmcnt(14)
ds_read_b64_tr_b16 a[76:77], v155 offset:16384
v_mfma_f32_16x16x32_bf16 v[88:91], a[80:83], a[140:143], v[88:91]
ds_read_b64_tr_b16 a[78:79], v155 offset:20480
buffer_load_dwordx4 v26, s[4:7], s69 offen offset:2048 lds
v_mfma_f32_16x16x32_bf16 v[92:95], a[80:83], a[144:147], v[92:95]
ds_read_b64_tr_b16 a[80:81], v156 offset:16384
v_mfma_f32_16x16x32_bf16 v[96:99], a[84:87], a[140:143], v[96:99]
ds_read_b64_tr_b16 a[82:83], v156 offset:20480
v_mfma_f32_16x16x32_bf16 v[100:103], a[84:87], a[144:147], v[100:103]
ds_read_b64_tr_b16 a[84:85], v157 offset:16384
v_mfma_f32_16x16x32_bf16 v[104:107], a[88:91], a[140:143], v[104:107]
ds_read_b64_tr_b16 a[86:87], v157 offset:20480
v_mfma_f32_16x16x32_bf16 v[108:111], a[88:91], a[144:147], v[108:111]
ds_read_b64_tr_b16 a[88:89], v158 offset:16384
buffer_load_dwordx4 v27, s[4:7], s69 offen offset:3072 lds
v_mfma_f32_16x16x32_bf16 v[112:115], a[92:95], a[140:143], v[112:115]
ds_read_b64_tr_b16 a[90:91], v158 offset:20480
s_add_u32 m0, s49, 114688
v_mfma_f32_16x16x32_bf16 v[116:119], a[92:95], a[144:147], v[116:119]
s_waitcnt lgkmcnt(14)
ds_read_b64_tr_b16 a[92:93], v159 offset:16384
v_mfma_f32_16x16x32_bf16 v[120:123], a[196:199], a[140:143], v[120:123]
ds_read_b64_tr_b16 a[94:95], v159 offset:20480
v_mfma_f32_16x16x32_bf16 v[124:127], a[196:199], a[144:147], v[124:127]
ds_read_b64_tr_b16 a[196:197], v168 offset:4096
v_mfma_f32_16x16x32_bf16 v[128:131], a[200:203], a[140:143], v[128:131]
ds_read_b64_tr_b16 a[198:199], v168 offset:6144
v_mfma_f32_16x16x32_bf16 v[132:135], a[200:203], a[144:147], v[132:135]
ds_read_b64_tr_b16 a[200:201], v169 offset:4096
v_mfma_f32_16x16x32_bf16 v[136:139], a[204:207], a[140:143], v[136:139]
ds_read_b64_tr_b16 a[202:203], v169 offset:6144
buffer_load_dwordx4 v24, s[4:7], s70 offen lds
v_mfma_f32_16x16x32_bf16 v[140:143], a[204:207], a[144:147], v[140:143]
ds_read_b64_tr_b16 a[204:205], v170 offset:4096
v_mfma_f32_16x16x32_bf16 v[144:147], a[208:211], a[140:143], v[144:147]
ds_read_b64_tr_b16 a[206:207], v170 offset:6144
v_mfma_f32_16x16x32_bf16 v[148:151], a[208:211], a[144:147], v[148:151]
ds_read_b64_tr_b16 a[208:209], v171 offset:4096
s_waitcnt lgkmcnt(15)
v_mfma_f32_16x16x32_bf16 v[56:59], a[64:67], a[148:151], v[56:59]
ds_read_b64_tr_b16 a[210:211], v171 offset:6144
s_waitcnt vmcnt(5)
v_readfirstlane_b32 s44, v23
s_nop 0
s_cmp_eq_u32 s44, s62
s_cbranch_scc0 L_fl1
L_fl1_r:
v_mfma_f32_16x16x32_bf16 v[60:63], a[64:67], a[152:155], v[60:63]
ds_read_b64_tr_b16 a[64:65], v152 offset:24576
s_add_u32 s41, s61, s82
v_mfma_f32_16x16x32_bf16 v[64:67], a[68:71], a[148:151], v[64:67]
ds_read_b64_tr_b16 a[66:67], v152 offset:28672
buffer_load_dwordx4 a[172:175], v11, s[20:23], s41 offen sc1
v_mfma_f32_16x16x32_bf16 v[68:71], a[68:71], a[152:155], v[68:71]
ds_read_b64_tr_b16 a[68:69], v153 offset:24576
buffer_load_dwordx4 v25, s[4:7], s70 offen offset:1024 lds
v_mfma_f32_16x16x32_bf16 v[72:75], a[72:75], a[148:151], v[72:75]
ds_read_b64_tr_b16 a[70:71], v153 offset:28672
buffer_load_dwordx4 a[176:179], v11, s[20:23], s41 offen offset:1024 sc1
v_mfma_f32_16x16x32_bf16 v[76:79], a[72:75], a[152:155], v[76:79]
ds_read_b64_tr_b16 a[72:73], v154 offset:24576
v_mfma_f32_16x16x32_bf16 v[80:83], a[76:79], a[148:151], v[80:83]
ds_read_b64_tr_b16 a[74:75], v154 offset:28672
v_mfma_f32_16x16x32_bf16 v[84:87], a[76:79], a[152:155], v[84:87]
s_waitcnt lgkmcnt(14)
ds_read_b64_tr_b16 a[76:77], v155 offset:24576
v_mfma_f32_16x16x32_bf16 v[88:91], a[80:83], a[148:151], v[88:91]
ds_read_b64_tr_b16 a[78:79], v155 offset:28672
buffer_load_dwordx4 v26, s[4:7], s70 offen offset:2048 lds
v_mfma_f32_16x16x32_bf16 v[92:95], a[80:83], a[152:155], v[92:95]
ds_read_b64_tr_b16 a[80:81], v156 offset:24576
s_add_u32 s40, s61, s83
v_mfma_f32_16x16x32_bf16 v[96:99], a[84:87], a[148:151], v[96:99]
ds_read_b64_tr_b16 a[82:83], v156 offset:28672
buffer_load_dwordx4 a[180:183], v11, s[20:23], s40 offen sc1
v_mfma_f32_16x16x32_bf16 v[100:103], a[84:87], a[152:155], v[100:103]
ds_read_b64_tr_b16 a[84:85], v157 offset:24576
v_mfma_f32_16x16x32_bf16 v[104:107], a[88:91], a[148:151], v[104:107]
ds_read_b64_tr_b16 a[86:87], v157 offset:28672
buffer_load_dwordx4 a[184:187], v11, s[20:23], s40 offen offset:1024 sc1
v_mfma_f32_16x16x32_bf16 v[108:111], a[88:91], a[152:155], v[108:111]
ds_read_b64_tr_b16 a[88:89], v158 offset:24576
v_mfma_f32_16x16x32_bf16 v[112:115], a[92:95], a[148:151], v[112:115]
ds_read_b64_tr_b16 a[90:91], v158 offset:28672
buffer_load_dwordx4 v27, s[4:7], s70 offen offset:3072 lds
v_mfma_f32_16x16x32_bf16 v[116:119], a[92:95], a[152:155], v[116:119]
s_waitcnt lgkmcnt(14)
ds_read_b64_tr_b16 a[92:93], v159 offset:24576
v_mfma_f32_16x16x32_bf16 v[120:123], a[196:199], a[148:151], v[120:123]
ds_read_b64_tr_b16 a[94:95], v159 offset:28672
v_mfma_f32_16x16x32_bf16 v[124:127], a[196:199], a[152:155], v[124:127]
ds_read_b64_tr_b16 a[196:197], v168 offset:8192
s_add_u32 s41, s61, s84
v_mfma_f32_16x16x32_bf16 v[128:131], a[200:203], a[148:151], v[128:131]
ds_read_b64_tr_b16 a[198:199], v168 offset:10240
buffer_load_dwordx4 a[188:191], v11, s[20:23], s41 offen sc1
v_mfma_f32_16x16x32_bf16 v[132:135], a[200:203], a[152:155], v[132:135]
ds_read_b64_tr_b16 a[200:201], v169 offset:8192
v_mfma_f32_16x16x32_bf16 v[136:139], a[204:207], a[148:151], v[136:139]
ds_read_b64_tr_b16 a[202:203], v169 offset:10240
buffer_load_dwordx4 a[192:195], v11, s[20:23], s41 offen offset:1024 sc1
v_mfma_f32_16x16x32_bf16 v[140:143], a[204:207], a[152:155], v[140:143]
ds_read_b64_tr_b16 a[204:205], v170 offset:8192
v_mfma_f32_16x16x32_bf16 v[144:147], a[208:211], a[148:151], v[144:147]
ds_read_b64_tr_b16 a[206:207], v170 offset:10240
v_mfma_f32_16x16x32_bf16 v[148:151], a[208:211], a[152:155], v[148:151]
ds_read_b64_tr_b16 a[208:209], v171 offset:8192
s_waitcnt lgkmcnt(15)
v_mfma_f32_16x16x32_bf16 v[56:59], a[64:67], a[156:159], v[56:59]
ds_read_b64_tr_b16 a[210:211], v171 offset:10240
s_add_u32 m0, m0, 4096
s_add_u32 s70, s70, 18432
v_mfma_f32_16x16x32_bf16 v[60:63], a[64:67], a[160:163], v[60:63]
s_add_u32 s40, s61, s86
v_mfma_f32_16x16x32_bf16 v[64:67], a[68:71], a[156:159], v[64:67]
buffer_load_dwordx4 a[100:103], v11, s[20:23], s40 offen sc1
buffer_load_dwordx4 v24, s[4:7], s70 offen lds
v_mfma_f32_16x16x32_bf16 v[68:71], a[68:71], a[160:163], v[68:71]
v_mfma_f32_16x16x32_bf16 v[72:75], a[72:75], a[156:159], v[72:75]
buffer_load_dwordx4 a[104:107], v11, s[20:23], s40 offen offset:1024 sc1
v_mfma_f32_16x16x32_bf16 v[76:79], a[72:75], a[160:163], v[76:79]
s_waitcnt vmcnt(22) lgkmcnt(0)
s_barrier
v_mfma_f32_16x16x32_bf16 v[80:83], a[76:79], a[156:159], v[80:83]
ds_read_b64_tr_b16 a[64:65], v152 offset:32768
ds_read_b64_tr_b16 a[66:67], v152 offset:36864
v_mfma_f32_16x16x32_bf16 v[84:87], a[76:79], a[160:163], v[84:87]
ds_read_b64_tr_b16 a[68:69], v153 offset:32768
v_mfma_f32_16x16x32_bf16 v[88:91], a[80:83], a[156:159], v[88:91]
ds_read_b64_tr_b16 a[70:71], v153 offset:36864
ds_read_b64_tr_b16 a[72:73], v154 offset:32768
v_mfma_f32_16x16x32_bf16 v[92:95], a[80:83], a[160:163], v[92:95]
ds_read_b64_tr_b16 a[74:75], v154 offset:36864
s_add_u32 s41, s61, s87
v_mfma_f32_16x16x32_bf16 v[96:99], a[84:87], a[156:159], v[96:99]
ds_read_b64_tr_b16 a[76:77], v155 offset:32768
ds_read_b64_tr_b16 a[78:79], v155 offset:36864
v_mfma_f32_16x16x32_bf16 v[100:103], a[84:87], a[160:163], v[100:103]
ds_read_b64_tr_b16 a[80:81], v156 offset:32768
buffer_load_dwordx4 a[108:111], v11, s[20:23], s41 offen sc1
v_mfma_f32_16x16x32_bf16 v[104:107], a[88:91], a[156:159], v[104:107]
ds_read_b64_tr_b16 a[82:83], v156 offset:36864
ds_read_b64_tr_b16 a[84:85], v157 offset:32768
v_mfma_f32_16x16x32_bf16 v[108:111], a[88:91], a[160:163], v[108:111]
ds_read_b64_tr_b16 a[86:87], v157 offset:36864
buffer_load_dwordx4 a[112:115], v11, s[20:23], s41 offen offset:1024 sc1
v_mfma_f32_16x16x32_bf16 v[112:115], a[92:95], a[156:159], v[112:115]
ds_read_b64_tr_b16 a[88:89], v158 offset:32768
ds_read_b64_tr_b16 a[90:91], v158 offset:36864
v_mfma_f32_16x16x32_bf16 v[116:119], a[92:95], a[160:163], v[116:119]
ds_read_b64_tr_b16 a[92:93], v159 offset:32768
buffer_load_dwordx4 v25, s[4:7], s70 offen offset:1024 lds
v_mfma_f32_16x16x32_bf16 v[120:123], a[196:199], a[156:159], v[120:123]
ds_read_b64_tr_b16 a[94:95], v159 offset:36864
buffer_load_dwordx4 v26, s[4:7], s70 offen offset:2048 lds
v_mfma_f32_16x16x32_bf16 v[124:127], a[196:199], a[160:163], v[124:127]
ds_read_b64_tr_b16 a[196:197], v168 offset:12288
s_add_u32 s40, s61, s88
v_mfma_f32_16x16x32_bf16 v[128:131], a[200:203], a[156:159], v[128:131]
ds_read_b64_tr_b16 a[198:199], v168 offset:14336
buffer_load_dwordx4 a[116:119], v11, s[20:23], s40 offen sc1
v_mfma_f32_16x16x32_bf16 v[132:135], a[200:203], a[160:163], v[132:135]
ds_read_b64_tr_b16 a[200:201], v169 offset:12288
v_mfma_f32_16x16x32_bf16 v[136:139], a[204:207], a[156:159], v[136:139]
ds_read_b64_tr_b16 a[202:203], v169 offset:14336
buffer_load_dwordx4 a[120:123], v11, s[20:23], s40 offen offset:1024 sc1
v_mfma_f32_16x16x32_bf16 v[140:143], a[204:207], a[160:163], v[140:143]
ds_read_b64_tr_b16 a[204:205], v170 offset:12288
buffer_load_dwordx4 v27, s[4:7], s70 offen offset:3072 lds
v_mfma_f32_16x16x32_bf16 v[144:147], a[208:211], a[156:159], v[144:147]
ds_read_b64_tr_b16 a[206:207], v170 offset:14336
s_add_u32 m0, s49, 0
v_mfma_f32_16x16x32_bf16 v[148:151], a[208:211], a[160:163], v[148:151]
ds_read_b64_tr_b16 a[208:209], v171 offset:12288
s_waitcnt lgkmcnt(15)
v_mfma_f32_16x16x32_bf16 v[56:59], a[64:67], a[164:167], v[56:59]
ds_read_b64_tr_b16 a[210:211], v171 offset:14336
v_mfma_f32_16x16x32_bf16 v[60:63], a[64:67], a[168:171], v[60:63]
ds_read_b64_tr_b16 a[64:65], v152 offset:40960
v_mfma_f32_16x16x32_bf16 v[64:67], a[68:71], a[164:167], v[64:67]
ds_read_b64_tr_b16 a[66:67], v152 offset:45056
v_mfma_f32_16x16x32_bf16 v[68:71], a[68:71], a[168:171], v[68:71]
ds_read_b64_tr_b16 a[68:69], v153 offset:40960
v_mfma_f32_16x16x32_bf16 v[72:75], a[72:75], a[164:167], v[72:75]
ds_read_b64_tr_b16 a[70:71], v153 offset:45056
v_mfma_f32_16x16x32_bf16 v[76:79], a[72:75], a[168:171], v[76:79]
ds_read_b64_tr_b16 a[72:73], v154 offset:40960
buffer_load_dwordx4 v24, s[4:7], s71 offen lds
v_mfma_f32_16x16x32_bf16 v[80:83], a[76:79], a[164:167], v[80:83]
ds_read_b64_tr_b16 a[74:75], v154 offset:45056
v_mfma_f32_16x16x32_bf16 v[84:87], a[76:79], a[168:171], v[84:87]
s_waitcnt lgkmcnt(14)
ds_read_b64_tr_b16 a[76:77], v155 offset:40960
v_mfma_f32_16x16x32_bf16 v[88:91], a[80:83], a[164:167], v[88:91]
ds_read_b64_tr_b16 a[78:79], v155 offset:45056
v_mfma_f32_16x16x32_bf16 v[92:95], a[80:83], a[168:171], v[92:95]
ds_read_b64_tr_b16 a[80:81], v156 offset:40960
s_add_u32 s41, s61, s89
v_mfma_f32_16x16x32_bf16 v[96:99], a[84:87], a[164:167], v[96:99]
ds_read_b64_tr_b16 a[82:83], v156 offset:45056
buffer_load_dwordx4 a[124:127], v11, s[20:23], s41 offen sc1
v_mfma_f32_16x16x32_bf16 v[100:103], a[84:87], a[168:171], v[100:103]
ds_read_b64_tr_b16 a[84:85], v157 offset:40960
v_mfma_f32_16x16x32_bf16 v[104:107], a[88:91], a[164:167], v[104:107]
ds_read_b64_tr_b16 a[86:87], v157 offset:45056
buffer_load_dwordx4 a[128:131], v11, s[20:23], s41 offen offset:1024 sc1
v_mfma_f32_16x16x32_bf16 v[108:111], a[88:91], a[168:171], v[108:111]
ds_read_b64_tr_b16 a[88:89], v158 offset:40960
buffer_load_dwordx4 v25, s[4:7], s71 offen offset:1024 lds
v_mfma_f32_16x16x32_bf16 v[112:115], a[92:95], a[164:167], v[112:115]
ds_read_b64_tr_b16 a[90:91], v158 offset:45056
v_mfma_f32_16x16x32_bf16 v[116:119], a[92:95], a[168:171], v[116:119]
s_waitcnt lgkmcnt(14)
ds_read_b64_tr_b16 a[92:93], v159 offset:40960
v_mfma_f32_16x16x32_bf16 v[120:123], a[196:199], a[164:167], v[120:123]
ds_read_b64_tr_b16 a[94:95], v159 offset:45056
v_mfma_f32_16x16x32_bf16 v[124:127], a[196:199], a[168:171], v[124:127]
v_mfma_f32_16x16x32_bf16 v[128:131], a[200:203], a[164:167], v[128:131]
v_mfma_f32_16x16x32_bf16 v[132:135], a[200:203], a[168:171], v[132:135]
v_mfma_f32_16x16x32_bf16 v[136:139], a[204:207], a[164:167], v[136:139]
buffer_load_dwordx4 v26, s[4:7], s71 offen offset:2048 lds
v_mfma_f32_16x16x32_bf16 v[140:143], a[204:207], a[168:171], v[140:143]
v_mfma_f32_16x16x32_bf16 v[144:147], a[208:211], a[164:167], v[144:147]
v_mfma_f32_16x16x32_bf16 v[148:151], a[208:211], a[168:171], v[148:151]
s_waitcnt vmcnt(21) lgkmcnt(8)
v_mfma_f32_16x16x32_bf16 v[56:59], a[64:67], a[172:175], v[56:59]
v_mfma_f32_16x16x32_bf16 v[60:63], a[64:67], a[176:179], v[60:63]
ds_read_b64_tr_b16 a[64:65], v152 offset:49152
s_add_u32 s40, s61, s64
v_mfma_f32_16x16x32_bf16 v[64:67], a[68:71], a[172:175], v[64:67]
ds_read_b64_tr_b16 a[66:67], v152 offset:53248
buffer_load_dwordx4 a[132:135], v11, s[20:23], s40 offen sc1
v_mfma_f32_16x16x32_bf16 v[68:71], a[68:71], a[176:179], v[68:71]
ds_read_b64_tr_b16 a[68:69], v153 offset:49152
v_mfma_f32_16x16x32_bf16 v[72:75], a[72:75], a[172:175], v[72:75]
ds_read_b64_tr_b16 a[70:71], v153 offset:53248
buffer_load_dwordx4 a[136:139], v11, s[20:23], s40 offen offset:1024 sc1
v_mfma_f32_16x16x32_bf16 v[76:79], a[72:75], a[176:179], v[76:79]
ds_read_b64_tr_b16 a[72:73], v154 offset:49152
buffer_load_dwordx4 v27, s[4:7], s71 offen offset:3072 lds
v_mfma_f32_16x16x32_bf16 v[80:83], a[76:79], a[172:175], v[80:83]
ds_read_b64_tr_b16 a[74:75], v154 offset:53248
v_mfma_f32_16x16x32_bf16 v[84:87], a[76:79], a[176:179], v[84:87]
s_waitcnt lgkmcnt(6)
ds_read_b64_tr_b16 a[76:77], v155 offset:49152
v_mfma_f32_16x16x32_bf16 v[88:91], a[80:83], a[172:175], v[88:91]
ds_read_b64_tr_b16 a[78:79], v155 offset:53248
v_mfma_f32_16x16x32_bf16 v[92:95], a[80:83], a[176:179], v[92:95]
ds_read_b64_tr_b16 a[80:81], v156 offset:49152
v_mfma_f32_16x16x32_bf16 v[96:99], a[84:87], a[172:175], v[96:99]
ds_read_b64_tr_b16 a[82:83], v156 offset:53248
v_mfma_f32_16x16x32_bf16 v[100:103], a[84:87], a[176:179], v[100:103]
ds_read_b64_tr_b16 a[84:85], v157 offset:49152
v_mfma_f32_16x16x32_bf16 v[104:107], a[88:91], a[172:175], v[104:107]
ds_read_b64_tr_b16 a[86:87], v157 offset:53248
buffer_load_dword v23, off, s[20:23], s92 sc1
v_mfma_f32_16x16x32_bf16 v[108:111], a[88:91], a[176:179], v[108:111]
ds_read_b64_tr_b16 a[88:89], v158 offset:49152
v_mfma_f32_16x16x32_bf16 v[112:115], a[92:95], a[172:175], v[112:115]
ds_read_b64_tr_b16 a[90:91], v158 offset:53248
v_mfma_f32_16x16x32_bf16 v[116:119], a[92:95], a[176:179], v[116:119]
ds_read_b64_tr_b16 a[92:93], v159 offset:49152
s_waitcnt vmcnt(22) lgkmcnt(7)
v_mfma_f32_16x16x32_bf16 v[56:59], a[64:67], a[180:183], v[56:59]
ds_read_b64_tr_b16 a[94:95], v159 offset:53248
s_add_u32 m0, m0, 4096
s_add_u32 s71, s71, 18432
v_mfma_f32_16x16x32_bf16 v[60:63], a[64:67], a[184:187], v[60:63]
ds_read_b64_tr_b16 a[64:65], v152 offset:57344
s_add_u32 s41, s61, s50
v_mfma_f32_16x16x32_bf16 v[64:67], a[68:71], a[180:183], v[64:67]
ds_read_b64_tr_b16 a[66:67], v152 offset:61440
buffer_load_dwordx4 a[140:143], v11, s[20:23], s41 offen sc1
v_mfma_f32_16x16x32_bf16 v[68:71], a[68:71], a[184:187], v[68:71]
ds_read_b64_tr_b16 a[68:69], v153 offset:57344
buffer_load_dwordx4 v24, s[4:7], s71 offen lds
v_mfma_f32_16x16x32_bf16 v[72:75], a[72:75], a[180:183], v[72:75]
ds_read_b64_tr_b16 a[70:71], v153 offset:61440
buffer_load_dwordx4 a[144:147], v11, s[20:23], s41 offen offset:1024 sc1
v_mfma_f32_16x16x32_bf16 v[76:79], a[72:75], a[184:187], v[76:79]
ds_read_b64_tr_b16 a[72:73], v154 offset:57344
v_mfma_f32_16x16x32_bf16 v[80:83], a[76:79], a[180:183], v[80:83]
ds_read_b64_tr_b16 a[74:75], v154 offset:61440
v_mfma_f32_16x16x32_bf16 v[84:87], a[76:79], a[184:187], v[84:87]
s_waitcnt lgkmcnt(6)
ds_read_b64_tr_b16 a[76:77], v155 offset:57344
v_mfma_f32_16x16x32_bf16 v[88:91], a[80:83], a[180:183], v[88:91]
ds_read_b64_tr_b16 a[78:79], v155 offset:61440
v_cvt_pk_bf16_f32 v120, v120, v121
v_mfma_f32_16x16x32_bf16 v[92:95], a[80:83], a[184:187], v[92:95]
ds_read_b64_tr_b16 a[80:81], v156 offset:57344
v_cvt_pk_bf16_f32 v121, v122, v123
v_mfma_f32_16x16x32_bf16 v[96:99], a[84:87], a[180:183], v[96:99]
ds_read_b64_tr_b16 a[82:83], v156 offset:61440
v_cvt_pk_bf16_f32 v122, v124, v125
v_mfma_f32_16x16x32_bf16 v[100:103], a[84:87], a[184:187], v[100:103]
ds_read_b64_tr_b16 a[84:85], v157 offset:57344
buffer_load_dwordx4 v25, s[4:7], s71 offen offset:1024 lds
v_mfma_f32_16x16x32_bf16 v[104:107], a[88:91], a[180:183], v[104:107]
ds_read_b64_tr_b16 a[86:87], v157 offset:61440
v_cvt_pk_bf16_f32 v123, v126, v127
v_mfma_f32_16x16x32_bf16 v[108:111], a[88:91], a[184:187], v[108:111]
ds_read_b64_tr_b16 a[88:89], v158 offset:57344
buffer_store_dwordx4 v[120:123], v52, s[20:23], s95 offen offset:0 sc1
v_mfma_f32_16x16x32_bf16 v[112:115], a[92:95], a[180:183], v[112:115]
ds_read_b64_tr_b16 a[90:91], v158 offset:61440
v_mfma_f32_16x16x32_bf16 v[116:119], a[92:95], a[184:187], v[116:119]
ds_read_b64_tr_b16 a[92:93], v159 offset:57344
s_waitcnt vmcnt(24) lgkmcnt(9)
v_mfma_f32_16x16x32_bf16 v[56:59], a[64:67], a[188:191], v[56:59]
ds_read_b64_tr_b16 a[94:95], v159 offset:61440
v_mfma_f32_16x16x32_bf16 v[60:63], a[64:67], a[192:195], v[60:63]
v_mfma_f32_16x16x32_bf16 v[64:67], a[68:71], a[188:191], v[64:67]
buffer_load_dwordx4 v26, s[4:7], s71 offen offset:2048 lds
v_mfma_f32_16x16x32_bf16 v[68:71], a[68:71], a[192:195], v[68:71]
v_mfma_f32_16x16x32_bf16 v[72:75], a[72:75], a[188:191], v[72:75]
v_mfma_f32_16x16x32_bf16 v[76:79], a[72:75], a[192:195], v[76:79]
s_waitcnt vmcnt(35) lgkmcnt(0)
s_barrier
v_mfma_f32_16x16x32_bf16 v[80:83], a[76:79], a[188:191], v[80:83]
ds_read_b64_tr_b16 a[64:65], v160 offset:0
ds_read_b64_tr_b16 a[66:67], v160 offset:4096
v_mfma_f32_16x16x32_bf16 v[84:87], a[76:79], a[192:195], v[84:87]
ds_read_b64_tr_b16 a[68:69], v161 offset:0
v_mfma_f32_16x16x32_bf16 v[88:91], a[80:83], a[188:191], v[88:91]
ds_read_b64_tr_b16 a[70:71], v161 offset:4096
ds_read_b64_tr_b16 a[72:73], v162 offset:0
v_mfma_f32_16x16x32_bf16 v[92:95], a[80:83], a[192:195], v[92:95]
ds_read_b64_tr_b16 a[74:75], v162 offset:4096
v_mfma_f32_16x16x32_bf16 v[96:99], a[84:87], a[188:191], v[96:99]
ds_read_b64_tr_b16 a[76:77], v163 offset:0
ds_read_b64_tr_b16 a[78:79], v163 offset:4096
v_mfma_f32_16x16x32_bf16 v[100:103], a[84:87], a[192:195], v[100:103]
ds_read_b64_tr_b16 a[80:81], v164 offset:0
buffer_load_dwordx4 v27, s[4:7], s71 offen offset:3072 lds
v_mfma_f32_16x16x32_bf16 v[104:107], a[88:91], a[188:191], v[104:107]
ds_read_b64_tr_b16 a[82:83], v164 offset:4096
ds_read_b64_tr_b16 a[84:85], v165 offset:0
v_mfma_f32_16x16x32_bf16 v[108:111], a[88:91], a[192:195], v[108:111]
ds_read_b64_tr_b16 a[86:87], v165 offset:4096
s_add_u32 m0, s49, 32768
v_mfma_f32_16x16x32_bf16 v[112:115], a[92:95], a[188:191], v[112:115]
ds_read_b64_tr_b16 a[88:89], v166 offset:0
ds_read_b64_tr_b16 a[90:91], v166 offset:4096
v_mfma_f32_16x16x32_bf16 v[116:119], a[92:95], a[192:195], v[116:119]
ds_read_b64_tr_b16 a[92:93], v167 offset:0
s_waitcnt vmcnt(23) lgkmcnt(7)
v_mfma_f32_16x16x32_bf16 v[56:59], a[64:67], a[100:103], v[56:59]
ds_read_b64_tr_b16 a[94:95], v167 offset:4096
s_waitcnt vmcnt(7)
v_readfirstlane_b32 s44, v23
s_nop 0
s_cmp_eq_u32 s44, s62
s_cbranch_scc0 L_fl2
L_fl2_r:
v_mfma_f32_16x16x32_bf16 v[60:63], a[64:67], a[104:107], v[60:63]
ds_read_b64_tr_b16 a[64:65], v160 offset:8192
s_add_u32 s40, s63, s82
v_mfma_f32_16x16x32_bf16 v[64:67], a[68:71], a[100:103], v[64:67]
ds_read_b64_tr_b16 a[66:67], v160 offset:12288
buffer_load_dwordx4 a[148:151], v11, s[20:23], s40 offen sc1
v_mfma_f32_16x16x32_bf16 v[68:71], a[68:71], a[104:107], v[68:71]
ds_read_b64_tr_b16 a[68:69], v161 offset:8192
buffer_load_dwordx4 v24, s[4:7], s72 offen lds
v_mfma_f32_16x16x32_bf16 v[72:75], a[72:75], a[100:103], v[72:75]
ds_read_b64_tr_b16 a[70:71], v161 offset:12288
buffer_load_dwordx4 a[152:155], v11, s[20:23], s40 offen offset:1024 sc1
v_mfma_f32_16x16x32_bf16 v[76:79], a[72:75], a[104:107], v[76:79]
ds_read_b64_tr_b16 a[72:73], v162 offset:8192
v_mfma_f32_16x16x32_bf16 v[80:83], a[76:79], a[100:103], v[80:83]
ds_read_b64_tr_b16 a[74:75], v162 offset:12288
v_mfma_f32_16x16x32_bf16 v[84:87], a[76:79], a[104:107], v[84:87]
s_waitcnt lgkmcnt(6)
ds_read_b64_tr_b16 a[76:77], v163 offset:8192
v_mfma_f32_16x16x32_bf16 v[88:91], a[80:83], a[100:103], v[88:91]
ds_read_b64_tr_b16 a[78:79], v163 offset:12288
v_cvt_pk_bf16_f32 v128, v128, v129
v_mfma_f32_16x16x32_bf16 v[92:95], a[80:83], a[104:107], v[92:95]
ds_read_b64_tr_b16 a[80:81], v164 offset:8192
v_cvt_pk_bf16_f32 v129, v130, v131
v_mfma_f32_16x16x32_bf16 v[96:99], a[84:87], a[100:103], v[96:99]
ds_read_b64_tr_b16 a[82:83], v164 offset:12288
v_cvt_pk_bf16_f32 v130, v132, v133
v_mfma_f32_16x16x32_bf16 v[100:103], a[84:87], a[104:107], v[100:103]
ds_read_b64_tr_b16 a[84:85], v165 offset:8192
buffer_load_dwordx4 v25, s[4:7], s72 offen offset:1024 lds
v_mfma_f32_16x16x32_bf16 v[104:107], a[88:91], a[100:103], v[104:107]
ds_read_b64_tr_b16 a[86:87], v165 offset:12288
v_cvt_pk_bf16_f32 v131, v134, v135
v_mfma_f32_16x16x32_bf16 v[108:111], a[88:91], a[104:107], v[108:111]
ds_read_b64_tr_b16 a[88:89], v166 offset:8192
buffer_store_dwordx4 v[128:131], v52, s[20:23], s95 offen offset:1024 sc1
v_mfma_f32_16x16x32_bf16 v[112:115], a[92:95], a[100:103], v[112:115]
ds_read_b64_tr_b16 a[90:91], v166 offset:12288
v_mfma_f32_16x16x32_bf16 v[116:119], a[92:95], a[104:107], v[116:119]
ds_read_b64_tr_b16 a[92:93], v167 offset:8192
s_waitcnt vmcnt(26) lgkmcnt(7)
v_mfma_f32_16x16x32_bf16 v[56:59], a[64:67], a[108:111], v[56:59]
ds_read_b64_tr_b16 a[94:95], v167 offset:12288
v_mfma_f32_16x16x32_bf16 v[60:63], a[64:67], a[112:115], v[60:63]
ds_read_b64_tr_b16 a[64:65], v160 offset:16384
s_add_u32 s41, s63, s83
v_mfma_f32_16x16x32_bf16 v[64:67], a[68:71], a[108:111], v[64:67]
ds_read_b64_tr_b16 a[66:67], v160 offset:20480
buffer_load_dwordx4 a[156:159], v11, s[20:23], s41 offen sc1
v_mfma_f32_16x16x32_bf16 v[68:71], a[68:71], a[112:115], v[68:71]
ds_read_b64_tr_b16 a[68:69], v161 offset:16384
buffer_load_dwordx4 v26, s[4:7], s72 offen offset:2048 lds
v_mfma_f32_16x16x32_bf16 v[72:75], a[72:75], a[108:111], v[72:75]
ds_read_b64_tr_b16 a[70:71], v161 offset:20480
buffer_load_dwordx4 a[160:163], v11, s[20:23], s41 offen offset:1024 sc1
v_mfma_f32_16x16x32_bf16 v[76:79], a[72:75], a[112:115], v[76:79]
ds_read_b64_tr_b16 a[72:73], v162 offset:16384
v_mfma_f32_16x16x32_bf16 v[80:83], a[76:79], a[108:111], v[80:83]
ds_read_b64_tr_b16 a[74:75], v162 offset:20480
v_mfma_f32_16x16x32_bf16 v[84:87], a[76:79], a[112:115], v[84:87]
s_waitcnt lgkmcnt(6)
ds_read_b64_tr_b16 a[76:77], v163 offset:16384
v_mfma_f32_16x16x32_bf16 v[88:91], a[80:83], a[108:111], v[88:91]
ds_read_b64_tr_b16 a[78:79], v163 offset:20480
v_mfma_f32_16x16x32_bf16 v[92:95], a[80:83], a[112:115], v[92:95]
ds_read_b64_tr_b16 a[80:81], v164 offset:16384
v_mfma_f32_16x16x32_bf16 v[96:99], a[84:87], a[108:111], v[96:99]
ds_read_b64_tr_b16 a[82:83], v164 offset:20480
buffer_load_dwordx4 v27, s[4:7], s72 offen offset:3072 lds
v_mfma_f32_16x16x32_bf16 v[100:103], a[84:87], a[112:115], v[100:103]
ds_read_b64_tr_b16 a[84:85], v165 offset:16384
v_mfma_f32_16x16x32_bf16 v[104:107], a[88:91], a[108:111], v[104:107]
ds_read_b64_tr_b16 a[86:87], v165 offset:20480
v_mfma_f32_16x16x32_bf16 v[108:111], a[88:91], a[112:115], v[108:111]
ds_read_b64_tr_b16 a[88:89], v166 offset:16384
v_mfma_f32_16x16x32_bf16 v[112:115], a[92:95], a[108:111], v[112:115]
ds_read_b64_tr_b16 a[90:91], v166 offset:20480
v_mfma_f32_16x16x32_bf16 v[116:119], a[92:95], a[112:115], v[116:119]
ds_read_b64_tr_b16 a[92:93], v167 offset:16384
s_waitcnt vmcnt(26) lgkmcnt(7)
v_mfma_f32_16x16x32_bf16 v[56:59], a[64:67], a[116:119], v[56:59]
ds_read_b64_tr_b16 a[94:95], v167 offset:20480
v_mfma_f32_16x16x32_bf16 v[60:63], a[64:67], a[120:123], v[60:63]
ds_read_b64_tr_b16 a[64:65], v160 offset:24576
s_add_u32 s40, s63, s84
v_mfma_f32_16x16x32_bf16 v[64:67], a[68:71], a[116:119], v[64:67]
ds_read_b64_tr_b16 a[66:67], v160 offset:28672
buffer_load_dwordx4 a[164:167], v11, s[20:23], s40 offen sc1
v_mfma_f32_16x16x32_bf16 v[68:71], a[68:71], a[120:123], v[68:71]
ds_read_b64_tr_b16 a[68:69], v161 offset:24576
v_mfma_f32_16x16x32_bf16 v[72:75], a[72:75], a[116:119], v[72:75]
ds_read_b64_tr_b16 a[70:71], v161 offset:28672
buffer_load_dwordx4 a[168:171], v11, s[20:23], s40 offen offset:1024 sc1
v_mfma_f32_16x16x32_bf16 v[76:79], a[72:75], a[120:123], v[76:79]
ds_read_b64_tr_b16 a[72:73], v162 offset:24576
s_add_u32 m0, m0, 4096
s_add_u32 s72, s72, 18432
v_mfma_f32_16x16x32_bf16 v[80:83], a[76:79], a[116:119], v[80:83]
ds_read_b64_tr_b16 a[74:75], v162 offset:28672
v_mfma_f32_16x16x32_bf16 v[84:87], a[76:79], a[120:123], v[84:87]
s_waitcnt lgkmcnt(6)
ds_read_b64_tr_b16 a[76:77], v163 offset:24576
v_mfma_f32_16x16x32_bf16 v[88:91], a[80:83], a[116:119], v[88:91]
ds_read_b64_tr_b16 a[78:79], v163 offset:28672
v_cvt_pk_bf16_f32 v136, v136, v137
v_mfma_f32_16x16x32_bf16 v[92:95], a[80:83], a[120:123], v[92:95]
ds_read_b64_tr_b16 a[80:81], v164 offset:24576
buffer_load_dwordx4 v24, s[4:7], s72 offen lds
v_mfma_f32_16x16x32_bf16 v[96:99], a[84:87], a[116:119], v[96:99]
ds_read_b64_tr_b16 a[82:83], v164 offset:28672
v_cvt_pk_bf16_f32 v137, v138, v139
v_mfma_f32_16x16x32_bf16 v[100:103], a[84:87], a[120:123], v[100:103]
ds_read_b64_tr_b16 a[84:85], v165 offset:24576
v_cvt_pk_bf16_f32 v138, v140, v141
v_mfma_f32_16x16x32_bf16 v[104:107], a[88:91], a[116:119], v[104:107]
ds_read_b64_tr_b16 a[86:87], v165 offset:28672
v_cvt_pk_bf16_f32 v139, v142, v143
v_mfma_f32_16x16x32_bf16 v[108:111], a[88:91], a[120:123], v[108:111]
ds_read_b64_tr_b16 a[88:89], v166 offset:24576
buffer_store_dwordx4 v[136:139], v52, s[20:23], s95 offen offset:2048 sc1
v_mfma_f32_16x16x32_bf16 v[112:115], a[92:95], a[116:119], v[112:115]
ds_read_b64_tr_b16 a[90:91], v166 offset:28672
v_mfma_f32_16x16x32_bf16 v[116:119], a[92:95], a[120:123], v[116:119]
ds_read_b64_tr_b16 a[92:93], v167 offset:24576
s_waitcnt vmcnt(26) lgkmcnt(9)
v_mfma_f32_16x16x32_bf16 v[56:59], a[64:67], a[124:127], v[56:59]
ds_read_b64_tr_b16 a[94:95], v167 offset:28672
v_mfma_f32_16x16x32_bf16 v[60:63], a[64:67], a[128:131], v[60:63]
s_add_u32 s41, s63, s86
buffer_load_dwordx4 v25, s[4:7], s72 offen offset:1024 lds
v_mfma_f32_16x16x32_bf16 v[64:67], a[68:71], a[124:127], v[64:67]
buffer_load_dwordx4 a[172:175], v11, s[20:23], s41 offen sc1
v_mfma_f32_16x16x32_bf16 v[68:71], a[68:71], a[128:131], v[68:71]
v_mfma_f32_16x16x32_bf16 v[72:75], a[72:75], a[124:127], v[72:75]
buffer_load_dwordx4 a[176:179], v11, s[20:23], s41 offen offset:1024 sc1
v_mfma_f32_16x16x32_bf16 v[76:79], a[72:75], a[128:131], v[76:79]
s_waitcnt vmcnt(32) lgkmcnt(0)
s_barrier
v_mfma_f32_16x16x32_bf16 v[80:83], a[76:79], a[124:127], v[80:83]
ds_read_b64_tr_b16 a[64:65], v244 offset:0
ds_read_b64_tr_b16 a[66:67], v244 offset:4096
v_mfma_f32_16x16x32_bf16 v[84:87], a[76:79], a[128:131], v[84:87]
ds_read_b64_tr_b16 a[68:69], v245 offset:0
v_mfma_f32_16x16x32_bf16 v[88:91], a[80:83], a[124:127], v[88:91]
ds_read_b64_tr_b16 a[70:71], v245 offset:4096
ds_read_b64_tr_b16 a[72:73], v246 offset:0
v_mfma_f32_16x16x32_bf16 v[92:95], a[80:83], a[128:131], v[92:95]
ds_read_b64_tr_b16 a[74:75], v246 offset:4096
buffer_load_dwordx4 v26, s[4:7], s72 offen offset:2048 lds
v_mfma_f32_16x16x32_bf16 v[96:99], a[84:87], a[124:127], v[96:99]
ds_read_b64_tr_b16 a[76:77], v247 offset:0
ds_read_b64_tr_b16 a[78:79], v247 offset:4096
v_mfma_f32_16x16x32_bf16 v[100:103], a[84:87], a[128:131], v[100:103]
ds_read_b64_tr_b16 a[80:81], v248 offset:0
v_mfma_f32_16x16x32_bf16 v[104:107], a[88:91], a[124:127], v[104:107]
ds_read_b64_tr_b16 a[82:83], v248 offset:4096
ds_read_b64_tr_b16 a[84:85], v249 offset:0
v_mfma_f32_16x16x32_bf16 v[108:111], a[88:91], a[128:131], v[108:111]
ds_read_b64_tr_b16 a[86:87], v249 offset:4096
v_mfma_f32_16x16x32_bf16 v[112:115], a[92:95], a[124:127], v[112:115]
ds_read_b64_tr_b16 a[88:89], v250 offset:0
ds_read_b64_tr_b16 a[90:91], v250 offset:4096
v_mfma_f32_16x16x32_bf16 v[116:119], a[92:95], a[128:131], v[116:119]
ds_read_b64_tr_b16 a[92:93], v251 offset:0
s_waitcnt vmcnt(26) lgkmcnt(7)
v_mfma_f32_16x16x32_bf16 v[56:59], a[64:67], a[132:135], v[56:59]
ds_read_b64_tr_b16 a[94:95], v251 offset:4096
buffer_load_dwordx4 v27, s[4:7], s72 offen offset:3072 lds
v_mfma_f32_16x16x32_bf16 v[60:63], a[64:67], a[136:139], v[60:63]
ds_read_b64_tr_b16 a[64:65], v244 offset:8192
s_add_u32 s40, s63, s87
v_mfma_f32_16x16x32_bf16 v[64:67], a[68:71], a[132:135], v[64:67]
ds_read_b64_tr_b16 a[66:67], v244 offset:12288
buffer_load_dwordx4 a[180:183], v11, s[20:23], s40 offen sc1
v_mfma_f32_16x16x32_bf16 v[68:71], a[68:71], a[136:139], v[68:71]
ds_read_b64_tr_b16 a[68:69], v245 offset:8192
s_add_u32 m0, s49, 65536
v_mfma_f32_16x16x32_bf16 v[72:75], a[72:75], a[132:135], v[72:75]
ds_read_b64_tr_b16 a[70:71], v245 offset:12288
buffer_load_dwordx4 a[184:187], v11, s[20:23], s40 offen offset:1024 sc1
v_mfma_f32_16x16x32_bf16 v[76:79], a[72:75], a[136:139], v[76:79]
ds_read_b64_tr_b16 a[72:73], v246 offset:8192
v_mfma_f32_16x16x32_bf16 v[80:83], a[76:79], a[132:135], v[80:83]
ds_read_b64_tr_b16 a[74:75], v246 offset:12288
v_mfma_f32_16x16x32_bf16 v[84:87], a[76:79], a[136:139], v[84:87]
s_waitcnt lgkmcnt(6)
ds_read_b64_tr_b16 a[76:77], v247 offset:8192
v_mfma_f32_16x16x32_bf16 v[88:91], a[80:83], a[132:135], v[88:91]
ds_read_b64_tr_b16 a[78:79], v247 offset:12288
buffer_load_dwordx4 v24, s[4:7], s73 offen lds
v_mfma_f32_16x16x32_bf16 v[92:95], a[80:83], a[136:139], v[92:95]
ds_read_b64_tr_b16 a[80:81], v248 offset:8192
v_cvt_pk_bf16_f32 v144, v144, v145
v_mfma_f32_16x16x32_bf16 v[96:99], a[84:87], a[132:135], v[96:99]
ds_read_b64_tr_b16 a[82:83], v248 offset:12288
v_cvt_pk_bf16_f32 v145, v146, v147
v_mfma_f32_16x16x32_bf16 v[100:103], a[84:87], a[136:139], v[100:103]
ds_read_b64_tr_b16 a[84:85], v249 offset:8192
v_cvt_pk_bf16_f32 v146, v148, v149
v_mfma_f32_16x16x32_bf16 v[104:107], a[88:91], a[132:135], v[104:107]
ds_read_b64_tr_b16 a[86:87], v249 offset:12288
v_cvt_pk_bf16_f32 v147, v150, v151
v_mfma_f32_16x16x32_bf16 v[108:111], a[88:91], a[136:139], v[108:111]
ds_read_b64_tr_b16 a[88:89], v250 offset:8192
buffer_store_dwordx4 v[144:147], v52, s[20:23], s95 offen offset:3072 sc1
v_mfma_f32_16x16x32_bf16 v[112:115], a[92:95], a[132:135], v[112:115]
ds_read_b64_tr_b16 a[90:91], v250 offset:12288
v_mfma_f32_16x16x32_bf16 v[116:119], a[92:95], a[136:139], v[116:119]
ds_read_b64_tr_b16 a[92:93], v251 offset:8192
s_waitcnt vmcnt(26) lgkmcnt(7)
v_mfma_f32_16x16x32_bf16 v[56:59], a[64:67], a[140:143], v[56:59]
ds_read_b64_tr_b16 a[94:95], v251 offset:12288
buffer_load_dwordx4 v25, s[4:7], s73 offen offset:1024 lds
v_mfma_f32_16x16x32_bf16 v[60:63], a[64:67], a[144:147], v[60:63]
ds_read_b64_tr_b16 a[64:65], v244 offset:16384
s_add_u32 s41, s63, s88
v_mfma_f32_16x16x32_bf16 v[64:67], a[68:71], a[140:143], v[64:67]
ds_read_b64_tr_b16 a[66:67], v244 offset:20480
buffer_load_dwordx4 a[188:191], v11, s[20:23], s41 offen sc1
v_mfma_f32_16x16x32_bf16 v[68:71], a[68:71], a[144:147], v[68:71]
ds_read_b64_tr_b16 a[68:69], v245 offset:16384
v_mfma_f32_16x16x32_bf16 v[72:75], a[72:75], a[140:143], v[72:75]
ds_read_b64_tr_b16 a[70:71], v245 offset:20480
buffer_load_dwordx4 a[192:195], v11, s[20:23], s41 offen offset:1024 sc1
v_mfma_f32_16x16x32_bf16 v[76:79], a[72:75], a[144:147], v[76:79]
ds_read_b64_tr_b16 a[72:73], v246 offset:16384
v_mfma_f32_16x16x32_bf16 v[80:83], a[76:79], a[140:143], v[80:83]
ds_read_b64_tr_b16 a[74:75], v246 offset:20480
v_mfma_f32_16x16x32_bf16 v[84:87], a[76:79], a[144:147], v[84:87]
s_waitcnt lgkmcnt(6)
ds_read_b64_tr_b16 a[76:77], v247 offset:16384
v_mfma_f32_16x16x32_bf16 v[88:91], a[80:83], a[140:143], v[88:91]
ds_read_b64_tr_b16 a[78:79], v247 offset:20480
buffer_load_dwordx4 v26, s[4:7], s73 offen offset:2048 lds
v_mfma_f32_16x16x32_bf16 v[92:95], a[80:83], a[144:147], v[92:95]
ds_read_b64_tr_b16 a[80:81], v248 offset:16384
v_mfma_f32_16x16x32_bf16 v[96:99], a[84:87], a[140:143], v[96:99]
ds_read_b64_tr_b16 a[82:83], v248 offset:20480
v_mfma_f32_16x16x32_bf16 v[100:103], a[84:87], a[144:147], v[100:103]
ds_read_b64_tr_b16 a[84:85], v249 offset:16384
v_mfma_f32_16x16x32_bf16 v[104:107], a[88:91], a[140:143], v[104:107]
ds_read_b64_tr_b16 a[86:87], v249 offset:20480
v_mfma_f32_16x16x32_bf16 v[108:111], a[88:91], a[144:147], v[108:111]
ds_read_b64_tr_b16 a[88:89], v250 offset:16384
v_mfma_f32_16x16x32_bf16 v[112:115], a[92:95], a[140:143], v[112:115]
ds_read_b64_tr_b16 a[90:91], v250 offset:20480
v_mfma_f32_16x16x32_bf16 v[116:119], a[92:95], a[144:147], v[116:119]
ds_read_b64_tr_b16 a[92:93], v251 offset:16384
s_waitcnt vmcnt(23) lgkmcnt(7)
v_mfma_f32_16x16x32_bf16 v[56:59], a[64:67], a[148:151], v[56:59]
ds_read_b64_tr_b16 a[94:95], v251 offset:20480
buffer_load_dwordx4 v27, s[4:7], s73 offen offset:3072 lds
v_mfma_f32_16x16x32_bf16 v[60:63], a[64:67], a[152:155], v[60:63]
ds_read_b64_tr_b16 a[64:65], v244 offset:24576
s_add_u32 s40, s63, s89
v_mfma_f32_16x16x32_bf16 v[64:67], a[68:71], a[148:151], v[64:67]
ds_read_b64_tr_b16 a[66:67], v244 offset:28672
buffer_load_dwordx4 a[100:103], v11, s[20:23], s40 offen sc1
v_mfma_f32_16x16x32_bf16 v[68:71], a[68:71], a[152:155], v[68:71]
ds_read_b64_tr_b16 a[68:69], v245 offset:24576
v_mfma_f32_16x16x32_bf16 v[72:75], a[72:75], a[148:151], v[72:75]
ds_read_b64_tr_b16 a[70:71], v245 offset:28672
buffer_load_dwordx4 a[104:107], v11, s[20:23], s40 offen offset:1024 sc1
v_mfma_f32_16x16x32_bf16 v[76:79], a[72:75], a[152:155], v[76:79]
ds_read_b64_tr_b16 a[72:73], v246 offset:24576
v_mfma_f32_16x16x32_bf16 v[80:83], a[76:79], a[148:151], v[80:83]
ds_read_b64_tr_b16 a[74:75], v246 offset:28672
v_mfma_f32_16x16x32_bf16 v[84:87], a[76:79], a[152:155], v[84:87]
s_waitcnt lgkmcnt(6)
ds_read_b64_tr_b16 a[76:77], v247 offset:24576
v_mfma_f32_16x16x32_bf16 v[88:91], a[80:83], a[148:151], v[88:91]
ds_read_b64_tr_b16 a[78:79], v247 offset:28672
v_mfma_f32_16x16x32_bf16 v[92:95], a[80:83], a[152:155], v[92:95]
ds_read_b64_tr_b16 a[80:81], v248 offset:24576
v_mfma_f32_16x16x32_bf16 v[96:99], a[84:87], a[148:151], v[96:99]
ds_read_b64_tr_b16 a[82:83], v248 offset:28672
s_add_u32 m0, m0, 4096
s_add_u32 s73, s73, 18432
v_mfma_f32_16x16x32_bf16 v[100:103], a[84:87], a[152:155], v[100:103]
ds_read_b64_tr_b16 a[84:85], v249 offset:24576
v_mfma_f32_16x16x32_bf16 v[104:107], a[88:91], a[148:151], v[104:107]
ds_read_b64_tr_b16 a[86:87], v249 offset:28672
v_mfma_f32_16x16x32_bf16 v[108:111], a[88:91], a[152:155], v[108:111]
ds_read_b64_tr_b16 a[88:89], v250 offset:24576
buffer_load_dword v23, off, s[20:23], s93 sc1
v_mfma_f32_16x16x32_bf16 v[112:115], a[92:95], a[148:151], v[112:115]
ds_read_b64_tr_b16 a[90:91], v250 offset:28672
buffer_load_dwordx4 v24, s[4:7], s73 offen lds
v_mfma_f32_16x16x32_bf16 v[116:119], a[92:95], a[152:155], v[116:119]
ds_read_b64_tr_b16 a[92:93], v251 offset:24576
s_waitcnt vmcnt(23) lgkmcnt(9)
v_mfma_f32_16x16x32_bf16 v[56:59], a[64:67], a[156:159], v[56:59]
ds_read_b64_tr_b16 a[94:95], v251 offset:28672
v_mfma_f32_16x16x32_bf16 v[60:63], a[64:67], a[160:163], v[60:63]
s_add_u32 s41, s63, s64
v_mfma_f32_16x16x32_bf16 v[64:67], a[68:71], a[156:159], v[64:67]
buffer_load_dwordx4 a[108:111], v11, s[20:23], s41 offen sc1
v_mfma_f32_16x16x32_bf16 v[68:71], a[68:71], a[160:163], v[68:71]
v_mfma_f32_16x16x32_bf16 v[72:75], a[72:75], a[156:159], v[72:75]
buffer_load_dwordx4 a[112:115], v11, s[20:23], s41 offen offset:1024 sc1
v_mfma_f32_16x16x32_bf16 v[76:79], a[72:75], a[160:163], v[76:79]
s_waitcnt vmcnt(33) lgkmcnt(0)
s_barrier
v_mfma_f32_16x16x32_bf16 v[80:83], a[76:79], a[156:159], v[80:83]
ds_read_b64_tr_b16 a[64:65], v152 offset:0
ds_read_b64_tr_b16 a[66:67], v152 offset:4096
v_mfma_f32_16x16x32_bf16 v[84:87], a[76:79], a[160:163], v[84:87]
ds_read_b64_tr_b16 a[68:69], v153 offset:0
buffer_load_dwordx4 v25, s[4:7], s73 offen offset:1024 lds
v_mfma_f32_16x16x32_bf16 v[88:91], a[80:83], a[156:159], v[88:91]
ds_read_b64_tr_b16 a[70:71], v153 offset:4096
ds_read_b64_tr_b16 a[72:73], v154 offset:0
v_mfma_f32_16x16x32_bf16 v[92:95], a[80:83], a[160:163], v[92:95]
ds_read_b64_tr_b16 a[74:75], v154 offset:4096
v_mfma_f32_16x16x32_bf16 v[96:99], a[84:87], a[156:159], v[96:99]
ds_read_b64_tr_b16 a[76:77], v155 offset:0
ds_read_b64_tr_b16 a[78:79], v155 offset:4096
v_mfma_f32_16x16x32_bf16 v[100:103], a[84:87], a[160:163], v[100:103]
ds_read_b64_tr_b16 a[80:81], v156 offset:0
v_mfma_f32_16x16x32_bf16 v[104:107], a[88:91], a[156:159], v[104:107]
ds_read_b64_tr_b16 a[82:83], v156 offset:4096
ds_read_b64_tr_b16 a[84:85], v157 offset:0
v_mfma_f32_16x16x32_bf16 v[108:111], a[88:91], a[160:163], v[108:111]
ds_read_b64_tr_b16 a[86:87], v157 offset:4096
buffer_load_dwordx4 v26, s[4:7], s73 offen offset:2048 lds
v_mfma_f32_16x16x32_bf16 v[112:115], a[92:95], a[156:159], v[112:115]
ds_read_b64_tr_b16 a[88:89], v158 offset:0
ds_read_b64_tr_b16 a[90:91], v158 offset:4096
v_mfma_f32_16x16x32_bf16 v[116:119], a[92:95], a[160:163], v[116:119]
ds_read_b64_tr_b16 a[92:93], v159 offset:0
s_waitcnt vmcnt(24) lgkmcnt(7)
v_mfma_f32_16x16x32_bf16 v[56:59], a[64:67], a[164:167], v[56:59]
ds_read_b64_tr_b16 a[94:95], v159 offset:4096
v_mfma_f32_16x16x32_bf16 v[60:63], a[64:67], a[168:171], v[60:63]
ds_read_b64_tr_b16 a[64:65], v152 offset:8192
s_add_u32 s40, s63, s50
v_mfma_f32_16x16x32_bf16 v[64:67], a[68:71], a[164:167], v[64:67]
ds_read_b64_tr_b16 a[66:67], v152 offset:12288
buffer_load_dwordx4 a[116:119], v11, s[20:23], s40 offen sc1
v_mfma_f32_16x16x32_bf16 v[68:71], a[68:71], a[168:171], v[68:71]
ds_read_b64_tr_b16 a[68:69], v153 offset:8192
v_mfma_f32_16x16x32_bf16 v[72:75], a[72:75], a[164:167], v[72:75]
ds_read_b64_tr_b16 a[70:71], v153 offset:12288
buffer_load_dwordx4 a[120:123], v11, s[20:23], s40 offen offset:1024 sc1
v_mfma_f32_16x16x32_bf16 v[76:79], a[72:75], a[168:171], v[76:79]
ds_read_b64_tr_b16 a[72:73], v154 offset:8192
buffer_load_dwordx4 v27, s[4:7], s73 offen offset:3072 lds
v_mfma_f32_16x16x32_bf16 v[80:83], a[76:79], a[164:167], v[80:83]
ds_read_b64_tr_b16 a[74:75], v154 offset:12288
s_add_u32 m0, s49, 114688
v_mfma_f32_16x16x32_bf16 v[84:87], a[76:79], a[168:171], v[84:87]
s_waitcnt lgkmcnt(6)
ds_read_b64_tr_b16 a[76:77], v155 offset:8192
v_mfma_f32_16x16x32_bf16 v[88:91], a[80:83], a[164:167], v[88:91]
ds_read_b64_tr_b16 a[78:79], v155 offset:12288
v_mfma_f32_16x16x32_bf16 v[92:95], a[80:83], a[168:171], v[92:95]
ds_read_b64_tr_b16 a[80:81], v156 offset:8192
v_mfma_f32_16x16x32_bf16 v[96:99], a[84:87], a[164:167], v[96:99]
ds_read_b64_tr_b16 a[82:83], v156 offset:12288
v_mfma_f32_16x16x32_bf16 v[100:103], a[84:87], a[168:171], v[100:103]
ds_read_b64_tr_b16 a[84:85], v157 offset:8192
v_mfma_f32_16x16x32_bf16 v[104:107], a[88:91], a[164:167], v[104:107]
ds_read_b64_tr_b16 a[86:87], v157 offset:12288
v_mfma_f32_16x16x32_bf16 v[108:111], a[88:91], a[168:171], v[108:111]
ds_read_b64_tr_b16 a[88:89], v158 offset:8192
buffer_load_dwordx4 v24, s[4:7], s100 offen lds
v_mfma_f32_16x16x32_bf16 v[112:115], a[92:95], a[164:167], v[112:115]
ds_read_b64_tr_b16 a[90:91], v158 offset:12288
v_mfma_f32_16x16x32_bf16 v[116:119], a[92:95], a[168:171], v[116:119]
ds_read_b64_tr_b16 a[92:93], v159 offset:8192
s_waitcnt vmcnt(23) lgkmcnt(7)
v_mfma_f32_16x16x32_bf16 v[56:59], a[64:67], a[172:175], v[56:59]
ds_read_b64_tr_b16 a[94:95], v159 offset:12288
v_mfma_f32_16x16x32_bf16 v[60:63], a[64:67], a[176:179], v[60:63]
ds_read_b64_tr_b16 a[64:65], v152 offset:16384
s_waitcnt vmcnt(9)
v_readfirstlane_b32 s44, v23
s_nop 0
s_cmp_eq_u32 s44, s62
s_cbranch_scc0 L_fl3
L_fl3_r:
v_mfma_f32_16x16x32_bf16 v[64:67], a[68:71], a[172:175], v[64:67]
ds_read_b64_tr_b16 a[66:67], v152 offset:20480
s_add_u32 s41, s101, s82
v_mfma_f32_16x16x32_bf16 v[68:71], a[68:71], a[176:179], v[68:71]
ds_read_b64_tr_b16 a[68:69], v153 offset:16384
buffer_load_dwordx4 a[124:127], v11, s[20:23], s41 offen sc1
v_mfma_f32_16x16x32_bf16 v[72:75], a[72:75], a[172:175], v[72:75]
ds_read_b64_tr_b16 a[70:71], v153 offset:20480
v_mfma_f32_16x16x32_bf16 v[76:79], a[72:75], a[176:179], v[76:79]
ds_read_b64_tr_b16 a[72:73], v154 offset:16384
buffer_load_dwordx4 a[128:131], v11, s[20:23], s41 offen offset:1024 sc1
v_mfma_f32_16x16x32_bf16 v[80:83], a[76:79], a[172:175], v[80:83]
ds_read_b64_tr_b16 a[74:75], v154 offset:20480
buffer_load_dwordx4 v25, s[4:7], s100 offen offset:1024 lds
v_mfma_f32_16x16x32_bf16 v[84:87], a[76:79], a[176:179], v[84:87]
s_waitcnt lgkmcnt(6)
ds_read_b64_tr_b16 a[76:77], v155 offset:16384
v_mfma_f32_16x16x32_bf16 v[88:91], a[80:83], a[172:175], v[88:91]
ds_read_b64_tr_b16 a[78:79], v155 offset:20480
v_mfma_f32_16x16x32_bf16 v[92:95], a[80:83], a[176:179], v[92:95]
ds_read_b64_tr_b16 a[80:81], v156 offset:16384
v_mfma_f32_16x16x32_bf16 v[96:99], a[84:87], a[172:175], v[96:99]
ds_read_b64_tr_b16 a[82:83], v156 offset:20480
v_mfma_f32_16x16x32_bf16 v[100:103], a[84:87], a[176:179], v[100:103]
ds_read_b64_tr_b16 a[84:85], v157 offset:16384
v_mfma_f32_16x16x32_bf16 v[104:107], a[88:91], a[172:175], v[104:107]
ds_read_b64_tr_b16 a[86:87], v157 offset:20480
buffer_load_dwordx4 v26, s[4:7], s100 offen offset:2048 lds
v_mfma_f32_16x16x32_bf16 v[108:111], a[88:91], a[176:179], v[108:111]
ds_read_b64_tr_b16 a[88:89], v158 offset:16384
v_mfma_f32_16x16x32_bf16 v[112:115], a[92:95], a[172:175], v[112:115]
ds_read_b64_tr_b16 a[90:91], v158 offset:20480
v_mfma_f32_16x16x32_bf16 v[116:119], a[92:95], a[176:179], v[116:119]
ds_read_b64_tr_b16 a[92:93], v159 offset:16384
s_waitcnt vmcnt(23) lgkmcnt(7)
v_mfma_f32_16x16x32_bf16 v[56:59], a[64:67], a[180:183], v[56:59]
ds_read_b64_tr_b16 a[94:95], v159 offset:20480
s_mov_b32 s60, 21594112
v_mfma_f32_16x16x32_bf16 v[60:63], a[64:67], a[184:187], v[60:63]
ds_read_b64_tr_b16 a[64:65], v152 offset:24576
buffer_load_dword v23, v9, s[20:23], s60 offen sc1
v_mfma_f32_16x16x32_bf16 v[64:67], a[68:71], a[180:183], v[64:67]
ds_read_b64_tr_b16 a[66:67], v152 offset:28672
s_add_u32 s40, s101, s83
v_mfma_f32_16x16x32_bf16 v[68:71], a[68:71], a[184:187], v[68:71]
ds_read_b64_tr_b16 a[68:69], v153 offset:24576
buffer_load_dwordx4 a[132:135], v11, s[20:23], s40 offen sc1
v_mfma_f32_16x16x32_bf16 v[72:75], a[72:75], a[180:183], v[72:75]
ds_read_b64_tr_b16 a[70:71], v153 offset:28672
buffer_load_dwordx4 v27, s[4:7], s100 offen offset:3072 lds
v_mfma_f32_16x16x32_bf16 v[76:79], a[72:75], a[184:187], v[76:79]
ds_read_b64_tr_b16 a[72:73], v154 offset:24576
buffer_load_dwordx4 a[136:139], v11, s[20:23], s40 offen offset:1024 sc1
v_mfma_f32_16x16x32_bf16 v[80:83], a[76:79], a[180:183], v[80:83]
ds_read_b64_tr_b16 a[74:75], v154 offset:28672
v_mfma_f32_16x16x32_bf16 v[84:87], a[76:79], a[184:187], v[84:87]
s_waitcnt lgkmcnt(6)
ds_read_b64_tr_b16 a[76:77], v155 offset:24576
v_mfma_f32_16x16x32_bf16 v[88:91], a[80:83], a[180:183], v[88:91]
ds_read_b64_tr_b16 a[78:79], v155 offset:28672
v_mfma_f32_16x16x32_bf16 v[92:95], a[80:83], a[184:187], v[92:95]
ds_read_b64_tr_b16 a[80:81], v156 offset:24576
v_mfma_f32_16x16x32_bf16 v[96:99], a[84:87], a[180:183], v[96:99]
ds_read_b64_tr_b16 a[82:83], v156 offset:28672
v_mfma_f32_16x16x32_bf16 v[100:103], a[84:87], a[184:187], v[100:103]
ds_read_b64_tr_b16 a[84:85], v157 offset:24576
v_mfma_f32_16x16x32_bf16 v[104:107], a[88:91], a[180:183], v[104:107]
ds_read_b64_tr_b16 a[86:87], v157 offset:28672
v_mfma_f32_16x16x32_bf16 v[108:111], a[88:91], a[184:187], v[108:111]
ds_read_b64_tr_b16 a[88:89], v158 offset:24576
v_mfma_f32_16x16x32_bf16 v[112:115], a[92:95], a[180:183], v[112:115]
ds_read_b64_tr_b16 a[90:91], v158 offset:28672
v_mfma_f32_16x16x32_bf16 v[116:119], a[92:95], a[184:187], v[116:119]
ds_read_b64_tr_b16 a[92:93], v159 offset:24576
s_waitcnt vmcnt(22) lgkmcnt(9)
v_mfma_f32_16x16x32_bf16 v[56:59], a[64:67], a[188:191], v[56:59]
ds_read_b64_tr_b16 a[94:95], v159 offset:28672
s_add_u32 m0, m0, 4096
s_add_u32 s100, s100, 18432
v_mfma_f32_16x16x32_bf16 v[60:63], a[64:67], a[192:195], v[60:63]
v_mfma_f32_16x16x32_bf16 v[64:67], a[68:71], a[188:191], v[64:67]
s_add_u32 s41, s101, s84
v_mfma_f32_16x16x32_bf16 v[68:71], a[68:71], a[192:195], v[68:71]
buffer_load_dwordx4 a[140:143], v11, s[20:23], s41 offen sc1
buffer_load_dwordx4 v24, s[4:7], s100 offen lds
v_mfma_f32_16x16x32_bf16 v[72:75], a[72:75], a[188:191], v[72:75]
v_mfma_f32_16x16x32_bf16 v[76:79], a[72:75], a[192:195], v[76:79]
s_waitcnt vmcnt(31) lgkmcnt(4)
s_barrier
v_mfma_f32_16x16x32_bf16 v[80:83], a[76:79], a[188:191], v[80:83]
ds_read_b64_tr_b16 a[64:65], v152 offset:32768
ds_read_b64_tr_b16 a[66:67], v152 offset:36864
v_mfma_f32_16x16x32_bf16 v[84:87], a[76:79], a[192:195], v[84:87]
ds_read_b64_tr_b16 a[68:69], v153 offset:32768
buffer_load_dwordx4 a[144:147], v11, s[20:23], s41 offen offset:1024 sc1
v_mfma_f32_16x16x32_bf16 v[88:91], a[80:83], a[188:191], v[88:91]
ds_read_b64_tr_b16 a[70:71], v153 offset:36864
ds_read_b64_tr_b16 a[72:73], v154 offset:32768
v_mfma_f32_16x16x32_bf16 v[92:95], a[80:83], a[192:195], v[92:95]
ds_read_b64_tr_b16 a[74:75], v154 offset:36864
v_mfma_f32_16x16x32_bf16 v[96:99], a[84:87], a[188:191], v[96:99]
ds_read_b64_tr_b16 a[76:77], v155 offset:32768
ds_read_b64_tr_b16 a[78:79], v155 offset:36864
v_mfma_f32_16x16x32_bf16 v[100:103], a[84:87], a[192:195], v[100:103]
s_waitcnt lgkmcnt(8)
ds_read_b64_tr_b16 a[80:81], v156 offset:32768
v_mfma_f32_16x16x32_bf16 v[104:107], a[88:91], a[188:191], v[104:107]
ds_read_b64_tr_b16 a[82:83], v156 offset:36864
ds_read_b64_tr_b16 a[84:85], v157 offset:32768
v_mfma_f32_16x16x32_bf16 v[108:111], a[88:91], a[192:195], v[108:111]
ds_read_b64_tr_b16 a[86:87], v157 offset:36864
buffer_load_dwordx4 v25, s[4:7], s100 offen offset:1024 lds
v_mfma_f32_16x16x32_bf16 v[112:115], a[92:95], a[188:191], v[112:115]
ds_read_b64_tr_b16 a[88:89], v158 offset:32768
ds_read_b64_tr_b16 a[90:91], v158 offset:36864
v_mfma_f32_16x16x32_bf16 v[116:119], a[92:95], a[192:195], v[116:119]
ds_read_b64_tr_b16 a[92:93], v159 offset:32768
s_waitcnt vmcnt(22) lgkmcnt(7)
v_mfma_f32_16x16x32_bf16 v[56:59], a[64:67], a[100:103], v[56:59]
ds_read_b64_tr_b16 a[94:95], v159 offset:36864
s_waitcnt vmcnt(29)
buffer_store_dword v54, v3, s[20:23], s94 offen sc1
v_mfma_f32_16x16x32_bf16 v[60:63], a[64:67], a[104:107], v[60:63]
ds_read_b64_tr_b16 a[64:65], v152 offset:40960
v_mfma_f32_16x16x32_bf16 v[64:67], a[68:71], a[100:103], v[64:67]
ds_read_b64_tr_b16 a[66:67], v152 offset:45056
s_add_u32 s40, s101, s86
v_mfma_f32_16x16x32_bf16 v[68:71], a[68:71], a[104:107], v[68:71]
ds_read_b64_tr_b16 a[68:69], v153 offset:40960
buffer_load_dwordx4 a[148:151], v11, s[20:23], s40 offen sc1
v_mfma_f32_16x16x32_bf16 v[72:75], a[72:75], a[100:103], v[72:75]
ds_read_b64_tr_b16 a[70:71], v153 offset:45056
buffer_load_dwordx4 v26, s[4:7], s100 offen offset:2048 lds
v_mfma_f32_16x16x32_bf16 v[76:79], a[72:75], a[104:107], v[76:79]
ds_read_b64_tr_b16 a[72:73], v154 offset:40960
buffer_load_dwordx4 a[152:155], v11, s[20:23], s40 offen offset:1024 sc1
v_mfma_f32_16x16x32_bf16 v[80:83], a[76:79], a[100:103], v[80:83]
ds_read_b64_tr_b16 a[74:75], v154 offset:45056
v_mfma_f32_16x16x32_bf16 v[84:87], a[76:79], a[104:107], v[84:87]
s_waitcnt lgkmcnt(6)
ds_read_b64_tr_b16 a[76:77], v155 offset:40960
v_mfma_f32_16x16x32_bf16 v[88:91], a[80:83], a[100:103], v[88:91]
ds_read_b64_tr_b16 a[78:79], v155 offset:45056
v_mfma_f32_16x16x32_bf16 v[92:95], a[80:83], a[104:107], v[92:95]
ds_read_b64_tr_b16 a[80:81], v156 offset:40960
v_mfma_f32_16x16x32_bf16 v[96:99], a[84:87], a[100:103], v[96:99]
ds_read_b64_tr_b16 a[82:83], v156 offset:45056
buffer_load_dwordx4 v27, s[4:7], s100 offen offset:3072 lds
v_mfma_f32_16x16x32_bf16 v[100:103], a[84:87], a[104:107], v[100:103]
ds_read_b64_tr_b16 a[84:85], v157 offset:40960
v_mfma_f32_16x16x32_bf16 v[104:107], a[88:91], a[100:103], v[104:107]
ds_read_b64_tr_b16 a[86:87], v157 offset:45056
v_mfma_f32_16x16x32_bf16 v[108:111], a[88:91], a[104:107], v[108:111]
ds_read_b64_tr_b16 a[88:89], v158 offset:40960
v_mfma_f32_16x16x32_bf16 v[112:115], a[92:95], a[100:103], v[112:115]
ds_read_b64_tr_b16 a[90:91], v158 offset:45056
v_mfma_f32_16x16x32_bf16 v[116:119], a[92:95], a[104:107], v[116:119]
ds_read_b64_tr_b16 a[92:93], v159 offset:40960
s_waitcnt vmcnt(23) lgkmcnt(7)
v_mfma_f32_16x16x32_bf16 v[56:59], a[64:67], a[108:111], v[56:59]
ds_read_b64_tr_b16 a[94:95], v159 offset:45056
v_mfma_f32_16x16x32_bf16 v[60:63], a[64:67], a[112:115], v[60:63]
ds_read_b64_tr_b16 a[64:65], v152 offset:49152
v_mfma_f32_16x16x32_bf16 v[64:67], a[68:71], a[108:111], v[64:67]
ds_read_b64_tr_b16 a[66:67], v152 offset:53248
s_add_u32 s41, s101, s87
v_mfma_f32_16x16x32_bf16 v[68:71], a[68:71], a[112:115], v[68:71]
ds_read_b64_tr_b16 a[68:69], v153 offset:49152
buffer_load_dwordx4 a[156:159], v11, s[20:23], s41 offen sc1
v_mfma_f32_16x16x32_bf16 v[72:75], a[72:75], a[108:111], v[72:75]
ds_read_b64_tr_b16 a[70:71], v153 offset:53248
v_mfma_f32_16x16x32_bf16 v[76:79], a[72:75], a[112:115], v[76:79]
ds_read_b64_tr_b16 a[72:73], v154 offset:49152
buffer_load_dwordx4 a[160:163], v11, s[20:23], s41 offen offset:1024 sc1
v_mfma_f32_16x16x32_bf16 v[80:83], a[76:79], a[108:111], v[80:83]
ds_read_b64_tr_b16 a[74:75], v154 offset:53248
v_mfma_f32_16x16x32_bf16 v[84:87], a[76:79], a[112:115], v[84:87]
s_waitcnt lgkmcnt(6)
ds_read_b64_tr_b16 a[76:77], v155 offset:49152
v_mfma_f32_16x16x32_bf16 v[88:91], a[80:83], a[108:111], v[88:91]
ds_read_b64_tr_b16 a[78:79], v155 offset:53248
v_mfma_f32_16x16x32_bf16 v[92:95], a[80:83], a[112:115], v[92:95]
ds_read_b64_tr_b16 a[80:81], v156 offset:49152
v_mfma_f32_16x16x32_bf16 v[96:99], a[84:87], a[108:111], v[96:99]
ds_read_b64_tr_b16 a[82:83], v156 offset:53248
v_mfma_f32_16x16x32_bf16 v[100:103], a[84:87], a[112:115], v[100:103]
ds_read_b64_tr_b16 a[84:85], v157 offset:49152
v_mfma_f32_16x16x32_bf16 v[104:107], a[88:91], a[108:111], v[104:107]
ds_read_b64_tr_b16 a[86:87], v157 offset:53248
v_mfma_f32_16x16x32_bf16 v[108:111], a[88:91], a[112:115], v[108:111]
ds_read_b64_tr_b16 a[88:89], v158 offset:49152
v_mfma_f32_16x16x32_bf16 v[112:115], a[92:95], a[108:111], v[112:115]
ds_read_b64_tr_b16 a[90:91], v158 offset:53248
v_mfma_f32_16x16x32_bf16 v[116:119], a[92:95], a[112:115], v[116:119]
ds_read_b64_tr_b16 a[92:93], v159 offset:49152
s_waitcnt vmcnt(21) lgkmcnt(7)
v_mfma_f32_16x16x32_bf16 v[56:59], a[64:67], a[116:119], v[56:59]
ds_read_b64_tr_b16 a[94:95], v159 offset:53248
v_mfma_f32_16x16x32_bf16 v[60:63], a[64:67], a[120:123], v[60:63]
ds_read_b64_tr_b16 a[64:65], v152 offset:57344
v_mfma_f32_16x16x32_bf16 v[64:67], a[68:71], a[116:119], v[64:67]
ds_read_b64_tr_b16 a[66:67], v152 offset:61440
s_add_u32 s40, s101, s88
v_mfma_f32_16x16x32_bf16 v[68:71], a[68:71], a[120:123], v[68:71]
ds_read_b64_tr_b16 a[68:69], v153 offset:57344
buffer_load_dwordx4 a[164:167], v11, s[20:23], s40 offen sc1
v_mfma_f32_16x16x32_bf16 v[72:75], a[72:75], a[116:119], v[72:75]
ds_read_b64_tr_b16 a[70:71], v153 offset:61440
s_lshl_b32 s45, s32, 12
s_add_u32 m0, s45, 147456
v_mfma_f32_16x16x32_bf16 v[76:79], a[72:75], a[120:123], v[76:79]
ds_read_b64_tr_b16 a[72:73], v154 offset:57344
buffer_load_dwordx4 a[168:171], v11, s[20:23], s40 offen offset:1024 sc1
v_mfma_f32_16x16x32_bf16 v[80:83], a[76:79], a[116:119], v[80:83]
ds_read_b64_tr_b16 a[74:75], v154 offset:61440
v_mfma_f32_16x16x32_bf16 v[84:87], a[76:79], a[120:123], v[84:87]
s_waitcnt lgkmcnt(6)
ds_read_b64_tr_b16 a[76:77], v155 offset:57344
v_mfma_f32_16x16x32_bf16 v[88:91], a[80:83], a[116:119], v[88:91]
ds_read_b64_tr_b16 a[78:79], v155 offset:61440
s_lshl_b32 s45, s32, 11
s_add_u32 s45, s45, 21561344
v_mfma_f32_16x16x32_bf16 v[92:95], a[80:83], a[120:123], v[92:95]
ds_read_b64_tr_b16 a[80:81], v156 offset:57344
buffer_load_dwordx4 v11, s[20:23], s45 offen offset:0 sc1 lds
v_mfma_f32_16x16x32_bf16 v[96:99], a[84:87], a[116:119], v[96:99]
ds_read_b64_tr_b16 a[82:83], v156 offset:61440
v_mfma_f32_16x16x32_bf16 v[100:103], a[84:87], a[120:123], v[100:103]
ds_read_b64_tr_b16 a[84:85], v157 offset:57344
v_mfma_f32_16x16x32_bf16 v[104:107], a[88:91], a[116:119], v[104:107]
ds_read_b64_tr_b16 a[86:87], v157 offset:61440
buffer_load_dwordx4 v11, s[20:23], s45 offen offset:1024 sc1 lds
v_mfma_f32_16x16x32_bf16 v[108:111], a[88:91], a[120:123], v[108:111]
ds_read_b64_tr_b16 a[88:89], v158 offset:57344
v_mfma_f32_16x16x32_bf16 v[112:115], a[92:95], a[116:119], v[112:115]
ds_read_b64_tr_b16 a[90:91], v158 offset:61440
v_mfma_f32_16x16x32_bf16 v[116:119], a[92:95], a[120:123], v[116:119]
ds_read_b64_tr_b16 a[92:93], v159 offset:57344
s_waitcnt vmcnt(21) lgkmcnt(9)
v_mfma_f32_16x16x32_bf16 v[56:59], a[64:67], a[124:127], v[56:59]
ds_read_b64_tr_b16 a[94:95], v159 offset:61440
buffer_load_dwordx4 v11, s[20:23], s45 offen offset:2048 sc1 lds
v_mfma_f32_16x16x32_bf16 v[60:63], a[64:67], a[128:131], v[60:63]
v_mfma_f32_16x16x32_bf16 v[64:67], a[68:71], a[124:127], v[64:67]
s_add_u32 s41, s101, s89
v_mfma_f32_16x16x32_bf16 v[68:71], a[68:71], a[128:131], v[68:71]
buffer_load_dwordx4 a[172:175], v11, s[20:23], s41 offen sc1
v_mfma_f32_16x16x32_bf16 v[72:75], a[72:75], a[124:127], v[72:75]
buffer_load_dwordx4 v11, s[20:23], s45 offen offset:3072 sc1 lds
v_mfma_f32_16x16x32_bf16 v[76:79], a[72:75], a[128:131], v[76:79]
s_waitcnt vmcnt(27) lgkmcnt(4)
s_barrier
v_mfma_f32_16x16x32_bf16 v[80:83], a[76:79], a[124:127], v[80:83]
ds_read_b64_tr_b16 a[64:65], v160 offset:0
ds_read_b64_tr_b16 a[66:67], v160 offset:4096
v_mfma_f32_16x16x32_bf16 v[84:87], a[76:79], a[128:131], v[84:87]
ds_read_b64_tr_b16 a[68:69], v161 offset:0
buffer_load_dwordx4 a[176:179], v11, s[20:23], s41 offen offset:1024 sc1
v_mfma_f32_16x16x32_bf16 v[88:91], a[80:83], a[124:127], v[88:91]
ds_read_b64_tr_b16 a[70:71], v161 offset:4096
ds_read_b64_tr_b16 a[72:73], v162 offset:0
v_mfma_f32_16x16x32_bf16 v[92:95], a[80:83], a[128:131], v[92:95]
ds_read_b64_tr_b16 a[74:75], v162 offset:4096
v_mfma_f32_16x16x32_bf16 v[96:99], a[84:87], a[124:127], v[96:99]
ds_read_b64_tr_b16 a[76:77], v163 offset:0
ds_read_b64_tr_b16 a[78:79], v163 offset:4096
v_mfma_f32_16x16x32_bf16 v[100:103], a[84:87], a[128:131], v[100:103]
s_waitcnt lgkmcnt(8)
ds_read_b64_tr_b16 a[80:81], v164 offset:0
v_mfma_f32_16x16x32_bf16 v[104:107], a[88:91], a[124:127], v[104:107]
ds_read_b64_tr_b16 a[82:83], v164 offset:4096
ds_read_b64_tr_b16 a[84:85], v165 offset:0
v_mfma_f32_16x16x32_bf16 v[108:111], a[88:91], a[128:131], v[108:111]
ds_read_b64_tr_b16 a[86:87], v165 offset:4096
v_mfma_f32_16x16x32_bf16 v[112:115], a[92:95], a[124:127], v[112:115]
ds_read_b64_tr_b16 a[88:89], v166 offset:0
ds_read_b64_tr_b16 a[90:91], v166 offset:4096
v_mfma_f32_16x16x32_bf16 v[116:119], a[92:95], a[128:131], v[116:119]
ds_read_b64_tr_b16 a[92:93], v167 offset:0
s_waitcnt vmcnt(19) lgkmcnt(5)
v_mfma_f32_16x16x32_bf16 v[72:75], a[72:75], a[132:135], v[72:75]
ds_read_b64_tr_b16 a[94:95], v167 offset:4096
v_mfma_f32_16x16x32_bf16 v[76:79], a[72:75], a[136:139], v[76:79]
ds_read_b64_tr_b16 a[72:73], v162 offset:8192
v_mfma_f32_16x16x32_bf16 v[80:83], a[76:79], a[132:135], v[80:83]
ds_read_b64_tr_b16 a[74:75], v162 offset:12288
s_add_u32 s40, s101, s64
v_mfma_f32_16x16x32_bf16 v[84:87], a[76:79], a[136:139], v[84:87]
ds_read_b64_tr_b16 a[76:77], v163 offset:8192
buffer_load_dwordx4 a[180:183], v11, s[20:23], s40 offen sc1
v_mfma_f32_16x16x32_bf16 v[88:91], a[80:83], a[132:135], v[88:91]
ds_read_b64_tr_b16 a[78:79], v163 offset:12288
v_mfma_f32_16x16x32_bf16 v[92:95], a[80:83], a[136:139], v[92:95]
s_waitcnt lgkmcnt(4)
ds_read_b64_tr_b16 a[80:81], v164 offset:8192
v_mfma_f32_16x16x32_bf16 v[96:99], a[84:87], a[132:135], v[96:99]
ds_read_b64_tr_b16 a[82:83], v164 offset:12288
buffer_load_dwordx4 a[184:187], v11, s[20:23], s40 offen offset:1024 sc1
v_mfma_f32_16x16x32_bf16 v[100:103], a[84:87], a[136:139], v[100:103]
ds_read_b64_tr_b16 a[84:85], v165 offset:8192
v_mfma_f32_16x16x32_bf16 v[104:107], a[88:91], a[132:135], v[104:107]
ds_read_b64_tr_b16 a[86:87], v165 offset:12288
v_mfma_f32_16x16x32_bf16 v[108:111], a[88:91], a[136:139], v[108:111]
ds_read_b64_tr_b16 a[88:89], v166 offset:8192
v_mfma_f32_16x16x32_bf16 v[112:115], a[92:95], a[132:135], v[112:115]
ds_read_b64_tr_b16 a[90:91], v166 offset:12288
ds_read_b64_tr_b16 a[196:197], v160 offset:8192
v_mfma_f32_16x16x32_bf16 v[116:119], a[92:95], a[136:139], v[116:119]
ds_read_b64_tr_b16 a[92:93], v167 offset:8192
s_waitcnt vmcnt(18) lgkmcnt(6)
v_mfma_f32_16x16x32_bf16 v[72:75], a[72:75], a[140:143], v[72:75]
ds_read_b64_tr_b16 a[94:95], v167 offset:12288
ds_read_b64_tr_b16 a[198:199], v160 offset:12288
v_mfma_f32_16x16x32_bf16 v[76:79], a[72:75], a[144:147], v[76:79]
ds_read_b64_tr_b16 a[72:73], v162 offset:16384
v_mfma_f32_16x16x32_bf16 v[80:83], a[76:79], a[140:143], v[80:83]
ds_read_b64_tr_b16 a[74:75], v162 offset:20480
ds_read_b64_tr_b16 a[200:201], v161 offset:8192
v_mfma_f32_16x16x32_bf16 v[84:87], a[76:79], a[144:147], v[84:87]
ds_read_b64_tr_b16 a[76:77], v163 offset:16384
v_mfma_f32_16x16x32_bf16 v[88:91], a[80:83], a[140:143], v[88:91]
ds_read_b64_tr_b16 a[78:79], v163 offset:20480
ds_read_b64_tr_b16 a[202:203], v161 offset:12288
v_mfma_f32_16x16x32_bf16 v[92:95], a[80:83], a[144:147], v[92:95]
s_waitcnt lgkmcnt(7)
ds_read_b64_tr_b16 a[80:81], v164 offset:16384
v_mfma_f32_16x16x32_bf16 v[96:99], a[84:87], a[140:143], v[96:99]
ds_read_b64_tr_b16 a[82:83], v164 offset:20480
s_add_u32 s41, s101, s50
v_mfma_f32_16x16x32_bf16 v[100:103], a[84:87], a[144:147], v[100:103]
ds_read_b64_tr_b16 a[84:85], v165 offset:16384
buffer_load_dwordx4 a[188:191], v11, s[20:23], s41 offen sc1
v_mfma_f32_16x16x32_bf16 v[104:107], a[88:91], a[140:143], v[104:107]
ds_read_b64_tr_b16 a[86:87], v165 offset:20480
ds_read_b64_tr_b16 a[204:205], v160 offset:16384
v_mfma_f32_16x16x32_bf16 v[108:111], a[88:91], a[144:147], v[108:111]
ds_read_b64_tr_b16 a[88:89], v166 offset:16384
buffer_load_dwordx4 a[192:195], v11, s[20:23], s41 offen offset:1024 sc1
s_waitcnt vmcnt(26)
v_cmp_ne_u32 vcc, s62, v23
v_mfma_f32_16x16x32_bf16 v[112:115], a[92:95], a[140:143], v[112:115]
ds_read_b64_tr_b16 a[90:91], v166 offset:20480
ds_read_b64_tr_b16 a[206:207], v160 offset:20480
s_cmp_eq_u64 vcc, 0
s_cselect_b32 s81, 1, 0
s_cselect_b32 s78, s76, 1073741824
v_mfma_f32_16x16x32_bf16 v[116:119], a[92:95], a[144:147], v[116:119]
ds_read_b64_tr_b16 a[92:93], v167 offset:16384
s_waitcnt vmcnt(15) lgkmcnt(7)
v_mfma_f32_16x16x32_bf16 v[72:75], a[72:75], a[148:151], v[72:75]
ds_read_b64_tr_b16 a[94:95], v167 offset:20480
ds_read_b64_tr_b16 a[208:209], v161 offset:16384
v_mfma_f32_16x16x32_bf16 v[76:79], a[72:75], a[152:155], v[76:79]
ds_read_b64_tr_b16 a[72:73], v162 offset:24576
buffer_load_dwordx4 v[172:175], v36, s[20:23], s78 offen sc1
v_mfma_f32_16x16x32_bf16 v[80:83], a[76:79], a[148:151], v[80:83]
ds_read_b64_tr_b16 a[74:75], v162 offset:28672
ds_read_b64_tr_b16 a[210:211], v161 offset:20480
v_mfma_f32_16x16x32_bf16 v[84:87], a[76:79], a[152:155], v[84:87]
ds_read_b64_tr_b16 a[76:77], v163 offset:24576
buffer_load_dwordx4 v[188:191], v37, s[20:23], s78 offen sc1
v_mfma_f32_16x16x32_bf16 v[88:91], a[80:83], a[148:151], v[88:91]
ds_read_b64_tr_b16 a[78:79], v163 offset:28672
v_mfma_f32_16x16x32_bf16 v[92:95], a[80:83], a[152:155], v[92:95]
s_waitcnt lgkmcnt(6)
ds_read_b64_tr_b16 a[80:81], v164 offset:24576
v_mfma_f32_16x16x32_bf16 v[96:99], a[84:87], a[148:151], v[96:99]
ds_read_b64_tr_b16 a[82:83], v164 offset:28672
ds_read_b64_tr_b16 a[212:213], v160 offset:24576
v_mfma_f32_16x16x32_bf16 v[100:103], a[84:87], a[152:155], v[100:103]
ds_read_b64_tr_b16 a[84:85], v165 offset:24576
s_add_u32 s78, s78, 589824
v_mfma_f32_16x16x32_bf16 v[104:107], a[88:91], a[148:151], v[104:107]
ds_read_b64_tr_b16 a[86:87], v165 offset:28672
ds_read_b64_tr_b16 a[214:215], v160 offset:28672
v_mfma_f32_16x16x32_bf16 v[108:111], a[88:91], a[152:155], v[108:111]
ds_read_b64_tr_b16 a[88:89], v166 offset:24576
buffer_load_dwordx4 v[176:179], v36, s[20:23], s78 offen sc1
v_mfma_f32_16x16x32_bf16 v[112:115], a[92:95], a[148:151], v[112:115]
ds_read_b64_tr_b16 a[90:91], v166 offset:28672
ds_read_b64_tr_b16 a[216:217], v161 offset:24576
v_mfma_f32_16x16x32_bf16 v[116:119], a[92:95], a[152:155], v[116:119]
ds_read_b64_tr_b16 a[92:93], v167 offset:24576
s_waitcnt vmcnt(15) lgkmcnt(8)
v_mfma_f32_16x16x32_bf16 v[72:75], a[72:75], a[156:159], v[72:75]
ds_read_b64_tr_b16 a[94:95], v167 offset:28672
ds_read_b64_tr_b16 a[218:219], v161 offset:28672
v_mfma_f32_16x16x32_bf16 v[76:79], a[72:75], a[160:163], v[76:79]
buffer_load_dwordx4 v[192:195], v37, s[20:23], s78 offen sc1
v_mfma_f32_16x16x32_bf16 v[80:83], a[76:79], a[156:159], v[80:83]
s_add_u32 s78, s78, 589824
v_mfma_f32_16x16x32_bf16 v[84:87], a[76:79], a[160:163], v[84:87]
v_mfma_f32_16x16x32_bf16 v[88:91], a[80:83], a[156:159], v[88:91]
v_mfma_f32_16x16x32_bf16 v[92:95], a[80:83], a[160:163], v[92:95]
s_waitcnt vmcnt(9) lgkmcnt(1)
s_barrier
v_mfma_f32_16x16x32_bf16 v[96:99], a[84:87], a[156:159], v[96:99]
ds_read_b64_tr_b16 a[72:73], v246 offset:0
ds_read_b64_tr_b16 a[74:75], v246 offset:4096
v_mfma_f32_16x16x32_bf16 v[100:103], a[84:87], a[160:163], v[100:103]
ds_read_b64_tr_b16 a[76:77], v247 offset:0
ds_read_b64_tr_b16 a[220:221], v244 offset:0
v_mfma_f32_16x16x32_bf16 v[104:107], a[88:91], a[156:159], v[104:107]
ds_read_b64_tr_b16 a[78:79], v247 offset:4096
ds_read_b64_tr_b16 a[80:81], v248 offset:0
v_mfma_f32_16x16x32_bf16 v[108:111], a[88:91], a[160:163], v[108:111]
ds_read_b64_tr_b16 a[82:83], v248 offset:4096
ds_read_b64_tr_b16 a[222:223], v244 offset:4096
v_mfma_f32_16x16x32_bf16 v[112:115], a[92:95], a[156:159], v[112:115]
ds_read_b64_tr_b16 a[84:85], v249 offset:0
ds_read_b64_tr_b16 a[86:87], v249 offset:4096
v_mfma_f32_16x16x32_bf16 v[116:119], a[92:95], a[160:163], v[116:119]
ds_read_b64_tr_b16 a[88:89], v250 offset:0
s_waitcnt vmcnt(14) lgkmcnt(4)
v_mfma_f32_16x16x32_bf16 v[72:75], a[72:75], a[164:167], v[72:75]
ds_read_b64_tr_b16 a[90:91], v250 offset:4096
ds_read_b64_tr_b16 a[92:93], v251 offset:0
v_mfma_f32_16x16x32_bf16 v[76:79], a[72:75], a[168:171], v[76:79]
ds_read_b64_tr_b16 a[94:95], v251 offset:4096
ds_read_b64_tr_b16 a[72:73], v246 offset:8192
v_mfma_f32_16x16x32_bf16 v[80:83], a[76:79], a[164:167], v[80:83]
ds_read_b64_tr_b16 a[74:75], v246 offset:12288
ds_read_b64_tr_b16 a[224:225], v245 offset:0
v_mfma_f32_16x16x32_bf16 v[84:87], a[76:79], a[168:171], v[84:87]
ds_read_b64_tr_b16 a[76:77], v247 offset:8192
ds_read_b64_tr_b16 a[226:227], v245 offset:4096
v_mfma_f32_16x16x32_bf16 v[88:91], a[80:83], a[164:167], v[88:91]
ds_read_b64_tr_b16 a[78:79], v247 offset:12288
ds_read_b64_tr_b16 a[228:229], v244 offset:8192
v_mfma_f32_16x16x32_bf16 v[92:95], a[80:83], a[168:171], v[92:95]
s_waitcnt lgkmcnt(7)
ds_read_b64_tr_b16 a[80:81], v248 offset:8192
v_mfma_f32_16x16x32_bf16 v[96:99], a[84:87], a[164:167], v[96:99]
ds_read_b64_tr_b16 a[82:83], v248 offset:12288
ds_read_b64_tr_b16 a[230:231], v244 offset:12288
v_mfma_f32_16x16x32_bf16 v[100:103], a[84:87], a[168:171], v[100:103]
ds_read_b64_tr_b16 a[84:85], v249 offset:8192
buffer_load_dwordx4 v[180:183], v36, s[20:23], s78 offen sc1
v_mfma_f32_16x16x32_bf16 v[104:107], a[88:91], a[164:167], v[104:107]
ds_read_b64_tr_b16 a[86:87], v249 offset:12288
ds_read_b64_tr_b16 a[232:233], v245 offset:8192
v_mfma_f32_16x16x32_bf16 v[108:111], a[88:91], a[168:171], v[108:111]
ds_read_b64_tr_b16 a[88:89], v250 offset:8192
buffer_load_dwordx4 v[196:199], v37, s[20:23], s78 offen sc1
v_mfma_f32_16x16x32_bf16 v[112:115], a[92:95], a[164:167], v[112:115]
ds_read_b64_tr_b16 a[90:91], v250 offset:12288
ds_read_b64_tr_b16 a[234:235], v245 offset:12288
v_mfma_f32_16x16x32_bf16 v[116:119], a[92:95], a[168:171], v[116:119]
ds_read_b64_tr_b16 a[92:93], v251 offset:8192
s_waitcnt vmcnt(10) lgkmcnt(8)
v_mfma_f32_16x16x32_bf16 v[72:75], a[72:75], a[172:175], v[72:75]
ds_read_b64_tr_b16 a[94:95], v251 offset:12288
s_add_u32 s78, s78, 589824
v_mfma_f32_16x16x32_bf16 v[76:79], a[72:75], a[176:179], v[76:79]
ds_read_b64_tr_b16 a[72:73], v246 offset:16384
buffer_load_dwordx4 v[184:187], v36, s[20:23], s78 offen sc1
v_mfma_f32_16x16x32_bf16 v[80:83], a[76:79], a[172:175], v[80:83]
ds_read_b64_tr_b16 a[74:75], v246 offset:20480
ds_read_b64_tr_b16 a[236:237], v244 offset:16384
v_mfma_f32_16x16x32_bf16 v[84:87], a[76:79], a[176:179], v[84:87]
ds_read_b64_tr_b16 a[76:77], v247 offset:16384
buffer_load_dwordx4 v[200:203], v37, s[20:23], s78 offen sc1
v_mfma_f32_16x16x32_bf16 v[88:91], a[80:83], a[172:175], v[88:91]
ds_read_b64_tr_b16 a[78:79], v247 offset:20480
ds_read_b64_tr_b16 a[238:239], v244 offset:20480
v_mfma_f32_16x16x32_bf16 v[92:95], a[80:83], a[176:179], v[92:95]
s_waitcnt lgkmcnt(6)
ds_read_b64_tr_b16 a[80:81], v248 offset:16384
v_mfma_f32_16x16x32_bf16 v[96:99], a[84:87], a[172:175], v[96:99]
ds_read_b64_tr_b16 a[82:83], v248 offset:20480
ds_read_b64_tr_b16 a[240:241], v245 offset:16384
v_mfma_f32_16x16x32_bf16 v[100:103], a[84:87], a[176:179], v[100:103]
ds_read_b64_tr_b16 a[84:85], v249 offset:16384
v_mfma_f32_16x16x32_bf16 v[104:107], a[88:91], a[172:175], v[104:107]
ds_read_b64_tr_b16 a[86:87], v249 offset:20480
ds_read_b64_tr_b16 a[242:243], v245 offset:20480
v_mfma_f32_16x16x32_bf16 v[108:111], a[88:91], a[176:179], v[108:111]
ds_read_b64_tr_b16 a[88:89], v250 offset:16384
v_mfma_f32_16x16x32_bf16 v[112:115], a[92:95], a[172:175], v[112:115]
ds_read_b64_tr_b16 a[90:91], v250 offset:20480
v_mfma_f32_16x16x32_bf16 v[116:119], a[92:95], a[176:179], v[116:119]
ds_read_b64_tr_b16 a[92:93], v251 offset:16384
s_waitcnt vmcnt(10) lgkmcnt(7)
v_mfma_f32_16x16x32_bf16 v[72:75], a[72:75], a[180:183], v[72:75]
ds_read_b64_tr_b16 a[94:95], v251 offset:20480
ds_read_b64_tr_b16 a[244:245], v244 offset:24576
v_mfma_f32_16x16x32_bf16 v[76:79], a[72:75], a[184:187], v[76:79]
ds_read_b64_tr_b16 a[72:73], v246 offset:24576
v_mfma_f32_16x16x32_bf16 v[80:83], a[76:79], a[180:183], v[80:83]
ds_read_b64_tr_b16 a[74:75], v246 offset:28672
ds_read_b64_tr_b16 a[246:247], v244 offset:28672
v_mfma_f32_16x16x32_bf16 v[84:87], a[76:79], a[184:187], v[84:87]
ds_read_b64_tr_b16 a[76:77], v247 offset:24576
v_mfma_f32_16x16x32_bf16 v[88:91], a[80:83], a[180:183], v[88:91]
ds_read_b64_tr_b16 a[78:79], v247 offset:28672
ds_read_b64_tr_b16 a[248:249], v245 offset:24576
v_mfma_f32_16x16x32_bf16 v[92:95], a[80:83], a[184:187], v[92:95]
s_waitcnt lgkmcnt(7)
ds_read_b64_tr_b16 a[80:81], v248 offset:24576
v_mfma_f32_16x16x32_bf16 v[96:99], a[84:87], a[180:183], v[96:99]
ds_read_b64_tr_b16 a[82:83], v248 offset:28672
ds_read_b64_tr_b16 a[250:251], v245 offset:28672
v_mfma_f32_16x16x32_bf16 v[100:103], a[84:87], a[184:187], v[100:103]
ds_read_b64_tr_b16 a[84:85], v249 offset:24576
v_mfma_f32_16x16x32_bf16 v[104:107], a[88:91], a[180:183], v[104:107]
ds_read_b64_tr_b16 a[86:87], v249 offset:28672
v_mfma_f32_16x16x32_bf16 v[108:111], a[88:91], a[184:187], v[108:111]
ds_read_b64_tr_b16 a[88:89], v250 offset:24576
v_mfma_f32_16x16x32_bf16 v[112:115], a[92:95], a[180:183], v[112:115]
ds_read_b64_tr_b16 a[90:91], v250 offset:28672
v_mfma_f32_16x16x32_bf16 v[116:119], a[92:95], a[184:187], v[116:119]
ds_read_b64_tr_b16 a[92:93], v251 offset:24576
s_waitcnt vmcnt(8) lgkmcnt(6)
v_mfma_f32_16x16x32_bf16 v[72:75], a[72:75], a[188:191], v[72:75]
ds_read_b64_tr_b16 a[94:95], v251 offset:28672
v_mfma_f32_16x16x32_bf16 v[76:79], a[72:75], a[192:195], v[76:79]
v_mfma_f32_16x16x32_bf16 v[80:83], a[76:79], a[188:191], v[80:83]
v_mfma_f32_16x16x32_bf16 v[84:87], a[76:79], a[192:195], v[84:87]
v_mfma_f32_16x16x32_bf16 v[88:91], a[80:83], a[188:191], v[88:91]
v_mfma_f32_16x16x32_bf16 v[92:95], a[80:83], a[192:195], v[92:95]
s_waitcnt lgkmcnt(0)
v_mfma_f32_16x16x32_bf16 v[96:99], a[84:87], a[188:191], v[96:99]
v_mfma_f32_16x16x32_bf16 v[100:103], a[84:87], a[192:195], v[100:103]
s_mov_b32 s94, 21757952
v_mfma_f32_16x16x32_bf16 v[104:107], a[88:91], a[188:191], v[104:107]
buffer_load_dword v48, v51, s[20:23], s94 offen sc1
v_mfma_f32_16x16x32_bf16 v[108:111], a[88:91], a[192:195], v[108:111]
v_mfma_f32_16x16x32_bf16 v[112:115], a[92:95], a[188:191], v[112:115]
v_mfma_f32_16x16x32_bf16 v[116:119], a[92:95], a[192:195], v[116:119]
s_waitcnt lgkmcnt(6)
v_mfma_f32_16x16x32_bf16 v[56:59], a[64:67], a[132:135], v[56:59]
v_cvt_pk_bf16_f32 v72, v72, v73
v_cvt_pk_bf16_f32 v73, v74, v75
v_mfma_f32_16x16x32_bf16 v[60:63], a[64:67], a[136:139], v[60:63]
v_cvt_pk_bf16_f32 v74, v76, v77
v_cvt_pk_bf16_f32 v75, v78, v79
v_mfma_f32_16x16x32_bf16 v[64:67], a[68:71], a[132:135], v[64:67]
buffer_store_dwordx4 v[72:75], v52, s[20:23], s37 offen offset:2048 sc1
v_cvt_pk_bf16_f32 v80, v80, v81
v_mfma_f32_16x16x32_bf16 v[68:71], a[68:71], a[136:139], v[68:71]
v_cvt_pk_bf16_f32 v81, v82, v83
v_cvt_pk_bf16_f32 v82, v84, v85
v_mfma_f32_16x16x32_bf16 v[56:59], a[196:199], a[140:143], v[56:59]
v_cvt_pk_bf16_f32 v83, v86, v87
buffer_store_dwordx4 v[80:83], v52, s[20:23], s37 offen offset:3072 sc1
v_mfma_f32_16x16x32_bf16 v[60:63], a[196:199], a[144:147], v[60:63]
v_cvt_pk_bf16_f32 v88, v88, v89
v_mfma_f32_16x16x32_bf16 v[64:67], a[200:203], a[140:143], v[64:67]
v_cvt_pk_bf16_f32 v89, v90, v91
v_cvt_pk_bf16_f32 v90, v92, v93
v_mfma_f32_16x16x32_bf16 v[68:71], a[200:203], a[144:147], v[68:71]
v_cvt_pk_bf16_f32 v91, v94, v95
buffer_store_dwordx4 v[88:91], v52, s[20:23], s38 offen offset:0 sc1
v_mfma_f32_16x16x32_bf16 v[56:59], a[204:207], a[148:151], v[56:59]
v_cvt_pk_bf16_f32 v96, v96, v97
v_cvt_pk_bf16_f32 v97, v98, v99
v_mfma_f32_16x16x32_bf16 v[60:63], a[204:207], a[152:155], v[60:63]
v_cvt_pk_bf16_f32 v98, v100, v101
v_cvt_pk_bf16_f32 v99, v102, v103
v_mfma_f32_16x16x32_bf16 v[64:67], a[208:211], a[148:151], v[64:67]
buffer_store_dwordx4 v[96:99], v52, s[20:23], s38 offen offset:1024 sc1
v_mfma_f32_16x16x32_bf16 v[68:71], a[208:211], a[152:155], v[68:71]
v_cvt_pk_bf16_f32 v104, v104, v105
v_cvt_pk_bf16_f32 v105, v106, v107
v_mfma_f32_16x16x32_bf16 v[56:59], a[212:215], a[156:159], v[56:59]
v_cvt_pk_bf16_f32 v106, v108, v109
v_cvt_pk_bf16_f32 v107, v110, v111
v_mfma_f32_16x16x32_bf16 v[60:63], a[212:215], a[160:163], v[60:63]
buffer_store_dwordx4 v[104:107], v52, s[20:23], s38 offen offset:2048 sc1
v_cvt_pk_bf16_f32 v112, v112, v113
v_mfma_f32_16x16x32_bf16 v[64:67], a[216:219], a[156:159], v[64:67]
v_cvt_pk_bf16_f32 v113, v114, v115
v_cvt_pk_bf16_f32 v114, v116, v117
v_mfma_f32_16x16x32_bf16 v[68:71], a[216:219], a[160:163], v[68:71]
v_cvt_pk_bf16_f32 v115, v118, v119
buffer_store_dwordx4 v[112:115], v52, s[20:23], s38 offen offset:3072 sc1
v_mfma_f32_16x16x32_bf16 v[56:59], a[220:223], a[164:167], v[56:59]
ds_read_b128 a[0:3], v29 offset:0
ds_read_b128 a[4:7], v29 offset:2048
v_mfma_f32_16x16x32_bf16 v[60:63], a[220:223], a[168:171], v[60:63]
ds_read_b128 a[8:11], v29 offset:4096
v_mfma_f32_16x16x32_bf16 v[64:67], a[224:227], a[164:167], v[64:67]
ds_read_b128 a[12:15], v29 offset:6144
v_mfma_f32_16x16x32_bf16 v[68:71], a[224:227], a[168:171], v[68:71]
ds_read_b128 a[16:19], v30 offset:0
v_mfma_f32_16x16x32_bf16 v[56:59], a[228:231], a[172:175], v[56:59]
ds_read_b128 a[20:23], v30 offset:2048
ds_read_b128 a[24:27], v30 offset:4096
v_mfma_f32_16x16x32_bf16 v[60:63], a[228:231], a[176:179], v[60:63]
ds_read_b128 a[28:31], v30 offset:6144
v_mfma_f32_16x16x32_bf16 v[64:67], a[232:235], a[172:175], v[64:67]
ds_read_b128 a[32:35], v31 offset:0
v_mfma_f32_16x16x32_bf16 v[68:71], a[232:235], a[176:179], v[68:71]
ds_read_b128 a[36:39], v31 offset:2048
v_mfma_f32_16x16x32_bf16 v[56:59], a[236:239], a[180:183], v[56:59]
ds_read_b128 a[40:43], v31 offset:4096
ds_read_b128 a[44:47], v31 offset:6144
v_mfma_f32_16x16x32_bf16 v[60:63], a[236:239], a[184:187], v[60:63]
ds_read_b128 a[48:51], v32 offset:0
v_mfma_f32_16x16x32_bf16 v[64:67], a[240:243], a[180:183], v[64:67]
ds_read_b128 a[52:55], v32 offset:2048
v_mfma_f32_16x16x32_bf16 v[68:71], a[240:243], a[184:187], v[68:71]
ds_read_b128 a[56:59], v32 offset:4096
v_mfma_f32_16x16x32_bf16 v[56:59], a[244:247], a[188:191], v[56:59]
ds_read_b128 a[60:63], v32 offset:6144
v_mfma_f32_16x16x32_bf16 v[60:63], a[244:247], a[192:195], v[60:63]
v_mfma_f32_16x16x32_bf16 v[64:67], a[248:251], a[188:191], v[64:67]
v_mfma_f32_16x16x32_bf16 v[68:71], a[248:251], a[192:195], v[68:71]
s_sub_u32 s45, s37, 22020096
s_xor_b32 s46, s45, 32768
s_add_u32 s82, s46, 22022144
s_xor_b32 s46, s45, 65536
s_add_u32 s83, s46, 22024192
s_xor_b32 s46, s45, 98304
s_add_u32 s84, s46, 22026240
s_mov_b32 s46, 0xffff0000
s_mov_b32 s47, 0xbfb8aa3b
s_mov_b32 s79, 21626880
s_mov_b32 s74, 0x40000
s_mov_b32 s86, 0
s_mov_b32 s87, -1
s_mov_b32 s88, s46
s_mov_b32 s89, s46
v_mul_f32 v244, s47, v33
v_mul_f32 v245, s47, v22
v_cndmask_b32 v246, v33, v22, s[86:87]
v_mul_f32 v247, s47, v246
v_lshlrev_b32 v0, 16, v2
v_and_b32 v1, s46, v2
s_waitcnt vmcnt(6)
v_cmp_ne_u32 vcc, s62, v48
s_waitcnt vmcnt(0)
buffer_store_dword v54, v3, s[20:23], s85 offen sc1
s_cmp_eq_u32 s81, 0
s_cbranch_scc1 L_late
s_cbranch_vccnz L_late2
L_late_r:
buffer_load_dwordx4 v[204:207], v8, s[20:23], s77 offen sc1
s_add_u32 s77, s77, 589824
buffer_load_dwordx4 v[208:211], v8, s[20:23], s77 offen sc1
s_add_u32 s77, s77, 589824
buffer_load_dwordx4 v[212:215], v8, s[20:23], s77 offen sc1
s_add_u32 s77, s77, 589824
buffer_load_dwordx4 v[216:219], v8, s[20:23], s77 offen sc1
s_add_u32 s77, s77, 589824
buffer_load_dwordx4 v[120:123], v53, s[20:23], s39 offen sc1
s_add_u32 s39, s39, 131072
buffer_load_dwordx4 v[124:127], v53, s[20:23], s39 offen sc1
s_add_u32 s39, s39, 131072
buffer_load_dwordx4 v[128:131], v53, s[20:23], s39 offen sc1
s_add_u32 s39, s39, 131072
buffer_load_dwordx4 v[132:135], v53, s[20:23], s39 offen sc1
s_add_u32 s39, s39, 131072
buffer_load_dword v23, v50, s[20:23], s79 offen sc1
s_waitcnt vmcnt(17) lgkmcnt(0)
v_mfma_f32_16x16x32_bf16 v[220:223], v[172:175], a[0:3], 0
v_mfma_f32_16x16x32_bf16 v[224:227], v[172:175], a[16:19], 0
v_mfma_f32_16x16x32_bf16 v[220:223], v[176:179], a[4:7], v[220:223]
v_mfma_f32_16x16x32_bf16 v[224:227], v[176:179], a[20:23], v[224:227]
v_mfma_f32_16x16x32_bf16 v[220:223], v[180:183], a[8:11], v[220:223]
v_mfma_f32_16x16x32_bf16 v[224:227], v[180:183], a[24:27], v[224:227]
v_mfma_f32_16x16x32_bf16 v[220:223], v[184:187], a[12:15], v[220:223]
v_mfma_f32_16x16x32_bf16 v[224:227], v[184:187], a[28:31], v[224:227]
v_mfma_f32_16x16x32_bf16 v[228:231], v[188:191], a[0:3], 0
v_mfma_f32_16x16x32_bf16 v[232:235], v[188:191], a[16:19], 0
v_mfma_f32_16x16x32_bf16 v[228:231], v[192:195], a[4:7], v[228:231]
v_mfma_f32_16x16x32_bf16 v[232:235], v[192:195], a[20:23], v[232:235]
v_mfma_f32_16x16x32_bf16 v[228:231], v[196:199], a[8:11], v[228:231]
v_mfma_f32_16x16x32_bf16 v[232:235], v[196:199], a[24:27], v[232:235]
v_mfma_f32_16x16x32_bf16 v[228:231], v[200:203], a[12:15], v[228:231]
v_mfma_f32_16x16x32_bf16 v[232:235], v[200:203], a[28:31], v[232:235]
v_accvgpr_read_b32 v97, a96
v_lshlrev_b32 v96, 16, v97
v_and_b32 v97, s46, v97
v_accvgpr_read_b32 v99, a97
v_lshlrev_b32 v98, 16, v99
v_and_b32 v99, s46, v99
v_accvgpr_read_b32 v101, a98
v_lshlrev_b32 v100, 16, v101
v_and_b32 v101, s46, v101
v_accvgpr_read_b32 v103, a99
v_lshlrev_b32 v102, 16, v103
v_and_b32 v103, s46, v103
v_accvgpr_read_b32 v105, a252
v_lshlrev_b32 v104, 16, v105
v_and_b32 v105, s46, v105
v_accvgpr_read_b32 v107, a253
v_lshlrev_b32 v106, 16, v107
v_and_b32 v107, s46, v107
v_accvgpr_read_b32 v109, a254
v_lshlrev_b32 v108, 16, v109
v_and_b32 v109, s46, v109
v_accvgpr_read_b32 v111, a255
v_lshlrev_b32 v110, 16, v111
v_and_b32 v111, s46, v111
v_mul_f32 v220, v220, v33
v_mul_f32 v221, v221, v33
v_mul_f32 v222, v222, v33
v_mul_f32 v223, v223, v33
v_mul_f32 v224, v224, v22
v_mul_f32 v225, v225, v22
v_mul_f32 v226, v226, v22
v_mul_f32 v227, v227, v22
v_mul_f32 v228, v228, v33
v_mul_f32 v229, v229, v33
v_mul_f32 v230, v230, v33
v_mul_f32 v231, v231, v33
v_mul_f32 v232, v232, v22
v_mul_f32 v233, v233, v22
v_mul_f32 v234, v234, v22
v_mul_f32 v235, v235, v22
s_waitcnt vmcnt(0)
v_cmp_ne_u32 vcc, s62, v23
s_nop 1
s_cbranch_vccnz L_pp
L_pp_r:
buffer_load_dwordx4 v[72:75], v52, s[20:23], s82 offen offset:0 sc1
buffer_load_dwordx4 v[80:83], v52, s[20:23], s83 offen offset:0 sc1
buffer_load_dwordx4 v[88:91], v52, s[20:23], s84 offen offset:0 sc1
buffer_load_dwordx4 v[76:79], v52, s[20:23], s82 offen offset:1024 sc1
buffer_load_dwordx4 v[84:87], v52, s[20:23], s83 offen offset:1024 sc1
buffer_load_dwordx4 v[92:95], v52, s[20:23], s84 offen offset:1024 sc1
v_mfma_f32_16x16x32_bf16 v[236:239], v[204:207], a[32:35], 0
v_mfma_f32_16x16x32_bf16 v[240:243], v[204:207], a[48:51], 0
v_mfma_f32_16x16x32_bf16 v[236:239], v[208:211], a[36:39], v[236:239]
v_mfma_f32_16x16x32_bf16 v[240:243], v[208:211], a[52:55], v[240:243]
v_mfma_f32_16x16x32_bf16 v[236:239], v[212:215], a[40:43], v[236:239]
v_mfma_f32_16x16x32_bf16 v[240:243], v[212:215], a[56:59], v[240:243]
v_mfma_f32_16x16x32_bf16 v[236:239], v[216:219], a[44:47], v[236:239]
v_mfma_f32_16x16x32_bf16 v[240:243], v[216:219], a[60:63], v[240:243]
v_mfma_f32_16x16x16_bf16 v[144:147], v[252:253], v[120:121], 0
v_mfma_f32_16x16x16_bf16 v[144:147], v[254:255], v[122:123], v[144:147]
v_mfma_f32_16x16x16_bf16 v[144:147], v[252:253], v[124:125], v[144:147]
v_mfma_f32_16x16x16_bf16 v[144:147], v[254:255], v[126:127], v[144:147]
v_mfma_f32_16x16x16_bf16 v[144:147], v[252:253], v[128:129], v[144:147]
v_mfma_f32_16x16x16_bf16 v[144:147], v[254:255], v[130:131], v[144:147]
v_mfma_f32_16x16x16_bf16 v[144:147], v[252:253], v[132:133], v[144:147]
v_mfma_f32_16x16x16_bf16 v[144:147], v[254:255], v[134:135], v[144:147]
v_cndmask_b32 v236, v236, v240, s[86:87]
v_cndmask_b32 v237, v237, v241, s[86:87]
v_cndmask_b32 v238, v238, v242, s[86:87]
v_cndmask_b32 v239, v239, v243, s[86:87]
v_cndmask_b32 v236, v236, v238, s[88:89]
v_cndmask_b32 v237, v237, v239, s[88:89]
v_mul_f32 v236, v236, v246
v_mul_f32 v237, v237, v246
s_nop 3
v_mul_f32 v248, v144, v247
v_mul_f32 v249, v145, v247
v_exp_f32 v248, v248
v_exp_f32 v249, v249
v_mul_f32 v144, v144, v236
v_mul_f32 v145, v145, v237
v_add_f32 v248, 1.0, v248
v_add_f32 v249, 1.0, v249
v_rcp_f32 v248, v248
v_rcp_f32 v249, v249
s_nop 0
v_fmac_f32 v0, v144, v248
v_fmac_f32 v1, v145, v249
v_cvt_pk_bf16_f32 v144, v0, v1
buffer_store_dword v144, v35, s[52:55], 0 offen
s_waitcnt vmcnt(6)
v_mfma_f32_16x16x16_bf16 v[56:59], v[12:13], v[72:73], v[56:59]
v_mfma_f32_16x16x16_bf16 v[60:63], v[12:13], v[74:75], v[60:63]
s_waitcnt vmcnt(5)
v_mfma_f32_16x16x16_bf16 v[56:59], v[12:13], v[80:81], v[56:59]
v_mfma_f32_16x16x16_bf16 v[60:63], v[12:13], v[82:83], v[60:63]
s_waitcnt vmcnt(4)
v_mfma_f32_16x16x16_bf16 v[56:59], v[12:13], v[88:89], v[56:59]
v_mfma_f32_16x16x16_bf16 v[60:63], v[12:13], v[90:91], v[60:63]
s_waitcnt vmcnt(3)
v_mfma_f32_16x16x16_bf16 v[64:67], v[12:13], v[76:77], v[64:67]
v_mfma_f32_16x16x16_bf16 v[68:71], v[12:13], v[78:79], v[68:71]
s_waitcnt vmcnt(2)
v_mfma_f32_16x16x16_bf16 v[64:67], v[12:13], v[84:85], v[64:67]
v_mfma_f32_16x16x16_bf16 v[68:71], v[12:13], v[86:87], v[68:71]
s_waitcnt vmcnt(1)
v_mfma_f32_16x16x16_bf16 v[64:67], v[12:13], v[92:93], v[64:67]
v_mfma_f32_16x16x16_bf16 v[68:71], v[12:13], v[94:95], v[68:71]
s_nop 1
v_mul_f32 v248, v56, v244
v_mul_f32 v249, v57, v244
v_mul_f32 v250, v58, v244
v_mul_f32 v251, v59, v244
v_exp_f32 v248, v248
v_exp_f32 v249, v249
v_exp_f32 v250, v250
v_exp_f32 v251, v251
v_mul_f32 v56, v56, v220
v_mul_f32 v57, v57, v221
v_mul_f32 v58, v58, v222
v_mul_f32 v59, v59, v223
v_add_f32 v248, 1.0, v248
v_add_f32 v249, 1.0, v249
v_add_f32 v250, 1.0, v250
v_add_f32 v251, 1.0, v251
v_rcp_f32 v248, v248
v_rcp_f32 v249, v249
v_rcp_f32 v250, v250
v_rcp_f32 v251, v251
v_fmac_f32 v96, v56, v248
v_fmac_f32 v97, v57, v249
v_fmac_f32 v98, v58, v250
v_fmac_f32 v99, v59, v251
v_cvt_pk_bf16_f32 v56, v96, v97
v_cvt_pk_bf16_f32 v57, v98, v99
buffer_store_dwordx2 v[56:57], v34, s[52:55], 0 offen offset:0
v_mul_f32 v248, v60, v245
v_mul_f32 v249, v61, v245
v_mul_f32 v250, v62, v245
v_mul_f32 v251, v63, v245
v_exp_f32 v248, v248
v_exp_f32 v249, v249
v_exp_f32 v250, v250
v_exp_f32 v251, v251
v_mul_f32 v60, v60, v224
v_mul_f32 v61, v61, v225
v_mul_f32 v62, v62, v226
v_mul_f32 v63, v63, v227
v_add_f32 v248, 1.0, v248
v_add_f32 v249, 1.0, v249
v_add_f32 v250, 1.0, v250
v_add_f32 v251, 1.0, v251
v_rcp_f32 v248, v248
v_rcp_f32 v249, v249
v_rcp_f32 v250, v250
v_rcp_f32 v251, v251
v_fmac_f32 v100, v60, v248
v_fmac_f32 v101, v61, v249
v_fmac_f32 v102, v62, v250
v_fmac_f32 v103, v63, v251
v_cvt_pk_bf16_f32 v60, v100, v101
v_cvt_pk_bf16_f32 v61, v102, v103
buffer_store_dwordx2 v[60:61], v34, s[52:55], s51 offen offset:0
v_mul_f32 v248, v64, v244
v_mul_f32 v249, v65, v244
v_mul_f32 v250, v66, v244
v_mul_f32 v251, v67, v244
v_exp_f32 v248, v248
v_exp_f32 v249, v249
v_exp_f32 v250, v250
v_exp_f32 v251, v251
v_mul_f32 v64, v64, v228
v_mul_f32 v65, v65, v229
v_mul_f32 v66, v66, v230
v_mul_f32 v67, v67, v231
v_add_f32 v248, 1.0, v248
v_add_f32 v249, 1.0, v249
v_add_f32 v250, 1.0, v250
v_add_f32 v251, 1.0, v251
v_rcp_f32 v248, v248
v_rcp_f32 v249, v249
v_rcp_f32 v250, v250
v_rcp_f32 v251, v251
v_fmac_f32 v104, v64, v248
v_fmac_f32 v105, v65, v249
v_fmac_f32 v106, v66, v250
v_fmac_f32 v107, v67, v251
v_cvt_pk_bf16_f32 v64, v104, v105
v_cvt_pk_bf16_f32 v65, v106, v107
buffer_store_dwordx2 v[64:65], v34, s[52:55], 0 offen offset:32
v_mul_f32 v248, v68, v245
v_mul_f32 v249, v69, v245
v_mul_f32 v250, v70, v245
v_mul_f32 v251, v71, v245
v_exp_f32 v248, v248
v_exp_f32 v249, v249
v_exp_f32 v250, v250
v_exp_f32 v251, v251
v_mul_f32 v68, v68, v232
v_mul_f32 v69, v69, v233
v_mul_f32 v70, v70, v234
v_mul_f32 v71, v71, v235
v_add_f32 v248, 1.0, v248
v_add_f32 v249, 1.0, v249
v_add_f32 v250, 1.0, v250
v_add_f32 v251, 1.0, v251
v_rcp_f32 v248, v248
v_rcp_f32 v249, v249
v_rcp_f32 v250, v250
v_rcp_f32 v251, v251
v_fmac_f32 v108, v68, v248
v_fmac_f32 v109, v69, v249
v_fmac_f32 v110, v70, v250
v_fmac_f32 v111, v71, v251
v_cvt_pk_bf16_f32 v68, v108, v109
v_cvt_pk_bf16_f32 v69, v110, v111
buffer_store_dwordx2 v[68:69], v34, s[52:55], s51 offen offset:32
s_endpgm
L_fl1:
s_mov_b32 s74, 0x40000
L_fl1_l:
s_sleep 4
buffer_load_dword v23, off, s[20:23], s91 sc1
s_waitcnt vmcnt(0)
v_readfirstlane_b32 s44, v23
s_sub_u32 s74, s74, 1
s_cbranch_scc1 L_fl1_r
s_cmp_eq_u32 s44, s62
s_cbranch_scc0 L_fl1_l
s_branch L_fl1_r
L_fl2:
s_mov_b32 s74, 0x40000
L_fl2_l:
s_sleep 4
buffer_load_dword v23, off, s[20:23], s92 sc1
s_waitcnt vmcnt(0)
v_readfirstlane_b32 s44, v23
s_sub_u32 s74, s74, 1
s_cbranch_scc1 L_fl2_r
s_cmp_eq_u32 s44, s62
s_cbranch_scc0 L_fl2_l
s_branch L_fl2_r
L_fl3:
s_mov_b32 s74, 0x40000
L_fl3_l:
s_sleep 4
buffer_load_dword v23, off, s[20:23], s93 sc1
s_waitcnt vmcnt(0)
v_readfirstlane_b32 s44, v23
s_sub_u32 s74, s74, 1
s_cbranch_scc1 L_fl3_r
s_cmp_eq_u32 s44, s62
s_cbranch_scc0 L_fl3_l
s_branch L_fl3_r
L_late:
buffer_load_dword v49, v9, s[20:23], s60 offen sc1
s_waitcnt vmcnt(0)
v_cmp_ne_u32 vcc, s62, v49
s_sub_u32 s74, s74, 1
s_cbranch_scc1 L_late_r
s_cbranch_vccnz L_late
buffer_load_dwordx4 v[172:175], v36, s[20:23], s76 offen sc1
buffer_load_dwordx4 v[188:191], v37, s[20:23], s76 offen sc1
s_add_u32 s76, s76, 589824
buffer_load_dwordx4 v[176:179], v36, s[20:23], s76 offen sc1
buffer_load_dwordx4 v[192:195], v37, s[20:23], s76 offen sc1
s_add_u32 s76, s76, 589824
buffer_load_dwordx4 v[180:183], v36, s[20:23], s76 offen sc1
buffer_load_dwordx4 v[196:199], v37, s[20:23], s76 offen sc1
s_add_u32 s76, s76, 589824
buffer_load_dwordx4 v[184:187], v36, s[20:23], s76 offen sc1
buffer_load_dwordx4 v[200:203], v37, s[20:23], s76 offen sc1
L_late2:
buffer_load_dword v48, v51, s[20:23], s94 offen sc1
s_waitcnt vmcnt(0)
v_cmp_ne_u32 vcc, s62, v48
s_sub_u32 s74, s74, 1
s_cbranch_scc1 L_late2_r
s_cbranch_vccnz L_late2
L_late2_r:
s_branch L_late_r
L_pp:
buffer_load_dword v23, v50, s[20:23], s79 offen sc1
s_waitcnt vmcnt(0)
v_cmp_ne_u32 vcc, s62, v23
s_sub_u32 s74, s74, 1
s_cbranch_scc1 L_pp_r
s_cbranch_vccnz L_pp
s_branch L_pp_r
L_nonce_l:
s_mov_b32 s74, 0x40000
L_nonce_l_l:
s_sleep 8
v_mov_b32 v33, 0
global_load_dword v33, v33, s[96:97] offset:8 sc1
s_waitcnt vmcnt(0)
v_readfirstlane_b32 s62, v33
s_sub_u32 s74, s74, 1
s_cbranch_scc1 L_nonce_l_r
s_cmp_lg_u32 s62, 0
s_cbranch_scc0 L_nonce_l_l
s_branch L_nonce_l_r
L_side_l:
s_mov_b32 s74, 0x40000
L_side_l_l:
s_sleep 8
buffer_load_dwordx3 v[0:2], v36, s[20:23], s39 offen offset:0 sc1
buffer_load_dwordx3 v[4:6], v36, s[20:23], s39 offen offset:256 sc1
buffer_load_dwordx2 v[38:39], v34, s[20:23], s37 offen offset:0 sc1
buffer_load_dwordx2 v[40:41], v34, s[20:23], s38 offen offset:0 sc1
buffer_load_dwordx2 v[42:43], v34, s[20:23], s37 offen offset:128 sc1
buffer_load_dwordx2 v[44:45], v34, s[20:23], s38 offen offset:128 sc1
buffer_load_dwordx2 v[46:47], v34, s[20:23], s37 offen offset:256 sc1
buffer_load_dwordx2 v[48:49], v34, s[20:23], s38 offen offset:256 sc1
buffer_load_dwordx2 v[50:51], v34, s[20:23], s37 offen offset:384 sc1
buffer_load_dwordx2 v[8:9], v34, s[20:23], s38 offen offset:384 sc1
buffer_load_dwordx2 v[32:33], v35, s[20:23], s37 offen sc1
buffer_load_dword v23, v37, s[20:23], s42 offen sc1
s_waitcnt vmcnt(0)
v_bfe_i32 v52, v34, 30, 1
v_xor_b32 v23, s62, v23
v_bitop3_b32 v23, v23, v2, s62 bitop3:0xf6
v_bitop3_b32 v23, v23, v6, s62 bitop3:0xf6
v_bitop3_b32 v23, v23, v39, s62 bitop3:0xf6
v_bitop3_b32 v23, v23, v41, s62 bitop3:0xf6
v_bitop3_b32 v23, v23, v43, s62 bitop3:0xf6
v_bitop3_b32 v23, v23, v45, s62 bitop3:0xf6
v_bitop3_b32 v23, v23, v47, s62 bitop3:0xf6
v_bitop3_b32 v23, v23, v49, s62 bitop3:0xf6
v_bitop3_b32 v23, v23, v51, s62 bitop3:0xf6
v_bitop3_b32 v23, v23, v9, s62 bitop3:0xf6
v_bitop3_b32 v23, v23, v33, s62 bitop3:0xf6
v_bfi_b32 v23, v52, 0, v23
v_cmp_ne_u32 vcc, 0, v23
s_sub_u32 s74, s74, 1
s_cbranch_scc1 L_side_l_r
s_cbranch_vccnz L_side_l_l
s_branch L_side_l_r
L_pub:
v_accvgpr_read_b32 v38, a212
v_accvgpr_read_b32 v39, a213
v_accvgpr_read_b32 v40, a214
v_accvgpr_read_b32 v41, a215
v_accvgpr_read_b32 v42, a216
v_accvgpr_read_b32 v48, a220
v_accvgpr_read_b32 v49, a221
v_accvgpr_read_b32 v50, a222
v_accvgpr_read_b32 v51, a223
v_add_f32_dpp v38, v38, v38 row_ror:8 row_mask:0xf bank_mask:0xf
v_add_f32_dpp v39, v39, v39 row_ror:8 row_mask:0xf bank_mask:0xf
v_add_f32_dpp v40, v40, v40 row_ror:8 row_mask:0xf bank_mask:0xf
v_add_f32_dpp v41, v41, v41 row_ror:8 row_mask:0xf bank_mask:0xf
v_and_b32 v52, 3, v19
v_cmp_eq_u32 vcc, 1, v52
v_lshrrev_b32 v53, 4, v19
v_and_b32 v46, 15, v19
v_cndmask_b32 v43, v48, v49, vcc
v_cmp_eq_u32 vcc, 2, v52
v_mov_b32 v44, s62
s_mov_b32 s44, 0xff00ff00
v_cndmask_b32 v43, v43, v50, vcc
v_cmp_eq_u32 vcc, 3, v52
s_mov_b32 s45, s44
v_mov_b32 v48, 1073741824
v_cndmask_b32 v43, v43, v51, vcc
v_lshrrev_b32 v52, 2, v46
v_cmp_eq_u32 vcc, v52, v53
v_lshlrev_b32 v46, 4, v46
v_cndmask_b32 v38, v38, v39, s[44:45]
v_cndmask_b32 v46, v48, v46, vcc
v_cndmask_b32 v40, v40, v41, s[44:45]
v_cmp_lt_u32 vcc, 31, v19
v_and_b32 v47, 7, v19
v_lshlrev_b32 v47, 6, v47
v_cndmask_b32 v38, v38, v40, vcc
v_mov_b32 v39, s62
v_bfe_u32 v48, v19, 4, 1
v_lshl_add_u32 v47, v48, 5, v47
v_lshrrev_b32 v48, 5, v19
v_lshl_add_u32 v47, v48, 4, v47
v_and_b32 v48, 8, v19
v_add_u32 v47, v48, v47
buffer_store_dwordx2 v[38:39], v47, s[20:23], s48 offen sc1
buffer_store_dwordx4 v[42:45], v46, s[20:23], s64 offen sc1
s_cmp_lg_u32 s63, 0
s_cbranch_scc1 L_pub_rl
s_mov_b32 s45, 21561344
s_mov_b32 s46, 21565440
buffer_store_dwordx4 a[228:231], v45, s[20:23], s45 offen sc1
buffer_store_dwordx4 a[232:235], v45, s[20:23], s45 offen offset:2048 sc1
buffer_store_dwordx4 a[236:239], v45, s[20:23], s46 offen sc1
buffer_store_dwordx4 a[240:243], v45, s[20:23], s46 offen offset:2048 sc1
s_lshl_b32 s45, s32, 7
s_add_u32 s45, s45, 21577728
s_waitcnt vmcnt(0)
buffer_store_dword v44, off, s[20:23], s45 sc1
s_branch L_pub_rl
L_midl:
buffer_load_dword v23, v31, s[4:7], 0 offen
s_bitcmp1_b32 s32, 0
s_cbranch_scc1 L_mt_l
buffer_load_dword v32, v32, s[24:27], 0 offen
s_branch L_mid_rl
L_mt_l:
buffer_load_dword v32, v32, s[28:31], 0 offen
s_branch L_mid_rl
L_nonce_h:
s_mov_b32 s74, 0x40000
L_nonce_h_l:
s_sleep 8
v_mov_b32 v33, 0
global_load_dword v33, v33, s[96:97] offset:8 sc1
s_waitcnt vmcnt(0)
v_readfirstlane_b32 s62, v33
s_sub_u32 s74, s74, 1
s_cbranch_scc1 L_nonce_h_r
s_cmp_lg_u32 s62, 0
s_cbranch_scc0 L_nonce_h_l
s_branch L_nonce_h_r
L_side_h:
s_mov_b32 s74, 0x40000
L_side_h_l:
s_sleep 8
buffer_load_dwordx3 v[0:2], v36, s[20:23], s39 offen offset:0 sc1
buffer_load_dwordx3 v[4:6], v36, s[20:23], s39 offen offset:256 sc1
buffer_load_dwordx2 v[38:39], v34, s[20:23], s37 offen offset:0 sc1
buffer_load_dwordx2 v[40:41], v34, s[20:23], s38 offen offset:0 sc1
buffer_load_dwordx2 v[42:43], v34, s[20:23], s37 offen offset:128 sc1
buffer_load_dwordx2 v[44:45], v34, s[20:23], s38 offen offset:128 sc1
buffer_load_dwordx2 v[46:47], v34, s[20:23], s37 offen offset:256 sc1
buffer_load_dwordx2 v[48:49], v34, s[20:23], s38 offen offset:256 sc1
buffer_load_dwordx2 v[50:51], v34, s[20:23], s37 offen offset:384 sc1
buffer_load_dwordx2 v[8:9], v34, s[20:23], s38 offen offset:384 sc1
buffer_load_dwordx2 v[32:33], v35, s[20:23], s37 offen sc1
buffer_load_dword v23, v37, s[20:23], s42 offen sc1
s_waitcnt vmcnt(0)
v_bfe_i32 v52, v34, 30, 1
v_xor_b32 v23, s62, v23
v_bitop3_b32 v23, v23, v2, s62 bitop3:0xf6
v_bitop3_b32 v23, v23, v6, s62 bitop3:0xf6
v_bitop3_b32 v23, v23, v39, s62 bitop3:0xf6
v_bitop3_b32 v23, v23, v41, s62 bitop3:0xf6
v_bitop3_b32 v23, v23, v43, s62 bitop3:0xf6
v_bitop3_b32 v23, v23, v45, s62 bitop3:0xf6
v_bitop3_b32 v23, v23, v47, s62 bitop3:0xf6
v_bitop3_b32 v23, v23, v49, s62 bitop3:0xf6
v_bitop3_b32 v23, v23, v51, s62 bitop3:0xf6
v_bitop3_b32 v23, v23, v9, s62 bitop3:0xf6
v_bitop3_b32 v23, v23, v33, s62 bitop3:0xf6
v_bfi_b32 v23, v52, 0, v23
v_cmp_ne_u32 vcc, 0, v23
s_sub_u32 s74, s74, 1
s_cbranch_scc1 L_side_h_r
s_cbranch_vccnz L_side_h_l
s_branch L_side_h_r
L_midh:
buffer_load_dword v23, v31, s[4:7], 0 offen
s_bitcmp1_b32 s32, 0
s_cbranch_scc1 L_mt_h
buffer_load_dword v32, v32, s[24:27], 0 offen
s_branch L_mid_rh
L_mt_h:
buffer_load_dword v32, v32, s[28:31], 0 offen
s_branch L_mid_rh
L_end:
s_endpgm
.section .rodata,"a"
.p2align 6
.amdhsa_kernel recurrent_scan__spectral_fnet__glu_gated_reglu__prompt_kernel
  .amdhsa_next_free_vgpr 512
  .amdhsa_next_free_sgpr 102
  .amdhsa_accum_offset 256
  .amdhsa_group_segment_fixed_size 0
  .amdhsa_kernarg_size 96
  .amdhsa_user_sgpr_count 2
  .amdhsa_user_sgpr_kernarg_segment_ptr 1
  .amdhsa_system_sgpr_workgroup_id_x 1
  .amdhsa_float_denorm_mode_32 3
.end_amdhsa_kernel
.text
```
